```python
import torch

def _softmax(x, axis=-1):
    return torch.softmax(x, dim=axis)

def _gelu(x):
    return torch.nn.functional.gelu(x, approximate='tanh')

def _silu(x):
    return torch.nn.functional.silu(x)

def _sigmoid(x):
    return torch.sigmoid(x)

def _layernorm(x, axis=-1, eps=1e-05):
    m = x.mean(dim=axis, keepdim=True)
    v = x.var(dim=axis, keepdim=True, unbiased=False)
    return (x - m) / torch.sqrt(v + eps)

def _scatter_add(tgt, idx, src, axis=0):
    return tgt.clone().index_add_(axis, idx, src)

def _segment_sum(src, seg, n):
    out = torch.zeros((n,) + src.shape[1:], dtype=src.dtype)
    return out.index_add_(0, seg, src)

def _pad(x, pw):
    flat = tuple((v for pair in reversed(pw) for v in pair))
    return torch.nn.functional.pad(x, flat)
kernel_name = 'concat_heads__spectral_gfnet__memory_aug_recurrent_mem_tr__prompt'

def setup_inputs():

    _w = lambda a: (lambda t: t.to(torch.bfloat16) if t.is_floating_point() else t)(torch.as_tensor(a))

    def _A_setup():
        B, S, D = (1, 2048, 576)
        Df = D // 2 + 1
        return {'x': _w((lambda *s: torch.randn(*s, dtype=torch.bfloat16) * 0.05)(B, S, D)), 'w_r': _w((lambda *s: torch.randn(*s, dtype=torch.bfloat16) * 3.2)(S, Df) * 0.02), 'w_i': _w((lambda *s: torch.randn(*s, dtype=torch.bfloat16) * 3.2)(S, Df) * 0.02)}
    _A_in = _A_setup()

    def _B_setup():
        B, S, Dm = (1, 2048, 576)
        H, Dh = (32, 128)
        M, seg = (8, 32)
        seg = min(seg, S)
        S = S // seg * seg
        return {'x': _w((lambda *s: torch.randn(*s, dtype=torch.bfloat16) * 0.05)(B, S, Dm)), 'mem0': _w((lambda *s: torch.randn(*s, dtype=torch.bfloat16) * 0.4)(B, M, Dm)), 'Wq': _w((lambda *s: torch.randn(*s, dtype=torch.bfloat16) * 6.4)(Dm, H, Dh) * Dm ** (-0.5)), 'Wk': _w((lambda *s: torch.randn(*s, dtype=torch.bfloat16) * 6.4)(Dm, H, Dh) * Dm ** (-0.5)), 'Wv': _w((lambda *s: torch.randn(*s, dtype=torch.bfloat16) * 0.4)(Dm, H, Dh) * Dm ** (-0.5)), 'Wo': _w((lambda *s: torch.randn(*s, dtype=torch.bfloat16) * 0.4)(H, Dh, Dm) * (H * Dh) ** (-0.5)), 'seg_len': seg}
    _B_in = _B_setup()
    return {'A_x': _A_in['x'], 'A_w_r': _A_in['w_r'], 'A_w_i': _A_in['w_i'], 'B_x': _B_in['x'], 'B_mem0': _B_in['mem0'], 'B_Wq': _B_in['Wq'], 'B_Wk': _B_in['Wk'], 'B_Wv': _B_in['Wv'], 'B_Wo': _B_in['Wo'], 'B_seg_len': _B_in['seg_len']}

def reference(A_x, A_w_r, A_w_i, B_x, B_mem0, B_Wq, B_Wk, B_Wv, B_Wo, B_seg_len):

    def _A_ref(x, w_r, w_i):
        B, S, D = x.shape
        X = (lambda x, axes=(-2, -1): torch.fft.rfft2(x.float(), dim=axes))(x, axes=(-2, -1))
        W = w_r + 1j * w_i
        X = X * W
        y = (lambda x, s, axes=(-2, -1): torch.fft.irfft2(x, s=s, dim=axes).to(torch.bfloat16))(X, (S, D), axes=(-2, -1))
        return y

    def _B_ref(x, mem0, Wq, Wk, Wv, Wo, seg_len):
        B, S, Dm = x.shape
        H, Dh = (Wq.shape[1], Wq.shape[2])
        M = mem0.shape[1]
        scale = Dh ** (-0.5)
        n_seg = S // seg_len
        L = M + seg_len
        idx = torch.arange(L)
        mask = (idx[:, None] < M) | (idx[:, None] >= idx[None, :])
        mem = mem0
        outs = []
        for s in range(n_seg):
            xs = x[:, s * seg_len:(s + 1) * seg_len, :].clone()
            h = torch.concatenate([mem, xs], axis=1)
            q = torch.einsum('btd,dhe->bhte', h, Wq)
            k = torch.einsum('btd,dhe->bhte', h, Wk)
            v = torch.einsum('btd,dhe->bhte', h, Wv)
            scores = torch.einsum('bhqe,bhke->bhqk', q, k) * scale
            scores = torch.where(mask[None, None], scores, -1000000000.0)
            p = _softmax(scores, axis=-1)
            o = torch.einsum('bhqk,bhke->bhqe', p, v)
            o = torch.einsum('bhte,hed->btd', o, Wo)
            mem = o[:, :M, :].clone()
            outs.append(o[:, M:, :])
        return torch.concatenate(outs, axis=1)
    a = _A_ref(A_x, A_w_r, A_w_i)
    b = _B_ref(B_x, B_mem0, B_Wq, B_Wk, B_Wv, B_Wo, B_seg_len)
    return torch.concatenate([a, b], axis=-1)
```

```asm
; @launch kernel=fused_kernel grid=(256,1,1) block=(256,1,1) lds=163840
.amdgcn_target "amdgcn-amd-amdhsa--gfx950"
.text
.globl fused_kernel
.p2align 8
.type fused_kernel,@function
fused_kernel:
    s_getpc_b64 s[60:61]
M_pc:
    v_lshlrev_b32 v254, 7, v0
    v_min_u32 v255, M_codeend - M_pc - 4, v254
    global_load_dword v253, v255, s[60:61]
    v_add_u32 v254, 32768, v254
    v_min_u32 v255, M_codeend - M_pc - 4, v254
    global_load_dword v253, v255, s[60:61]
    s_cmp_ge_u32 s2, 256
    s_cbranch_scc1 M_end
    s_load_dwordx2 s[8:9], s[0:1], 0
    s_load_dwordx2 s[12:13], s[0:1], 8
    s_load_dwordx2 s[16:17], s[0:1], 16
    s_load_dwordx2 s[20:21], s[0:1], 24
    s_load_dwordx2 s[24:25], s[0:1], 32
    s_load_dwordx2 s[28:29], s[0:1], 40
    s_load_dwordx2 s[32:33], s[0:1], 48
    s_load_dwordx2 s[36:37], s[0:1], 56
    s_load_dwordx2 s[40:41], s[0:1], 64
    s_load_dwordx2 s[44:45], s[0:1], 80
    s_load_dwordx2 s[48:49], s[0:1], 88
    s_load_dwordx2 s[52:53], s[0:1], 96
    v_lshrrev_b32 v2, 6, v0
    v_and_b32 v1, 63, v0
    v_readfirstlane_b32 s56, v2
    s_mov_b32 s10, 2359296
    s_mov_b32 s11, 0x20000
    s_mov_b32 s14, 1183744
    s_mov_b32 s15, 0x20000
    s_mov_b32 s18, 1183744
    s_mov_b32 s19, 0x20000
    s_mov_b32 s22, 2359296
    s_mov_b32 s23, 0x20000
    s_mov_b32 s26, 9216
    s_mov_b32 s27, 0x20000
    s_mov_b32 s30, 4718592
    s_mov_b32 s31, 0x20000
    s_mov_b32 s34, 4718592
    s_mov_b32 s35, 0x20000
    s_mov_b32 s38, 4718592
    s_mov_b32 s39, 0x20000
    s_mov_b32 s42, 4718592
    s_mov_b32 s43, 0x20000
    s_mov_b32 s46, 4718592
    s_mov_b32 s47, 0x20000
    s_mov_b32 s50, 256
    s_mov_b32 s51, 0x20000
    s_mov_b32 s54, 268435456
    s_mov_b32 s55, 0x20000
    s_waitcnt lgkmcnt(0)
    s_getreg_b32 s59, hwreg(HW_REG_XCC_ID)
    s_and_b32 s59, s59, 15
    s_bfe_u32 s60, s2, 0x50003
    s_xor_b32 s60, s60, 0
    s_lshl_b32 s58, s59, 5
    s_add_u32 s58, s58, s60
    v_mov_b32 v30, -1
    v_mov_b32 v31, 0
    s_cmp_lg_u32 s56, 0
    s_cbranch_scc1 RA_iss
    s_cmp_ge_u32 s59, 8
    s_cbranch_scc1 RA_iss
    s_lshl_b32 s61, 1, s60
    s_mov_b32 s62, 192
    s_cmp_eq_u32 s59, 1
    s_cselect_b32 s62, 0, s62
    s_cmp_eq_u32 s59, 2
    s_cselect_b32 s62, 128, s62
    s_cmp_eq_u32 s59, 3
    s_cselect_b32 s62, 160, s62
    s_cmp_eq_u32 s59, 4
    s_cselect_b32 s62, 96, s62
    s_cmp_eq_u32 s59, 5
    s_cselect_b32 s62, 4, s62
    s_cmp_eq_u32 s59, 6
    s_cselect_b32 s62, 132, s62
    s_cmp_eq_u32 s59, 7
    s_cselect_b32 s62, 164, s62
    v_mov_b32 v30, s61
    v_mov_b32 v31, s62
    s_mov_b64 exec, 1
    buffer_atomic_or v30, v31, s[48:51], 0 offen sc0 sc1
    s_mov_b64 exec, -1
RA_iss:
    s_mov_b32 s57, 0
    s_cmp_eq_u32 s59, 0
    s_cbranch_scc1 M_head
    s_cmp_lg_u32 s56, 0
    s_cbranch_scc1 RAa_bc
    s_and_b32 s60, s58, 31
    s_waitcnt vmcnt(0)
RAa_try:
    v_readfirstlane_b32 s61, v30
    s_bitcmp0_b32 s61, s60
    s_cbranch_scc1 RAa_got
    s_ff0_i32_b32 s60, s61
    s_cmp_lt_i32 s60, 0
    s_cbranch_scc1 RAa_ovf
    s_lshl_b32 s61, 1, s60
    v_mov_b32 v30, s61
    s_mov_b64 exec, 1
    buffer_atomic_or v30, v31, s[48:51], 0 offen sc0 sc1
    s_mov_b64 exec, -1
    s_waitcnt vmcnt(0)
    s_branch RAa_try
RAa_got:
    s_lshl_b32 s3, s59, 5
    s_add_u32 s3, s3, s60
    s_branch RAa_have
RAa_ovf:
    v_mov_b32 v28, 1
    v_mov_b32 v29, 80
    s_mov_b64 exec, 1
    buffer_atomic_add v28, v29, s[48:51], 0 offen sc0 sc1
    s_mov_b64 exec, -1
    s_waitcnt vmcnt(0)
    v_readfirstlane_b32 s61, v28
    v_lshlrev_b32 v29, 2, v1
    s_mov_b32 s63, 200000
RAa_poll:
    buffer_load_dword v28, v29, s[48:51], 0 offen sc1
    s_sub_u32 s63, s63, 1
    s_cbranch_scc1 M_abort
    s_waitcnt vmcnt(0)
    v_readlane_b32 s62, v28, 20
    v_readlane_b32 s60, v28, 48
    s_nop 1
    v_writelane_b32 v30, s60, 0
    s_bcnt1_i32_b32 s60, s60
    s_add_u32 s62, s62, s60
    v_readlane_b32 s60, v28, 0
    s_nop 1
    v_writelane_b32 v30, s60, 1
    s_bcnt1_i32_b32 s60, s60
    s_add_u32 s62, s62, s60
    v_readlane_b32 s60, v28, 32
    s_nop 1
    v_writelane_b32 v30, s60, 2
    s_bcnt1_i32_b32 s60, s60
    s_add_u32 s62, s62, s60
    v_readlane_b32 s60, v28, 40
    s_nop 1
    v_writelane_b32 v30, s60, 3
    s_bcnt1_i32_b32 s60, s60
    s_add_u32 s62, s62, s60
    v_readlane_b32 s60, v28, 24
    s_nop 1
    v_writelane_b32 v30, s60, 4
    s_bcnt1_i32_b32 s60, s60
    s_add_u32 s62, s62, s60
    v_readlane_b32 s60, v28, 1
    s_nop 1
    v_writelane_b32 v30, s60, 5
    s_bcnt1_i32_b32 s60, s60
    s_add_u32 s62, s62, s60
    v_readlane_b32 s60, v28, 33
    s_nop 1
    v_writelane_b32 v30, s60, 6
    s_bcnt1_i32_b32 s60, s60
    s_add_u32 s62, s62, s60
    v_readlane_b32 s60, v28, 41
    s_nop 1
    v_writelane_b32 v30, s60, 7
    s_bcnt1_i32_b32 s60, s60
    s_add_u32 s62, s62, s60
    s_cmp_lt_u32 s62, 256
    s_cbranch_scc1 RAa_poll
    s_mov_b32 s3, 0
RAa_scan:
    s_lshr_b32 s60, s3, 5
    s_nop 3
    v_readlane_b32 s62, v30, s60
    s_and_b32 s60, s3, 31
    s_bitcmp1_b32 s62, s60
    s_cbranch_scc1 RAa_nx
    s_cmp_eq_u32 s61, 0
    s_cbranch_scc1 RAa_fnd
    s_sub_u32 s61, s61, 1
RAa_nx:
    s_add_u32 s3, s3, 1
    s_cmp_lt_u32 s3, 255
    s_cbranch_scc1 RAa_scan
RAa_fnd:
    s_cmp_ge_u32 s3, 32
    s_cbranch_scc1 RAa_have
    v_mov_b32 v28, 1
    v_mov_b32 v29, 84
    s_mov_b64 exec, 1
    buffer_store_dword v28, v29, s[48:51], 0 offen sc1
    s_mov_b64 exec, -1
    s_waitcnt vmcnt(0)
RAa_have:
    v_mov_b32 v28, s3
    v_mov_b32 v29, 163836
    ds_write_b32 v29, v28
    s_waitcnt lgkmcnt(0)
RAa_bc:
    s_barrier
    v_mov_b32 v29, 163836
    ds_read_b32 v28, v29
    s_waitcnt lgkmcnt(0)
    v_readfirstlane_b32 s3, v28
    s_barrier
M_dispatch:
    s_mov_b32 s58, s3
    s_mov_b32 s57, 1
    s_cmp_ge_u32 s58, 32
    s_cbranch_scc1 M_worker
M_head:
    s_lshl_b32 s60, s58, 8
    s_lshr_b32 s61, s56, 1
    s_lshl_b32 s61, s61, 7
    s_add_u32 s60, s60, s61
    s_and_b32 s61, s56, 1
    s_lshl_b32 s61, s61, 18
    s_add_u32 s60, s60, s61
    s_mul_i32 s7, s56, 36864
    v_bfe_u32 v26, v1, 3, 3
    v_lshlrev_b32 v76, 13, v26
    v_bfe_u32 v26, v1, 0, 3
    v_lshl_add_u32 v76, v26, 4, v76
    v_add_u32 v76, s60, v76
    v_lshrrev_b32 v32, 4, v1
    s_lshl_b32 s60, s56, 4
    v_add_u32 v32, s60, v32
    v_mul_u32_u24 v32, 1152, v32
    s_mul_i32 s60, s58, 147456
    v_add_u32 v32, s60, v32
    v_bfe_u32 v26, v1, 0, 4
    v_lshlrev_b32 v77, 4, v26
    v_add_u32 v77, v32, v77
    s_add_u32 m0, s7, 32768
    s_mov_b32 s61, 0
    buffer_load_dwordx4 v76, s[32:35], s61 offen lds
    s_add_u32 m0, s7, 33792
    s_mov_b32 s61, 65536
    buffer_load_dwordx4 v76, s[32:35], s61 offen lds
    s_add_u32 m0, s7, 34816
    s_mov_b32 s61, 131072
    buffer_load_dwordx4 v76, s[32:35], s61 offen lds
    s_add_u32 m0, s7, 35840
    s_mov_b32 s61, 196608
    buffer_load_dwordx4 v76, s[32:35], s61 offen lds
    s_add_u32 m0, s7, 0
    s_mov_b32 s61, 0
    buffer_load_dwordx4 v77, s[40:43], s61 offen lds
    s_add_u32 m0, s7, 1024
    s_mov_b32 s61, 4608
    buffer_load_dwordx4 v77, s[40:43], s61 offen lds
    s_add_u32 m0, s7, 2048
    s_mov_b32 s61, 9216
    buffer_load_dwordx4 v77, s[40:43], s61 offen lds
    s_add_u32 m0, s7, 3072
    s_mov_b32 s61, 13824
    buffer_load_dwordx4 v77, s[40:43], s61 offen lds
    s_add_u32 m0, s7, 4096
    s_mov_b32 s61, 524288
    buffer_load_dwordx4 v76, s[32:35], s61 offen lds
    s_add_u32 m0, s7, 5120
    s_mov_b32 s61, 589824
    buffer_load_dwordx4 v76, s[32:35], s61 offen lds
    s_add_u32 m0, s7, 6144
    s_mov_b32 s61, 655360
    buffer_load_dwordx4 v76, s[32:35], s61 offen lds
    s_add_u32 m0, s7, 7168
    s_mov_b32 s61, 720896
    buffer_load_dwordx4 v76, s[32:35], s61 offen lds
    s_add_u32 m0, s7, 8192
    s_mov_b32 s61, 73728
    buffer_load_dwordx4 v77, s[40:43], s61 offen lds
    s_add_u32 m0, s7, 9216
    s_mov_b32 s61, 78336
    buffer_load_dwordx4 v77, s[40:43], s61 offen lds
    s_add_u32 m0, s7, 10240
    s_mov_b32 s61, 82944
    buffer_load_dwordx4 v77, s[40:43], s61 offen lds
    s_add_u32 m0, s7, 11264
    s_mov_b32 s61, 87552
    buffer_load_dwordx4 v77, s[40:43], s61 offen lds
    s_add_u32 m0, s7, 12288
    s_mov_b32 s61, 1048576
    buffer_load_dwordx4 v76, s[32:35], s61 offen lds
    s_add_u32 m0, s7, 13312
    s_mov_b32 s61, 1114112
    buffer_load_dwordx4 v76, s[32:35], s61 offen lds
    s_add_u32 m0, s7, 14336
    s_mov_b32 s61, 1179648
    buffer_load_dwordx4 v76, s[32:35], s61 offen lds
    s_add_u32 m0, s7, 15360
    s_mov_b32 s61, 1245184
    buffer_load_dwordx4 v76, s[32:35], s61 offen lds
    s_add_u32 m0, s7, 16384
    s_mov_b32 s61, 1572864
    buffer_load_dwordx4 v76, s[32:35], s61 offen lds
    s_add_u32 m0, s7, 17408
    s_mov_b32 s61, 1638400
    buffer_load_dwordx4 v76, s[32:35], s61 offen lds
    s_add_u32 m0, s7, 18432
    s_mov_b32 s61, 1703936
    buffer_load_dwordx4 v76, s[32:35], s61 offen lds
    s_add_u32 m0, s7, 19456
    s_mov_b32 s61, 1769472
    buffer_load_dwordx4 v76, s[32:35], s61 offen lds
    s_add_u32 m0, s7, 20480
    s_mov_b32 s61, 256
    buffer_load_dwordx4 v77, s[40:43], s61 offen lds
    s_add_u32 m0, s7, 21504
    s_mov_b32 s61, 4864
    buffer_load_dwordx4 v77, s[40:43], s61 offen lds
    s_add_u32 m0, s7, 22528
    s_mov_b32 s61, 9472
    buffer_load_dwordx4 v77, s[40:43], s61 offen lds
    s_add_u32 m0, s7, 23552
    s_mov_b32 s61, 14080
    buffer_load_dwordx4 v77, s[40:43], s61 offen lds
    s_add_u32 m0, s7, 24576
    s_mov_b32 s61, 2097152
    buffer_load_dwordx4 v76, s[32:35], s61 offen lds
    s_add_u32 m0, s7, 25600
    s_mov_b32 s61, 2162688
    buffer_load_dwordx4 v76, s[32:35], s61 offen lds
    s_add_u32 m0, s7, 26624
    s_mov_b32 s61, 2228224
    buffer_load_dwordx4 v76, s[32:35], s61 offen lds
    s_add_u32 m0, s7, 27648
    s_mov_b32 s61, 2293760
    buffer_load_dwordx4 v76, s[32:35], s61 offen lds
    s_add_u32 m0, s7, 28672
    s_mov_b32 s61, 2621440
    buffer_load_dwordx4 v76, s[32:35], s61 offen lds
    s_add_u32 m0, s7, 29696
    s_mov_b32 s61, 2686976
    buffer_load_dwordx4 v76, s[32:35], s61 offen lds
    s_add_u32 m0, s7, 30720
    s_mov_b32 s61, 2752512
    buffer_load_dwordx4 v76, s[32:35], s61 offen lds
    s_add_u32 m0, s7, 31744
    s_mov_b32 s61, 2818048
    buffer_load_dwordx4 v76, s[32:35], s61 offen lds
    s_cmp_eq_u32 s57, 1
    s_cbranch_scc1 M_resolved
    s_cmp_lg_u32 s56, 0
    s_cbranch_scc1 RAb_bc
    s_and_b32 s60, s58, 31
    s_waitcnt vmcnt(36)
RAb_try:
    v_readfirstlane_b32 s61, v30
    s_bitcmp0_b32 s61, s60
    s_cbranch_scc1 RAb_got
    s_ff0_i32_b32 s60, s61
    s_cmp_lt_i32 s60, 0
    s_cbranch_scc1 RAb_ovf
    s_lshl_b32 s61, 1, s60
    v_mov_b32 v30, s61
    s_mov_b64 exec, 1
    buffer_atomic_or v30, v31, s[48:51], 0 offen sc0 sc1
    s_mov_b64 exec, -1
    s_waitcnt vmcnt(0)
    s_branch RAb_try
RAb_got:
    s_lshl_b32 s3, s59, 5
    s_add_u32 s3, s3, s60
    s_branch RAb_have
RAb_ovf:
    v_mov_b32 v28, 1
    v_mov_b32 v29, 80
    s_mov_b64 exec, 1
    buffer_atomic_add v28, v29, s[48:51], 0 offen sc0 sc1
    s_mov_b64 exec, -1
    s_waitcnt vmcnt(0)
    v_readfirstlane_b32 s61, v28
    v_lshlrev_b32 v29, 2, v1
    s_mov_b32 s63, 200000
RAb_poll:
    buffer_load_dword v28, v29, s[48:51], 0 offen sc1
    s_sub_u32 s63, s63, 1
    s_cbranch_scc1 M_abort
    s_waitcnt vmcnt(0)
    v_readlane_b32 s62, v28, 20
    v_readlane_b32 s60, v28, 48
    s_nop 1
    v_writelane_b32 v30, s60, 0
    s_bcnt1_i32_b32 s60, s60
    s_add_u32 s62, s62, s60
    v_readlane_b32 s60, v28, 0
    s_nop 1
    v_writelane_b32 v30, s60, 1
    s_bcnt1_i32_b32 s60, s60
    s_add_u32 s62, s62, s60
    v_readlane_b32 s60, v28, 32
    s_nop 1
    v_writelane_b32 v30, s60, 2
    s_bcnt1_i32_b32 s60, s60
    s_add_u32 s62, s62, s60
    v_readlane_b32 s60, v28, 40
    s_nop 1
    v_writelane_b32 v30, s60, 3
    s_bcnt1_i32_b32 s60, s60
    s_add_u32 s62, s62, s60
    v_readlane_b32 s60, v28, 24
    s_nop 1
    v_writelane_b32 v30, s60, 4
    s_bcnt1_i32_b32 s60, s60
    s_add_u32 s62, s62, s60
    v_readlane_b32 s60, v28, 1
    s_nop 1
    v_writelane_b32 v30, s60, 5
    s_bcnt1_i32_b32 s60, s60
    s_add_u32 s62, s62, s60
    v_readlane_b32 s60, v28, 33
    s_nop 1
    v_writelane_b32 v30, s60, 6
    s_bcnt1_i32_b32 s60, s60
    s_add_u32 s62, s62, s60
    v_readlane_b32 s60, v28, 41
    s_nop 1
    v_writelane_b32 v30, s60, 7
    s_bcnt1_i32_b32 s60, s60
    s_add_u32 s62, s62, s60
    s_cmp_lt_u32 s62, 256
    s_cbranch_scc1 RAb_poll
    s_mov_b32 s3, 0
RAb_scan:
    s_lshr_b32 s60, s3, 5
    s_nop 3
    v_readlane_b32 s62, v30, s60
    s_and_b32 s60, s3, 31
    s_bitcmp1_b32 s62, s60
    s_cbranch_scc1 RAb_nx
    s_cmp_eq_u32 s61, 0
    s_cbranch_scc1 RAb_fnd
    s_sub_u32 s61, s61, 1
RAb_nx:
    s_add_u32 s3, s3, 1
    s_cmp_lt_u32 s3, 255
    s_cbranch_scc1 RAb_scan
RAb_fnd:
    s_cmp_ge_u32 s3, 32
    s_cbranch_scc1 RAb_have
    v_mov_b32 v28, 1
    v_mov_b32 v29, 84
    s_mov_b64 exec, 1
    buffer_store_dword v28, v29, s[48:51], 0 offen sc1
    s_mov_b64 exec, -1
    s_waitcnt vmcnt(0)
RAb_have:
    v_mov_b32 v28, s3
    v_mov_b32 v29, 163836
    ds_write_b32 v29, v28
    s_waitcnt lgkmcnt(0)
RAb_bc:
    s_barrier
    v_mov_b32 v29, 163836
    ds_read_b32 v28, v29
    s_waitcnt lgkmcnt(0)
    v_readfirstlane_b32 s3, v28
    s_barrier
    s_cmp_eq_u32 s3, s58
    s_cbranch_scc1 M_resolved
    s_waitcnt vmcnt(0)
    s_barrier
    s_branch M_dispatch
M_resolved:
    s_mov_b32 s72, -1
    s_mov_b32 s73, 0
    s_mov_b32 s74, 0
    s_mov_b32 s75, -1
    s_mov_b32 s76, 0x0f0f0f0f
    s_mov_b32 s77, 0x0f0f0f0f
    s_mov_b32 s78, 0xff00ff00
    s_mov_b32 s79, 0xff00ff00
    s_mov_b32 s82, 1040356334
    s_mov_b32 s83, 1040356334
    s_lshl_b32 s85, s56, 10
    s_lshl_b32 s4, s58, 7
    s_add_u32 s4, s4, 86589440
    s_sub_u32 s66, 8192, s85
    s_mov_b32 s57, 153600
    s_mov_b32 s59, 85983232
    s_mov_b32 s81, 0x40000000
    s_cmp_eq_u32 s56, 0
    s_cselect_b32 s60, s81, s59
    s_cselect_b32 s81, s59, s81
    s_mov_b32 s59, s60
    s_mov_b32 s86, 5570645
    s_mov_b32 s87, 5570645
    s_mov_b32 s88, 1426085120
    s_mov_b32 s89, 1426085120
    s_mov_b32 s90, 11141290
    s_mov_b32 s91, 11141290
    s_mov_b32 s92, 2852170240
    s_mov_b32 s93, 2852170240
    v_mov_b32 v2, 0x44444444
    v_mov_b32 v24, 0xeeeeeeee
    v_cndmask_b32 v2, v2, v24, s[78:79]
    v_mov_b32 v3, 0x3f800000
    v_mov_b32 v24, 0x3f80
    v_cndmask_b32 v3, v3, v24, s[76:77]
    s_mov_b32 s76, -1
    s_mov_b32 s77, -1
    v_lshlrev_b32 v24, 4, v1
    s_add_u32 s60, s85, 98304
    v_add_u32 v7, s60, v24
    s_mul_i32 s60, s56, 36864
    v_add_u32 v9, s60, v24
    s_lshl_b32 s60, s56, 5
    s_add_u32 s60, s60, s58
    s_lshl_b32 s61, s60, 12
    s_cmp_lt_u32 s60, 72
    s_cselect_b32 s70, 1, 0
    s_cselect_b32 s61, s61, 0x40000000
    v_add_u32 v5, s61, v24
    s_lshr_b32 s61, s60, 1
    s_lshl_b32 s95, s61, 5
    s_lshl_b32 s61, s61, 8
    s_and_b32 s62, s60, 1
    s_mul_i32 s94, s62, 4608
    s_add_u32 s95, s95, s94
    s_lshl_b32 s62, s62, 6
    s_add_u32 s61, s61, s62
    s_lshr_b32 s62, s60, 4
    s_mov_b32 s84, 1
    s_cmp_eq_u32 s62, 1
    s_cselect_b32 s84, 2, s84
    s_cmp_eq_u32 s62, 2
    s_cselect_b32 s84, 3, s84
    s_cmp_eq_u32 s62, 3
    s_cselect_b32 s84, 4, s84
    s_cmp_eq_u32 s62, 4
    s_cselect_b32 s84, 4, s84
    v_bfe_u32 v26, v1, 2, 1
    v_lshlrev_b32 v6, 7, v26
    v_bfe_u32 v26, v1, 4, 2
    v_lshl_add_u32 v6, v26, 4, v6
    v_bfe_u32 v26, v1, 0, 2
    v_lshl_add_u32 v6, v26, 2, v6
    v_add_u32 v6, s61, v6
    s_lshl_b32 s61, s56, 1
    s_xor_b32 s62, s58, s61
    s_lshl_b32 s62, s62, 7
    s_lshl_b32 s61, s56, 13
    v_bfe_u32 v26, v1, 5, 1
    v_lshlrev_b32 v4, 10, v26
    v_bfe_u32 v26, v1, 4, 1
    v_lshl_add_u32 v4, v26, 7, v4
    v_xor_b32 v25, s62, v4
    v_add_u32 v25, s61, v25
    v_bfe_u32 v26, v1, 5, 1
    v_lshlrev_b32 v4, 15, v26
    v_bfe_u32 v26, v1, 4, 1
    v_lshl_add_u32 v4, v26, 12, v4
    v_bfe_u32 v26, v1, 0, 4
    v_lshl_add_u32 v4, v26, 3, v4
    v_add_u32 v4, v25, v4
    s_lshl_b32 s61, s56, 9
    s_add_u32 s62, s61, 34816
    v_bfe_u32 v26, v1, 5, 1
    v_lshlrev_b32 v10, 8, v26
    v_bfe_u32 v26, v1, 0, 4
    v_lshl_add_u32 v10, v26, 4, v10
    v_bfe_u32 v26, v1, 4, 1
    v_lshl_add_u32 v10, v26, 3, v10
    v_add_u32 v10, s62, v10
    v_bfe_u32 v26, v1, 5, 1
    v_lshlrev_b32 v11, 8, v26
    v_bfe_u32 v26, v1, 4, 1
    v_lshl_add_u32 v11, v26, 6, v11
    v_bfe_u32 v26, v1, 2, 2
    v_lshl_add_u32 v11, v26, 4, v11
    v_bfe_u32 v26, v1, 0, 1
    v_lshl_add_u32 v11, v26, 3, v11
    v_add_u32 v11, 34816, v11
    v_bfe_u32 v26, v1, 4, 2
    v_lshlrev_b32 v12, 9, v26
    v_bfe_u32 v26, v1, 3, 1
    v_lshl_add_u32 v12, v26, 8, v12
    v_bfe_u32 v26, v1, 0, 3
    v_lshl_add_u32 v12, v26, 4, v12
    v_add_u32 v12, 98304, v12
    v_bfe_u32 v26, v1, 4, 2
    v_lshlrev_b32 v8, 7, v26
    v_bfe_u32 v26, v1, 0, 3
    v_lshl_add_u32 v8, v26, 4, v8
    v_add_u32 v8, 98304, v8
    s_add_u32 s62, s61, 108544
    v_bfe_u32 v26, v1, 5, 1
    v_lshlrev_b32 v13, 7, v26
    v_bfe_u32 v26, v1, 0, 3
    v_lshl_add_u32 v13, v26, 4, v13
    v_bfe_u32 v26, v1, 4, 1
    v_lshl_add_u32 v13, v26, 3, v13
    v_add_u32 v13, s62, v13
    s_lshl_b32 s61, s56, 11
    v_bfe_u32 v26, v1, 4, 2
    v_lshlrev_b32 v14, 9, v26
    v_bfe_u32 v26, v1, 0, 4
    v_lshl_add_u32 v14, v26, 4, v14
    v_add_u32 v14, s61, v14
    v_mov_b32 v28, -1
    v_mov_b32 v29, -1
    v_mov_b32 v30, -1
    v_mov_b32 v31, -1
    s_cmp_eq_u32 s70, 0
    s_cbranch_scc1 R_noarm
    v_bfe_u32 v26, v1, 4, 2
    v_lshlrev_b32 v33, 0, v26
    v_mul_u32_u24 v33, 1152, v33
    v_bfe_u32 v26, v1, 0, 3
    v_lshlrev_b32 v32, 2, v26
    v_add_u32 v32, v33, v32
    buffer_load_dword v15, v32, s[24:27], s95 offen
    s_mov_b32 s60, 85983232
    buffer_store_dwordx4 v[28:31], v5, s[52:55], s60 offen offset:0 sc1
    buffer_store_dwordx4 v[28:31], v5, s[52:55], s60 offen offset:1024 sc1
    buffer_store_dwordx4 v[28:31], v5, s[52:55], s60 offen offset:2048 sc1
    buffer_store_dwordx4 v[28:31], v5, s[52:55], s60 offen offset:3072 sc1
    s_mov_b64 exec, s[76:77]
    s_mov_b32 s60, 86507520
    buffer_store_dword v28, v6, s[52:55], s60 offen sc1
    s_mov_b32 s60, 86516736
    buffer_store_dword v28, v6, s[52:55], s60 offen sc1
    s_mov_b32 s60, 86525952
    buffer_store_dword v28, v6, s[52:55], s60 offen sc1
    s_mov_b64 exec, -1
R_noarm:
    s_cmp_lg_u32 s56, 3
    s_cbranch_scc1 R_nz
    v_lshlrev_b32 v32, 2, v1
    v_mov_b32 v33, 0
    s_lshl_b32 s60, s58, 8
    s_add_u32 s60, s60, 86573056
    buffer_store_dword v33, v32, s[52:55], s60 offen sc1
    v_lshlrev_b32 v32, 12, v1
    s_lshl_b32 s60, s58, 7
    s_add_u32 s60, s60, 86638592
    buffer_store_dword v33, v32, s[52:55], s60 offen sc1
    v_mov_b32 v32, s4
    buffer_store_dword v33, v32, s[52:55], 0 offen sc1
R_nz:
    s_and_b32 s60, s56, 2
    s_mul_i32 s60, s60, 36864
    s_and_b32 s61, s56, 1
    s_lshl_b32 s61, s61, 6
    s_add_u32 s60, s60, s61
    s_lshl_b32 s61, s56, 5
    v_bfe_u32 v26, v1, 4, 2
    v_lshlrev_b32 v68, 9, v26
    v_bfe_u32 v26, v1, 2, 1
    v_lshl_add_u32 v68, v26, 7, v68
    v_bfe_u32 v26, v1, 3, 1
    v_lshl_add_u32 v68, v26, 5, v68
    v_bfe_u32 v26, v1, 0, 2
    v_lshl_add_u32 v68, v26, 3, v68
    v_add_u32 v68, s60, v68
    v_add_u32 v69, 36864, v68
    v_bfe_u32 v26, v1, 4, 2
    v_lshlrev_b32 v70, 10, v26
    v_bfe_u32 v26, v1, 2, 1
    v_lshl_add_u32 v70, v26, 8, v70
    v_bfe_u32 v26, v1, 3, 1
    v_lshl_add_u32 v70, v26, 7, v70
    v_bfe_u32 v26, v1, 0, 2
    v_lshl_add_u32 v70, v26, 3, v70
    v_add_u32 v70, s61, v70
    v_bfe_u32 v26, v1, 4, 1
    v_lshlrev_b32 v52, 11, v26
    v_bfe_u32 v26, v1, 2, 2
    v_lshl_add_u32 v52, v26, 8, v52
    v_bfe_u32 v26, v1, 0, 2
    v_lshl_add_u32 v52, v26, 3, v52
    v_add_u32 v52, s61, v52
    v_bfe_u32 v26, v1, 5, 1
    v_mul_u32_u24 v26, 36864, v26
    v_add_u32 v52, v52, v26
    v_add_u32 v71, 36864, v70
    v_add_u32 v72, 73728, v70
    v_add_u32 v73, 110592, v70
    v_add_u32 v53, 73728, v52
    s_waitcnt vmcnt(32)
    s_waitcnt lgkmcnt(0)
    s_barrier
    ds_read_b64_tr_b16 a[144:145], v68 offset:32768
    ds_read_b64_tr_b16 a[146:147], v68 offset:33024
    ds_read_b64_tr_b16 a[148:149], v68 offset:34816
    ds_read_b64_tr_b16 a[150:151], v68 offset:35072
    ds_read_b64_tr_b16 a[152:153], v69 offset:32768
    ds_read_b64_tr_b16 a[154:155], v69 offset:33024
    ds_read_b64_tr_b16 a[156:157], v69 offset:34816
    ds_read_b64_tr_b16 a[158:159], v69 offset:35072
    s_waitcnt lgkmcnt(0)
    s_barrier
    s_add_u32 m0, s7, 32768
    s_mov_b32 s61, 73984
    buffer_load_dwordx4 v77, s[40:43], s61 offen lds
    s_add_u32 m0, s7, 33792
    s_mov_b32 s61, 78592
    buffer_load_dwordx4 v77, s[40:43], s61 offen lds
    s_add_u32 m0, s7, 34816
    s_mov_b32 s61, 83200
    buffer_load_dwordx4 v77, s[40:43], s61 offen lds
    s_add_u32 m0, s7, 35840
    s_mov_b32 s61, 87808
    buffer_load_dwordx4 v77, s[40:43], s61 offen lds
    s_waitcnt vmcnt(32)
    s_waitcnt lgkmcnt(0)
    s_barrier
    ds_read_b64_tr_b16 v[112:113], v70 offset:0
    ds_read_b64_tr_b16 v[114:115], v70 offset:512
    ds_read_b64_tr_b16 v[116:117], v71 offset:0
    ds_read_b64_tr_b16 v[118:119], v71 offset:512
    ds_read_b64_tr_b16 v[120:121], v72 offset:0
    ds_read_b64_tr_b16 v[122:123], v72 offset:512
    ds_read_b64_tr_b16 v[124:125], v73 offset:0
    ds_read_b64_tr_b16 v[126:127], v73 offset:512
    s_waitcnt lgkmcnt(0)
    s_barrier
    s_add_u32 m0, s7, 0
    s_mov_b32 s61, 3145728
    buffer_load_dwordx4 v76, s[32:35], s61 offen lds
    s_add_u32 m0, s7, 1024
    s_mov_b32 s61, 3211264
    buffer_load_dwordx4 v76, s[32:35], s61 offen lds
    s_add_u32 m0, s7, 2048
    s_mov_b32 s61, 3276800
    buffer_load_dwordx4 v76, s[32:35], s61 offen lds
    s_add_u32 m0, s7, 3072
    s_mov_b32 s61, 3342336
    buffer_load_dwordx4 v76, s[32:35], s61 offen lds
    s_waitcnt vmcnt(32)
    s_waitcnt lgkmcnt(0)
    s_barrier
    ds_read_b64_tr_b16 a[160:161], v68 offset:4096
    ds_read_b64_tr_b16 a[162:163], v68 offset:4352
    ds_read_b64_tr_b16 a[164:165], v68 offset:6144
    ds_read_b64_tr_b16 a[166:167], v68 offset:6400
    ds_read_b64_tr_b16 a[168:169], v69 offset:4096
    ds_read_b64_tr_b16 a[170:171], v69 offset:4352
    ds_read_b64_tr_b16 a[172:173], v69 offset:6144
    ds_read_b64_tr_b16 a[174:175], v69 offset:6400
    s_waitcnt lgkmcnt(0)
    s_barrier
    s_add_u32 m0, s7, 4096
    s_mov_b32 s61, 3670016
    buffer_load_dwordx4 v76, s[32:35], s61 offen lds
    s_add_u32 m0, s7, 5120
    s_mov_b32 s61, 3735552
    buffer_load_dwordx4 v76, s[32:35], s61 offen lds
    s_add_u32 m0, s7, 6144
    s_mov_b32 s61, 3801088
    buffer_load_dwordx4 v76, s[32:35], s61 offen lds
    s_add_u32 m0, s7, 7168
    s_mov_b32 s61, 3866624
    buffer_load_dwordx4 v76, s[32:35], s61 offen lds
    s_waitcnt vmcnt(32)
    s_waitcnt lgkmcnt(0)
    s_barrier
    ds_read_b64_tr_b16 v[128:129], v70 offset:8192
    ds_read_b64_tr_b16 v[130:131], v70 offset:8704
    ds_read_b64_tr_b16 v[132:133], v71 offset:8192
    ds_read_b64_tr_b16 v[134:135], v71 offset:8704
    ds_read_b64_tr_b16 v[136:137], v72 offset:8192
    ds_read_b64_tr_b16 v[138:139], v72 offset:8704
    ds_read_b64_tr_b16 v[140:141], v73 offset:8192
    ds_read_b64_tr_b16 v[142:143], v73 offset:8704
    s_waitcnt lgkmcnt(0)
    s_barrier
    s_add_u32 m0, s7, 8192
    s_mov_b32 s61, 512
    buffer_load_dwordx4 v77, s[40:43], s61 offen lds
    s_add_u32 m0, s7, 9216
    s_mov_b32 s61, 5120
    buffer_load_dwordx4 v77, s[40:43], s61 offen lds
    s_add_u32 m0, s7, 10240
    s_mov_b32 s61, 9728
    buffer_load_dwordx4 v77, s[40:43], s61 offen lds
    s_add_u32 m0, s7, 11264
    s_mov_b32 s61, 14336
    buffer_load_dwordx4 v77, s[40:43], s61 offen lds
    s_waitcnt vmcnt(32)
    s_waitcnt lgkmcnt(0)
    s_barrier
    ds_read_b64_tr_b16 a[176:177], v68 offset:12288
    ds_read_b64_tr_b16 a[178:179], v68 offset:12544
    ds_read_b64_tr_b16 a[180:181], v68 offset:14336
    ds_read_b64_tr_b16 a[182:183], v68 offset:14592
    ds_read_b64_tr_b16 a[184:185], v69 offset:12288
    ds_read_b64_tr_b16 a[186:187], v69 offset:12544
    ds_read_b64_tr_b16 a[188:189], v69 offset:14336
    ds_read_b64_tr_b16 a[190:191], v69 offset:14592
    s_waitcnt lgkmcnt(0)
    s_barrier
    s_add_u32 m0, s7, 12288
    s_mov_b32 s61, 4194304
    buffer_load_dwordx4 v76, s[32:35], s61 offen lds
    s_add_u32 m0, s7, 13312
    s_mov_b32 s61, 4259840
    buffer_load_dwordx4 v76, s[32:35], s61 offen lds
    s_add_u32 m0, s7, 14336
    s_mov_b32 s61, 4325376
    buffer_load_dwordx4 v76, s[32:35], s61 offen lds
    s_add_u32 m0, s7, 15360
    s_mov_b32 s61, 4390912
    buffer_load_dwordx4 v76, s[32:35], s61 offen lds
    s_waitcnt vmcnt(32)
    s_waitcnt lgkmcnt(0)
    s_barrier
    ds_read_b64_tr_b16 a[192:193], v68 offset:16384
    ds_read_b64_tr_b16 a[194:195], v68 offset:16640
    ds_read_b64_tr_b16 a[196:197], v68 offset:18432
    ds_read_b64_tr_b16 a[198:199], v68 offset:18688
    ds_read_b64_tr_b16 a[200:201], v69 offset:16384
    ds_read_b64_tr_b16 a[202:203], v69 offset:16640
    ds_read_b64_tr_b16 a[204:205], v69 offset:18432
    ds_read_b64_tr_b16 a[206:207], v69 offset:18688
    s_waitcnt lgkmcnt(0)
    s_barrier
    s_add_u32 m0, s7, 16384
    s_mov_b32 s61, 74240
    buffer_load_dwordx4 v77, s[40:43], s61 offen lds
    s_add_u32 m0, s7, 17408
    s_mov_b32 s61, 78848
    buffer_load_dwordx4 v77, s[40:43], s61 offen lds
    s_add_u32 m0, s7, 18432
    s_mov_b32 s61, 83456
    buffer_load_dwordx4 v77, s[40:43], s61 offen lds
    s_add_u32 m0, s7, 19456
    s_mov_b32 s61, 88064
    buffer_load_dwordx4 v77, s[40:43], s61 offen lds
    s_waitcnt vmcnt(32)
    s_waitcnt lgkmcnt(0)
    s_barrier
    ds_read_b64_tr_b16 v[144:145], v70 offset:20480
    ds_read_b64_tr_b16 v[146:147], v70 offset:20992
    ds_read_b64_tr_b16 v[148:149], v71 offset:20480
    ds_read_b64_tr_b16 v[150:151], v71 offset:20992
    ds_read_b64_tr_b16 v[152:153], v72 offset:20480
    ds_read_b64_tr_b16 v[154:155], v72 offset:20992
    ds_read_b64_tr_b16 v[156:157], v73 offset:20480
    ds_read_b64_tr_b16 v[158:159], v73 offset:20992
    s_waitcnt lgkmcnt(0)
    s_barrier
    s_add_u32 m0, s7, 20480
    s_mov_b32 s61, 0
    buffer_load_dwordx4 v76, s[28:31], s61 offen lds
    s_add_u32 m0, s7, 21504
    s_mov_b32 s61, 65536
    buffer_load_dwordx4 v76, s[28:31], s61 offen lds
    s_add_u32 m0, s7, 22528
    s_mov_b32 s61, 131072
    buffer_load_dwordx4 v76, s[28:31], s61 offen lds
    s_add_u32 m0, s7, 23552
    s_mov_b32 s61, 196608
    buffer_load_dwordx4 v76, s[28:31], s61 offen lds
    s_waitcnt vmcnt(32)
    s_waitcnt lgkmcnt(0)
    s_barrier
    ds_read_b64_tr_b16 a[208:209], v68 offset:24576
    ds_read_b64_tr_b16 a[210:211], v68 offset:24832
    ds_read_b64_tr_b16 a[212:213], v68 offset:26624
    ds_read_b64_tr_b16 a[214:215], v68 offset:26880
    ds_read_b64_tr_b16 a[216:217], v69 offset:24576
    ds_read_b64_tr_b16 a[218:219], v69 offset:24832
    ds_read_b64_tr_b16 a[220:221], v69 offset:26624
    ds_read_b64_tr_b16 a[222:223], v69 offset:26880
    s_waitcnt lgkmcnt(0)
    s_barrier
    s_add_u32 m0, s7, 24576
    s_mov_b32 s61, 524288
    buffer_load_dwordx4 v76, s[28:31], s61 offen lds
    s_add_u32 m0, s7, 25600
    s_mov_b32 s61, 589824
    buffer_load_dwordx4 v76, s[28:31], s61 offen lds
    s_add_u32 m0, s7, 26624
    s_mov_b32 s61, 655360
    buffer_load_dwordx4 v76, s[28:31], s61 offen lds
    s_add_u32 m0, s7, 27648
    s_mov_b32 s61, 720896
    buffer_load_dwordx4 v76, s[28:31], s61 offen lds
    s_waitcnt vmcnt(32)
    s_waitcnt lgkmcnt(0)
    s_barrier
    ds_read_b64_tr_b16 a[224:225], v68 offset:28672
    ds_read_b64_tr_b16 a[226:227], v68 offset:28928
    ds_read_b64_tr_b16 a[228:229], v68 offset:30720
    ds_read_b64_tr_b16 a[230:231], v68 offset:30976
    ds_read_b64_tr_b16 a[232:233], v69 offset:28672
    ds_read_b64_tr_b16 a[234:235], v69 offset:28928
    ds_read_b64_tr_b16 a[236:237], v69 offset:30720
    ds_read_b64_tr_b16 a[238:239], v69 offset:30976
    s_waitcnt lgkmcnt(0)
    s_barrier
    s_add_u32 m0, s7, 28672
    s_mov_b32 s61, 768
    buffer_load_dwordx4 v77, s[40:43], s61 offen lds
    s_add_u32 m0, s7, 29696
    s_mov_b32 s61, 5376
    buffer_load_dwordx4 v77, s[40:43], s61 offen lds
    s_add_u32 m0, s7, 30720
    s_mov_b32 s61, 9984
    buffer_load_dwordx4 v77, s[40:43], s61 offen lds
    s_add_u32 m0, s7, 31744
    s_mov_b32 s61, 14592
    buffer_load_dwordx4 v77, s[40:43], s61 offen lds
    s_waitcnt vmcnt(32)
    s_waitcnt lgkmcnt(0)
    s_barrier
    ds_read_b64_tr_b16 v[160:161], v70 offset:32768
    ds_read_b64_tr_b16 v[162:163], v70 offset:33280
    ds_read_b64_tr_b16 v[164:165], v71 offset:32768
    ds_read_b64_tr_b16 v[166:167], v71 offset:33280
    ds_read_b64_tr_b16 v[168:169], v72 offset:32768
    ds_read_b64_tr_b16 v[170:171], v72 offset:33280
    ds_read_b64_tr_b16 v[172:173], v73 offset:32768
    ds_read_b64_tr_b16 v[174:175], v73 offset:33280
    s_waitcnt lgkmcnt(0)
    s_barrier
    s_cmp_lg_u32 s56, 0
    s_cbranch_scc1 R_armed
    v_mov_b32 v24, 1
    v_mov_b32 v25, 40
    s_mov_b64 exec, 1
    buffer_atomic_add v24, v25, s[48:51], 0 offen sc1
    s_mov_b64 exec, -1
R_armed:
    s_cmp_eq_u32 s70, 0
    s_cbranch_scc1 R_nom0
    v_min_u32 v15, -2, v15
    s_mov_b32 s60, 86507520
    s_mov_b64 exec, s[76:77]
    buffer_store_dword v15, v6, s[52:55], s60 offen sc1
    s_mov_b64 exec, -1
    s_nop 0
    v_mov_b32 v15, -1
R_nom0:
    s_add_u32 m0, s7, 32768
    s_mov_b32 s61, 1048576
    buffer_load_dwordx4 v76, s[28:31], s61 offen lds
    s_add_u32 m0, s7, 33792
    s_mov_b32 s61, 1114112
    buffer_load_dwordx4 v76, s[28:31], s61 offen lds
    s_add_u32 m0, s7, 34816
    s_mov_b32 s61, 1179648
    buffer_load_dwordx4 v76, s[28:31], s61 offen lds
    s_add_u32 m0, s7, 35840
    s_mov_b32 s61, 1245184
    buffer_load_dwordx4 v76, s[28:31], s61 offen lds
    s_waitcnt vmcnt(32)
    s_waitcnt lgkmcnt(0)
    s_barrier
    ds_read_b64_tr_b16 a[240:241], v68 offset:0
    ds_read_b64_tr_b16 a[242:243], v68 offset:256
    ds_read_b64_tr_b16 a[244:245], v68 offset:2048
    ds_read_b64_tr_b16 a[246:247], v68 offset:2304
    ds_read_b64_tr_b16 a[248:249], v69 offset:0
    ds_read_b64_tr_b16 a[250:251], v69 offset:256
    ds_read_b64_tr_b16 a[252:253], v69 offset:2048
    ds_read_b64_tr_b16 a[254:255], v69 offset:2304
    s_waitcnt lgkmcnt(0)
    s_barrier
    s_add_u32 m0, s7, 0
    s_mov_b32 s61, 1572864
    buffer_load_dwordx4 v76, s[28:31], s61 offen lds
    s_add_u32 m0, s7, 1024
    s_mov_b32 s61, 1638400
    buffer_load_dwordx4 v76, s[28:31], s61 offen lds
    s_add_u32 m0, s7, 2048
    s_mov_b32 s61, 1703936
    buffer_load_dwordx4 v76, s[28:31], s61 offen lds
    s_add_u32 m0, s7, 3072
    s_mov_b32 s61, 1769472
    buffer_load_dwordx4 v76, s[28:31], s61 offen lds
    s_waitcnt vmcnt(32)
    s_waitcnt lgkmcnt(0)
    s_barrier
    ds_read_b64_tr_b16 v[80:81], v68 offset:4096
    ds_read_b64_tr_b16 v[82:83], v68 offset:4352
    ds_read_b64_tr_b16 v[84:85], v68 offset:6144
    ds_read_b64_tr_b16 v[86:87], v68 offset:6400
    ds_read_b64_tr_b16 v[88:89], v69 offset:4096
    ds_read_b64_tr_b16 v[90:91], v69 offset:4352
    ds_read_b64_tr_b16 v[92:93], v69 offset:6144
    ds_read_b64_tr_b16 v[94:95], v69 offset:6400
    s_waitcnt lgkmcnt(0)
    s_barrier
    s_add_u32 m0, s7, 4096
    s_mov_b32 s61, 74496
    buffer_load_dwordx4 v77, s[40:43], s61 offen lds
    s_add_u32 m0, s7, 5120
    s_mov_b32 s61, 79104
    buffer_load_dwordx4 v77, s[40:43], s61 offen lds
    s_add_u32 m0, s7, 6144
    s_mov_b32 s61, 83712
    buffer_load_dwordx4 v77, s[40:43], s61 offen lds
    s_add_u32 m0, s7, 7168
    s_mov_b32 s61, 88320
    buffer_load_dwordx4 v77, s[40:43], s61 offen lds
    s_waitcnt vmcnt(32)
    s_waitcnt lgkmcnt(0)
    s_barrier
    ds_read_b64_tr_b16 v[176:177], v70 offset:8192
    ds_read_b64_tr_b16 v[178:179], v70 offset:8704
    ds_read_b64_tr_b16 v[180:181], v71 offset:8192
    ds_read_b64_tr_b16 v[182:183], v71 offset:8704
    ds_read_b64_tr_b16 v[184:185], v72 offset:8192
    ds_read_b64_tr_b16 v[186:187], v72 offset:8704
    ds_read_b64_tr_b16 v[188:189], v73 offset:8192
    ds_read_b64_tr_b16 v[190:191], v73 offset:8704
    s_waitcnt lgkmcnt(0)
    s_barrier
    s_add_u32 m0, s7, 8192
    s_mov_b32 s61, 2097152
    buffer_load_dwordx4 v76, s[28:31], s61 offen lds
    s_add_u32 m0, s7, 9216
    s_mov_b32 s61, 2162688
    buffer_load_dwordx4 v76, s[28:31], s61 offen lds
    s_add_u32 m0, s7, 10240
    s_mov_b32 s61, 2228224
    buffer_load_dwordx4 v76, s[28:31], s61 offen lds
    s_add_u32 m0, s7, 11264
    s_mov_b32 s61, 2293760
    buffer_load_dwordx4 v76, s[28:31], s61 offen lds
    s_waitcnt vmcnt(32)
    s_waitcnt lgkmcnt(0)
    s_barrier
    ds_read_b64_tr_b16 v[96:97], v68 offset:12288
    ds_read_b64_tr_b16 v[98:99], v68 offset:12544
    ds_read_b64_tr_b16 v[100:101], v68 offset:14336
    ds_read_b64_tr_b16 v[102:103], v68 offset:14592
    ds_read_b64_tr_b16 v[104:105], v69 offset:12288
    ds_read_b64_tr_b16 v[106:107], v69 offset:12544
    ds_read_b64_tr_b16 v[108:109], v69 offset:14336
    ds_read_b64_tr_b16 v[110:111], v69 offset:14592
    s_waitcnt lgkmcnt(0)
    s_barrier
    s_add_u32 m0, s7, 12288
    s_mov_b32 s61, 2621440
    buffer_load_dwordx4 v76, s[28:31], s61 offen lds
    s_add_u32 m0, s7, 13312
    s_mov_b32 s61, 2686976
    buffer_load_dwordx4 v76, s[28:31], s61 offen lds
    s_add_u32 m0, s7, 14336
    s_mov_b32 s61, 2752512
    buffer_load_dwordx4 v76, s[28:31], s61 offen lds
    s_add_u32 m0, s7, 15360
    s_mov_b32 s61, 2818048
    buffer_load_dwordx4 v76, s[28:31], s61 offen lds
    s_waitcnt vmcnt(32)
    s_waitcnt lgkmcnt(0)
    s_barrier
    ds_read_b64_tr_b16 v[192:193], v70 offset:16384
    ds_read_b64_tr_b16 v[194:195], v70 offset:16896
    ds_read_b64_tr_b16 v[196:197], v71 offset:16384
    ds_read_b64_tr_b16 v[198:199], v71 offset:16896
    ds_read_b64_tr_b16 v[200:201], v72 offset:16384
    ds_read_b64_tr_b16 v[202:203], v72 offset:16896
    ds_read_b64_tr_b16 v[204:205], v73 offset:16384
    ds_read_b64_tr_b16 v[206:207], v73 offset:16896
    s_waitcnt lgkmcnt(0)
    s_barrier
    s_add_u32 m0, s7, 16384
    s_mov_b32 s61, 1024
    buffer_load_dwordx4 v77, s[40:43], s61 offen lds
    s_add_u32 m0, s7, 17408
    s_mov_b32 s61, 5632
    buffer_load_dwordx4 v77, s[40:43], s61 offen lds
    s_add_u32 m0, s7, 18432
    s_mov_b32 s61, 10240
    buffer_load_dwordx4 v77, s[40:43], s61 offen lds
    s_add_u32 m0, s7, 19456
    s_mov_b32 s61, 14848
    buffer_load_dwordx4 v77, s[40:43], s61 offen lds
    s_waitcnt vmcnt(32)
    s_waitcnt lgkmcnt(0)
    s_barrier
    ds_read_b64_tr_b16 a[0:1], v68 offset:20480
    ds_read_b64_tr_b16 a[2:3], v68 offset:20736
    ds_read_b64_tr_b16 a[4:5], v68 offset:22528
    ds_read_b64_tr_b16 a[6:7], v68 offset:22784
    ds_read_b64_tr_b16 a[8:9], v69 offset:20480
    ds_read_b64_tr_b16 a[10:11], v69 offset:20736
    ds_read_b64_tr_b16 a[12:13], v69 offset:22528
    ds_read_b64_tr_b16 a[14:15], v69 offset:22784
    s_waitcnt lgkmcnt(0)
    s_barrier
    s_add_u32 m0, s7, 20480
    s_mov_b32 s61, 3145728
    buffer_load_dwordx4 v76, s[28:31], s61 offen lds
    s_add_u32 m0, s7, 21504
    s_mov_b32 s61, 3211264
    buffer_load_dwordx4 v76, s[28:31], s61 offen lds
    s_add_u32 m0, s7, 22528
    s_mov_b32 s61, 3276800
    buffer_load_dwordx4 v76, s[28:31], s61 offen lds
    s_add_u32 m0, s7, 23552
    s_mov_b32 s61, 3342336
    buffer_load_dwordx4 v76, s[28:31], s61 offen lds
    s_waitcnt vmcnt(32)
    s_waitcnt lgkmcnt(0)
    s_barrier
    ds_read_b64_tr_b16 a[16:17], v68 offset:24576
    ds_read_b64_tr_b16 a[18:19], v68 offset:24832
    ds_read_b64_tr_b16 a[20:21], v68 offset:26624
    ds_read_b64_tr_b16 a[22:23], v68 offset:26880
    ds_read_b64_tr_b16 a[24:25], v69 offset:24576
    ds_read_b64_tr_b16 a[26:27], v69 offset:24832
    ds_read_b64_tr_b16 a[28:29], v69 offset:26624
    ds_read_b64_tr_b16 a[30:31], v69 offset:26880
    s_waitcnt lgkmcnt(0)
    s_barrier
    s_add_u32 m0, s7, 24576
    s_mov_b32 s61, 3670016
    buffer_load_dwordx4 v76, s[28:31], s61 offen lds
    s_add_u32 m0, s7, 25600
    s_mov_b32 s61, 3735552
    buffer_load_dwordx4 v76, s[28:31], s61 offen lds
    s_add_u32 m0, s7, 26624
    s_mov_b32 s61, 3801088
    buffer_load_dwordx4 v76, s[28:31], s61 offen lds
    s_add_u32 m0, s7, 27648
    s_mov_b32 s61, 3866624
    buffer_load_dwordx4 v76, s[28:31], s61 offen lds
    s_waitcnt vmcnt(32)
    s_waitcnt lgkmcnt(0)
    s_barrier
    ds_read_b64_tr_b16 v[208:209], v70 offset:28672
    ds_read_b64_tr_b16 v[210:211], v70 offset:29184
    ds_read_b64_tr_b16 v[212:213], v71 offset:28672
    ds_read_b64_tr_b16 v[214:215], v71 offset:29184
    ds_read_b64_tr_b16 v[216:217], v72 offset:28672
    ds_read_b64_tr_b16 v[218:219], v72 offset:29184
    ds_read_b64_tr_b16 v[220:221], v73 offset:28672
    ds_read_b64_tr_b16 v[222:223], v73 offset:29184
    s_waitcnt lgkmcnt(0)
    s_barrier
    s_add_u32 m0, s7, 28672
    s_mov_b32 s61, 74752
    buffer_load_dwordx4 v77, s[40:43], s61 offen lds
    s_add_u32 m0, s7, 29696
    s_mov_b32 s61, 79360
    buffer_load_dwordx4 v77, s[40:43], s61 offen lds
    s_add_u32 m0, s7, 30720
    s_mov_b32 s61, 83968
    buffer_load_dwordx4 v77, s[40:43], s61 offen lds
    s_add_u32 m0, s7, 31744
    s_mov_b32 s61, 88576
    buffer_load_dwordx4 v77, s[40:43], s61 offen lds
    s_waitcnt vmcnt(32)
    s_waitcnt lgkmcnt(0)
    s_barrier
    ds_read_b64_tr_b16 a[32:33], v68 offset:32768
    ds_read_b64_tr_b16 a[34:35], v68 offset:33024
    ds_read_b64_tr_b16 a[36:37], v68 offset:34816
    ds_read_b64_tr_b16 a[38:39], v68 offset:35072
    ds_read_b64_tr_b16 a[40:41], v69 offset:32768
    ds_read_b64_tr_b16 a[42:43], v69 offset:33024
    ds_read_b64_tr_b16 a[44:45], v69 offset:34816
    ds_read_b64_tr_b16 a[46:47], v69 offset:35072
    s_waitcnt lgkmcnt(0)
    s_barrier
    s_add_u32 m0, s7, 32768
    s_mov_b32 s61, 4194304
    buffer_load_dwordx4 v76, s[28:31], s61 offen lds
    s_add_u32 m0, s7, 33792
    s_mov_b32 s61, 4259840
    buffer_load_dwordx4 v76, s[28:31], s61 offen lds
    s_add_u32 m0, s7, 34816
    s_mov_b32 s61, 4325376
    buffer_load_dwordx4 v76, s[28:31], s61 offen lds
    s_add_u32 m0, s7, 35840
    s_mov_b32 s61, 4390912
    buffer_load_dwordx4 v76, s[28:31], s61 offen lds
    s_waitcnt vmcnt(32)
    s_waitcnt lgkmcnt(0)
    s_barrier
    ds_read_b64_tr_b16 a[48:49], v68 offset:0
    ds_read_b64_tr_b16 a[50:51], v68 offset:256
    ds_read_b64_tr_b16 a[52:53], v68 offset:2048
    ds_read_b64_tr_b16 a[54:55], v68 offset:2304
    ds_read_b64_tr_b16 a[56:57], v69 offset:0
    ds_read_b64_tr_b16 a[58:59], v69 offset:256
    ds_read_b64_tr_b16 a[60:61], v69 offset:2048
    ds_read_b64_tr_b16 a[62:63], v69 offset:2304
    s_waitcnt lgkmcnt(0)
    s_barrier
    s_add_u32 m0, s7, 0
    s_mov_b32 s61, 0
    buffer_load_dwordx4 v76, s[36:39], s61 offen lds
    s_add_u32 m0, s7, 1024
    s_mov_b32 s61, 65536
    buffer_load_dwordx4 v76, s[36:39], s61 offen lds
    s_add_u32 m0, s7, 2048
    s_mov_b32 s61, 131072
    buffer_load_dwordx4 v76, s[36:39], s61 offen lds
    s_add_u32 m0, s7, 3072
    s_mov_b32 s61, 196608
    buffer_load_dwordx4 v76, s[36:39], s61 offen lds
    s_waitcnt vmcnt(32)
    s_waitcnt lgkmcnt(0)
    s_barrier
    ds_read_b64_tr_b16 v[224:225], v70 offset:4096
    ds_read_b64_tr_b16 v[226:227], v70 offset:4608
    ds_read_b64_tr_b16 v[228:229], v71 offset:4096
    ds_read_b64_tr_b16 v[230:231], v71 offset:4608
    ds_read_b64_tr_b16 v[232:233], v72 offset:4096
    ds_read_b64_tr_b16 v[234:235], v72 offset:4608
    ds_read_b64_tr_b16 v[236:237], v73 offset:4096
    ds_read_b64_tr_b16 v[238:239], v73 offset:4608
    s_waitcnt lgkmcnt(0)
    s_barrier
    s_add_u32 m0, s7, 4096
    s_mov_b32 s61, 524288
    buffer_load_dwordx4 v76, s[36:39], s61 offen lds
    s_add_u32 m0, s7, 5120
    s_mov_b32 s61, 589824
    buffer_load_dwordx4 v76, s[36:39], s61 offen lds
    s_add_u32 m0, s7, 6144
    s_mov_b32 s61, 655360
    buffer_load_dwordx4 v76, s[36:39], s61 offen lds
    s_add_u32 m0, s7, 7168
    s_mov_b32 s61, 720896
    buffer_load_dwordx4 v76, s[36:39], s61 offen lds
    s_waitcnt vmcnt(32)
    s_waitcnt lgkmcnt(0)
    s_barrier
    ds_read_b64_tr_b16 a[64:65], v68 offset:8192
    ds_read_b64_tr_b16 a[66:67], v68 offset:8448
    ds_read_b64_tr_b16 a[68:69], v68 offset:10240
    ds_read_b64_tr_b16 a[70:71], v68 offset:10496
    ds_read_b64_tr_b16 a[72:73], v69 offset:8192
    ds_read_b64_tr_b16 a[74:75], v69 offset:8448
    ds_read_b64_tr_b16 a[76:77], v69 offset:10240
    ds_read_b64_tr_b16 a[78:79], v69 offset:10496
    s_waitcnt lgkmcnt(0)
    s_barrier
    s_add_u32 m0, s7, 8192
    s_mov_b32 s61, 1048576
    buffer_load_dwordx4 v76, s[36:39], s61 offen lds
    s_add_u32 m0, s7, 9216
    s_mov_b32 s61, 1114112
    buffer_load_dwordx4 v76, s[36:39], s61 offen lds
    s_add_u32 m0, s7, 10240
    s_mov_b32 s61, 1179648
    buffer_load_dwordx4 v76, s[36:39], s61 offen lds
    s_add_u32 m0, s7, 11264
    s_mov_b32 s61, 1245184
    buffer_load_dwordx4 v76, s[36:39], s61 offen lds
    s_waitcnt vmcnt(32)
    s_waitcnt lgkmcnt(0)
    s_barrier
    ds_read_b64_tr_b16 a[80:81], v68 offset:12288
    ds_read_b64_tr_b16 a[82:83], v68 offset:12544
    ds_read_b64_tr_b16 a[84:85], v68 offset:14336
    ds_read_b64_tr_b16 a[86:87], v68 offset:14592
    ds_read_b64_tr_b16 a[88:89], v69 offset:12288
    ds_read_b64_tr_b16 a[90:91], v69 offset:12544
    ds_read_b64_tr_b16 a[92:93], v69 offset:14336
    ds_read_b64_tr_b16 a[94:95], v69 offset:14592
    s_waitcnt lgkmcnt(0)
    s_barrier
    s_add_u32 m0, s7, 12288
    s_mov_b32 s61, 1572864
    buffer_load_dwordx4 v76, s[36:39], s61 offen lds
    s_add_u32 m0, s7, 13312
    s_mov_b32 s61, 1638400
    buffer_load_dwordx4 v76, s[36:39], s61 offen lds
    s_add_u32 m0, s7, 14336
    s_mov_b32 s61, 1703936
    buffer_load_dwordx4 v76, s[36:39], s61 offen lds
    s_add_u32 m0, s7, 15360
    s_mov_b32 s61, 1769472
    buffer_load_dwordx4 v76, s[36:39], s61 offen lds
    s_waitcnt vmcnt(32)
    s_waitcnt lgkmcnt(0)
    s_barrier
    ds_read_b64_tr_b16 v[240:241], v52 offset:16384
    ds_read_b64_tr_b16 v[242:243], v52 offset:17408
    ds_read_b64_tr_b16 v[244:245], v53 offset:16384
    ds_read_b64_tr_b16 v[246:247], v53 offset:17408
    s_waitcnt lgkmcnt(0)
    s_barrier
    s_add_u32 m0, s7, 16384
    s_mov_b32 s61, 2097152
    buffer_load_dwordx4 v76, s[36:39], s61 offen lds
    s_add_u32 m0, s7, 17408
    s_mov_b32 s61, 2162688
    buffer_load_dwordx4 v76, s[36:39], s61 offen lds
    s_add_u32 m0, s7, 18432
    s_mov_b32 s61, 2228224
    buffer_load_dwordx4 v76, s[36:39], s61 offen lds
    s_add_u32 m0, s7, 19456
    s_mov_b32 s61, 2293760
    buffer_load_dwordx4 v76, s[36:39], s61 offen lds
    s_waitcnt vmcnt(32)
    s_waitcnt lgkmcnt(0)
    s_barrier
    ds_read_b64_tr_b16 a[96:97], v68 offset:20480
    ds_read_b64_tr_b16 a[98:99], v68 offset:20736
    ds_read_b64_tr_b16 a[100:101], v68 offset:22528
    ds_read_b64_tr_b16 a[102:103], v68 offset:22784
    ds_read_b64_tr_b16 a[104:105], v69 offset:20480
    ds_read_b64_tr_b16 a[106:107], v69 offset:20736
    ds_read_b64_tr_b16 a[108:109], v69 offset:22528
    ds_read_b64_tr_b16 a[110:111], v69 offset:22784
    s_waitcnt lgkmcnt(0)
    s_barrier
    s_add_u32 m0, s7, 20480
    s_mov_b32 s61, 2621440
    buffer_load_dwordx4 v76, s[36:39], s61 offen lds
    s_add_u32 m0, s7, 21504
    s_mov_b32 s61, 2686976
    buffer_load_dwordx4 v76, s[36:39], s61 offen lds
    s_add_u32 m0, s7, 22528
    s_mov_b32 s61, 2752512
    buffer_load_dwordx4 v76, s[36:39], s61 offen lds
    s_add_u32 m0, s7, 23552
    s_mov_b32 s61, 2818048
    buffer_load_dwordx4 v76, s[36:39], s61 offen lds
    s_waitcnt vmcnt(32)
    s_waitcnt lgkmcnt(0)
    s_barrier
    ds_read_b64_tr_b16 a[112:113], v68 offset:24576
    ds_read_b64_tr_b16 a[114:115], v68 offset:24832
    ds_read_b64_tr_b16 a[116:117], v68 offset:26624
    ds_read_b64_tr_b16 a[118:119], v68 offset:26880
    ds_read_b64_tr_b16 a[120:121], v69 offset:24576
    ds_read_b64_tr_b16 a[122:123], v69 offset:24832
    ds_read_b64_tr_b16 a[124:125], v69 offset:26624
    ds_read_b64_tr_b16 a[126:127], v69 offset:26880
    s_waitcnt lgkmcnt(0)
    s_barrier
    s_add_u32 m0, s7, 24576
    s_mov_b32 s61, 3145728
    buffer_load_dwordx4 v76, s[36:39], s61 offen lds
    s_add_u32 m0, s7, 25600
    s_mov_b32 s61, 3211264
    buffer_load_dwordx4 v76, s[36:39], s61 offen lds
    s_add_u32 m0, s7, 26624
    s_mov_b32 s61, 3276800
    buffer_load_dwordx4 v76, s[36:39], s61 offen lds
    s_add_u32 m0, s7, 27648
    s_mov_b32 s61, 3342336
    buffer_load_dwordx4 v76, s[36:39], s61 offen lds
    s_waitcnt vmcnt(32)
    s_waitcnt lgkmcnt(0)
    s_barrier
    ds_read_b64_tr_b16 v[248:249], v52 offset:28672
    ds_read_b64_tr_b16 v[250:251], v52 offset:29696
    ds_read_b64_tr_b16 v[252:253], v53 offset:28672
    ds_read_b64_tr_b16 v[254:255], v53 offset:29696
    s_waitcnt lgkmcnt(0)
    s_barrier
    s_add_u32 m0, s7, 28672
    s_mov_b32 s61, 3670016
    buffer_load_dwordx4 v76, s[36:39], s61 offen lds
    s_add_u32 m0, s7, 29696
    s_mov_b32 s61, 3735552
    buffer_load_dwordx4 v76, s[36:39], s61 offen lds
    s_add_u32 m0, s7, 30720
    s_mov_b32 s61, 3801088
    buffer_load_dwordx4 v76, s[36:39], s61 offen lds
    s_add_u32 m0, s7, 31744
    s_mov_b32 s61, 3866624
    buffer_load_dwordx4 v76, s[36:39], s61 offen lds
    v_lshlrev_b32 v33, 2, v1
    s_lshl_b32 s61, s58, 8
    s_add_u32 s61, s61, 86573056
    buffer_load_dword v74, v33, s[48:51], 0 offen sc1
    buffer_load_dword v75, v33, s[52:55], s61 offen sc1
    s_waitcnt vmcnt(34)
    s_waitcnt lgkmcnt(0)
    s_barrier
    ds_read_b64_tr_b16 a[128:129], v68 offset:32768
    ds_read_b64_tr_b16 a[130:131], v68 offset:33024
    ds_read_b64_tr_b16 a[132:133], v68 offset:34816
    ds_read_b64_tr_b16 a[134:135], v68 offset:35072
    ds_read_b64_tr_b16 a[136:137], v69 offset:32768
    ds_read_b64_tr_b16 a[138:139], v69 offset:33024
    ds_read_b64_tr_b16 a[140:141], v69 offset:34816
    ds_read_b64_tr_b16 a[142:143], v69 offset:35072
    s_waitcnt lgkmcnt(0)
    s_barrier
    s_add_u32 m0, s7, 32768
    s_mov_b32 s61, 4194304
    buffer_load_dwordx4 v76, s[36:39], s61 offen lds
    s_add_u32 m0, s7, 33792
    s_mov_b32 s61, 4259840
    buffer_load_dwordx4 v76, s[36:39], s61 offen lds
    s_add_u32 m0, s7, 34816
    s_mov_b32 s61, 4325376
    buffer_load_dwordx4 v76, s[36:39], s61 offen lds
    s_add_u32 m0, s7, 35840
    s_mov_b32 s61, 4390912
    buffer_load_dwordx4 v76, s[36:39], s61 offen lds
    s_mov_b32 s60, 85983232
    buffer_load_dwordx4 v[52:55], v5, s[52:55], s60 offen offset:0 sc1
    buffer_load_dwordx4 v[56:59], v5, s[52:55], s60 offen offset:1024 sc1
    buffer_load_dwordx4 v[60:63], v5, s[52:55], s60 offen offset:2048 sc1
    buffer_load_dwordx4 v[64:67], v5, s[52:55], s60 offen offset:3072 sc1
    s_mov_b32 s60, 86507520
    buffer_load_dword v70, v6, s[52:55], s60 offen sc1
    s_mov_b32 s60, 86516736
    buffer_load_dword v70, v6, s[52:55], s60 offen sc1
    s_mov_b32 s60, 86525952
    buffer_load_dword v70, v6, s[52:55], s60 offen sc1
    s_waitcnt vmcnt(41)
    s_waitcnt lgkmcnt(0)
    s_barrier
    ds_read_b64_tr_b16 v[36:37], v68 offset:0
    ds_read_b64_tr_b16 v[38:39], v68 offset:256
    ds_read_b64_tr_b16 v[40:41], v68 offset:2048
    ds_read_b64_tr_b16 v[42:43], v68 offset:2304
    ds_read_b64_tr_b16 v[44:45], v69 offset:0
    ds_read_b64_tr_b16 v[46:47], v69 offset:256
    ds_read_b64_tr_b16 v[48:49], v69 offset:2048
    ds_read_b64_tr_b16 v[50:51], v69 offset:2304
    s_waitcnt lgkmcnt(0)
    s_barrier
    ds_write_b128 v9, v[36:39] offset:0
    ds_write_b128 v9, v[40:43] offset:1024
    ds_write_b128 v9, v[44:47] offset:2048
    ds_write_b128 v9, v[48:51] offset:3072
    s_waitcnt vmcnt(37)
    s_waitcnt lgkmcnt(0)
    s_barrier
    ds_read_b64_tr_b16 v[36:37], v68 offset:4096
    ds_read_b64_tr_b16 v[38:39], v68 offset:4352
    ds_read_b64_tr_b16 v[40:41], v68 offset:6144
    ds_read_b64_tr_b16 v[42:43], v68 offset:6400
    ds_read_b64_tr_b16 v[44:45], v69 offset:4096
    ds_read_b64_tr_b16 v[46:47], v69 offset:4352
    ds_read_b64_tr_b16 v[48:49], v69 offset:6144
    ds_read_b64_tr_b16 v[50:51], v69 offset:6400
    s_waitcnt lgkmcnt(0)
    s_barrier
    ds_write_b128 v9, v[36:39] offset:4096
    ds_write_b128 v9, v[40:43] offset:5120
    ds_write_b128 v9, v[44:47] offset:6144
    ds_write_b128 v9, v[48:51] offset:7168
    s_waitcnt vmcnt(33)
    s_waitcnt lgkmcnt(0)
    s_barrier
    ds_read_b64_tr_b16 v[36:37], v68 offset:8192
    ds_read_b64_tr_b16 v[38:39], v68 offset:8448
    ds_read_b64_tr_b16 v[40:41], v68 offset:10240
    ds_read_b64_tr_b16 v[42:43], v68 offset:10496
    ds_read_b64_tr_b16 v[44:45], v69 offset:8192
    ds_read_b64_tr_b16 v[46:47], v69 offset:8448
    ds_read_b64_tr_b16 v[48:49], v69 offset:10240
    ds_read_b64_tr_b16 v[50:51], v69 offset:10496
    s_waitcnt lgkmcnt(0)
    s_barrier
    ds_write_b128 v9, v[36:39] offset:8192
    ds_write_b128 v9, v[40:43] offset:9216
    ds_write_b128 v9, v[44:47] offset:10240
    ds_write_b128 v9, v[48:51] offset:11264
    s_waitcnt vmcnt(29)
    s_waitcnt lgkmcnt(0)
    s_barrier
    ds_read_b64_tr_b16 v[36:37], v68 offset:12288
    ds_read_b64_tr_b16 v[38:39], v68 offset:12544
    ds_read_b64_tr_b16 v[40:41], v68 offset:14336
    ds_read_b64_tr_b16 v[42:43], v68 offset:14592
    ds_read_b64_tr_b16 v[44:45], v69 offset:12288
    ds_read_b64_tr_b16 v[46:47], v69 offset:12544
    ds_read_b64_tr_b16 v[48:49], v69 offset:14336
    ds_read_b64_tr_b16 v[50:51], v69 offset:14592
    s_waitcnt lgkmcnt(0)
    s_barrier
    ds_write_b128 v9, v[36:39] offset:12288
    ds_write_b128 v9, v[40:43] offset:13312
    ds_write_b128 v9, v[44:47] offset:14336
    ds_write_b128 v9, v[48:51] offset:15360
    s_waitcnt vmcnt(25)
    s_waitcnt lgkmcnt(0)
    s_barrier
    ds_read_b64_tr_b16 v[36:37], v68 offset:16384
    ds_read_b64_tr_b16 v[38:39], v68 offset:16640
    ds_read_b64_tr_b16 v[40:41], v68 offset:18432
    ds_read_b64_tr_b16 v[42:43], v68 offset:18688
    ds_read_b64_tr_b16 v[44:45], v69 offset:16384
    ds_read_b64_tr_b16 v[46:47], v69 offset:16640
    ds_read_b64_tr_b16 v[48:49], v69 offset:18432
    ds_read_b64_tr_b16 v[50:51], v69 offset:18688
    s_waitcnt lgkmcnt(0)
    s_barrier
    ds_write_b128 v9, v[36:39] offset:16384
    ds_write_b128 v9, v[40:43] offset:17408
    ds_write_b128 v9, v[44:47] offset:18432
    ds_write_b128 v9, v[48:51] offset:19456
    s_waitcnt vmcnt(21)
    s_waitcnt lgkmcnt(0)
    s_barrier
    ds_read_b64_tr_b16 v[36:37], v68 offset:20480
    ds_read_b64_tr_b16 v[38:39], v68 offset:20736
    ds_read_b64_tr_b16 v[40:41], v68 offset:22528
    ds_read_b64_tr_b16 v[42:43], v68 offset:22784
    ds_read_b64_tr_b16 v[44:45], v69 offset:20480
    ds_read_b64_tr_b16 v[46:47], v69 offset:20736
    ds_read_b64_tr_b16 v[48:49], v69 offset:22528
    ds_read_b64_tr_b16 v[50:51], v69 offset:22784
    s_waitcnt lgkmcnt(0)
    s_barrier
    ds_write_b128 v9, v[36:39] offset:20480
    ds_write_b128 v9, v[40:43] offset:21504
    ds_write_b128 v9, v[44:47] offset:22528
    ds_write_b128 v9, v[48:51] offset:23552
    s_waitcnt vmcnt(17)
    s_waitcnt lgkmcnt(0)
    s_barrier
    ds_read_b64_tr_b16 v[36:37], v68 offset:24576
    ds_read_b64_tr_b16 v[38:39], v68 offset:24832
    ds_read_b64_tr_b16 v[40:41], v68 offset:26624
    ds_read_b64_tr_b16 v[42:43], v68 offset:26880
    ds_read_b64_tr_b16 v[44:45], v69 offset:24576
    ds_read_b64_tr_b16 v[46:47], v69 offset:24832
    ds_read_b64_tr_b16 v[48:49], v69 offset:26624
    ds_read_b64_tr_b16 v[50:51], v69 offset:26880
    s_waitcnt lgkmcnt(0)
    s_barrier
    ds_write_b128 v9, v[36:39] offset:24576
    ds_write_b128 v9, v[40:43] offset:25600
    ds_write_b128 v9, v[44:47] offset:26624
    ds_write_b128 v9, v[48:51] offset:27648
    s_waitcnt vmcnt(13)
    s_waitcnt lgkmcnt(0)
    s_barrier
    ds_read_b64_tr_b16 v[36:37], v68 offset:28672
    ds_read_b64_tr_b16 v[38:39], v68 offset:28928
    ds_read_b64_tr_b16 v[40:41], v68 offset:30720
    ds_read_b64_tr_b16 v[42:43], v68 offset:30976
    ds_read_b64_tr_b16 v[44:45], v69 offset:28672
    ds_read_b64_tr_b16 v[46:47], v69 offset:28928
    ds_read_b64_tr_b16 v[48:49], v69 offset:30720
    ds_read_b64_tr_b16 v[50:51], v69 offset:30976
    s_waitcnt lgkmcnt(0)
    s_barrier
    ds_write_b128 v9, v[36:39] offset:28672
    ds_write_b128 v9, v[40:43] offset:29696
    ds_write_b128 v9, v[44:47] offset:30720
    ds_write_b128 v9, v[48:51] offset:31744
    s_waitcnt vmcnt(7)
    s_waitcnt lgkmcnt(0)
    s_barrier
    ds_read_b64_tr_b16 v[36:37], v68 offset:32768
    ds_read_b64_tr_b16 v[38:39], v68 offset:33024
    ds_read_b64_tr_b16 v[40:41], v68 offset:34816
    ds_read_b64_tr_b16 v[42:43], v68 offset:35072
    ds_read_b64_tr_b16 v[16:17], v69 offset:32768
    ds_read_b64_tr_b16 v[18:19], v69 offset:33024
    ds_read_b64_tr_b16 v[20:21], v69 offset:34816
    ds_read_b64_tr_b16 v[22:23], v69 offset:35072
    s_waitcnt lgkmcnt(0)
    s_barrier
    ds_write_b128 v9, v[36:39] offset:32768
    ds_write_b128 v9, v[40:43] offset:33792
    v_readlane_b32 s3, v74, 10
    v_readlane_b32 s61, v74, 21
    v_cmp_ne_u32 vcc, 4, v75
    s_cmp_eq_u32 s61, 0
    s_cselect_b32 s6, 0, 1
    s_ff1_i32_b64 s5, vcc
    s_cmp_lt_i32 s5, 0
    s_cselect_b32 s5, 64, s5
    s_mov_b32 s7, 0
    s_cmp_lg_u32 s56, 3
    s_cbranch_scc1 R_nwe
    s_cmp_lt_u32 s5, 3
    s_cbranch_scc1 R_nwe
    v_lshlrev_b32 v32, 7, v1
    s_lshl_b32 s60, s58, 13
    s_add_u32 s61, s60, 2097152
    buffer_load_dword v33, v32, s[52:55], s61 offen sc1
    s_add_u32 s61, s60, 18874368
    buffer_load_dword v33, v32, s[52:55], s61 offen sc1
    s_add_u32 s61, s60, 2359296
    buffer_load_dword v33, v32, s[52:55], s61 offen sc1
    s_add_u32 s61, s60, 19136512
    buffer_load_dword v33, v32, s[52:55], s61 offen sc1
    s_mov_b32 s7, 1
R_nwe:
    s_mov_b32 s63, 200000
    v_lshlrev_b32 v25, 2, v1
    s_cmp_ge_u32 s3, 32
    s_cbranch_scc1 R_warmok
    s_mov_b32 s5, 0
    s_mov_b32 s7, 0
R_warm:
    buffer_load_dword v24, v25, s[48:51], 0 offen sc1
    s_sub_u32 s63, s63, 1
    s_cbranch_scc1 M_abort
    s_waitcnt vmcnt(0)
    v_readlane_b32 s60, v24, 10
    v_readlane_b32 s61, v24, 21
    s_cmp_lt_u32 s60, 32
    s_cbranch_scc1 R_warm
    s_cmp_eq_u32 s61, 0
    s_cselect_b32 s6, 0, 1
R_warmok:
    s_cmp_lg_u32 s56, 3
    s_cbranch_scc1 R_nkvi
    s_cmp_eq_u32 s7, 1
    s_cbranch_scc1 R_nkvi
    s_waitcnt vmcnt(0)
    s_mov_b32 s60, 3
    s_cmp_ge_u32 s5, s60
    s_cbranch_scc1 R_kvi_ok
    s_waitcnt vmcnt(0)
    s_lshl_b32 s61, s58, 8
    s_add_u32 s61, s61, 86573056
    v_lshrrev_b32 v0, 2, v7
    v_and_b32 v0, 255, v0
R_kvi_p:
    buffer_load_dword v64, v0, s[52:55], s61 offen sc1
    s_sub_u32 s63, s63, 1
    s_cbranch_scc1 M_abort
    s_waitcnt vmcnt(0)
    v_cmp_ne_u32 vcc, 4, v64
    s_ff1_i32_b64 s5, vcc
    s_cmp_lt_i32 s5, 0
    s_cselect_b32 s5, 64, s5
    s_cmp_ge_u32 s5, s60
    s_cbranch_scc1 R_kvi_ok
    s_sleep 4
    s_branch R_kvi_p
R_kvi_ok:
    v_lshlrev_b32 v32, 7, v1
    s_lshl_b32 s60, s58, 13
    s_add_u32 s61, s60, 2097152
    buffer_load_dword v33, v32, s[52:55], s61 offen sc1
    s_add_u32 s61, s60, 18874368
    buffer_load_dword v33, v32, s[52:55], s61 offen sc1
    s_add_u32 s61, s60, 2359296
    buffer_load_dword v33, v32, s[52:55], s61 offen sc1
    s_add_u32 s61, s60, 19136512
    buffer_load_dword v33, v32, s[52:55], s61 offen sc1
R_nkvi:
    s_mov_b32 s64, 0
    s_mov_b32 s65, 85983232
    s_mov_b32 s69, 86525952
    s_mov_b32 s67, 86507520
    s_mov_b32 s68, 86516736
    s_lshl_b32 s71, s58, 13
    s_mov_b32 s80, 0x40000000
    s_cmp_lg_u32 s56, 3
    s_cselect_b32 s4, s80, s4
    s_mov_b32 s3, s80
    s_cbranch_scc1 R_nw3i
    s_lshl_b32 s3, s58, 8
    s_add_u32 s3, s3, 86573056
    v_lshlrev_b32 v6, 2, v1
    s_mov_b32 s80, 2621440
    v_lshlrev_b32 v5, 7, v1
    v_mov_b32 v15, 0
R_nw3i:
    s_cmp_eq_u32 s56, 3
    s_movk_i32 s60, 2048
    s_cselect_b32 s60, 1024, s60
    v_subrev_u32 v1, s60, v7
    s_waitcnt vmcnt(0) lgkmcnt(0)
    s_barrier
    v_mov_b32 v24, 0
    v_mov_b32 v25, 0
    v_mov_b32 v26, 0
    v_mov_b32 v27, 0
    v_mov_b32 v28, 0
    v_mov_b32 v29, 0
    v_mov_b32 v30, 0
    v_mov_b32 v31, 0
    v_mov_b32 v32, 0
    v_mov_b32 v33, 0
    v_mov_b32 v34, 0
    v_mov_b32 v35, 0
    s_cmp_eq_u32 s6, 1
    s_cbranch_scc1 R_loopS0x
R_loop0:
R_loop0x:
    s_mov_b32 s94, s69
    s_mov_b32 s69, s67
    s_mov_b32 s67, s68
    s_mov_b32 s68, s94
    s_mov_b32 s63, 200000
    s_sub_u32 s60, s69, 98304
    s_mov_b32 s61, s60
    s_add_u32 s62, s60, 4096
    s_add_u32 s94, s60, s66
    s_add_u32 s95, s71, 1998848
    s_add_u32 m0, s85, 149504
    ds_read_b128 v[52:55], v9 offset:0
    ds_read_b128 v[56:59], v9 offset:1024
    ds_read_b128 v[60:63], v9 offset:2048
    ds_read_b128 v[64:67], v9 offset:3072
    ds_read_b128 v[68:71], v9 offset:4096
    ds_read_b128 v[72:75], v9 offset:5120
    s_cmp_lt_u32 s56, 2
    s_cbranch_scc1 R_cdj0
    s_sleep 1
    buffer_load_dwordx4 v[36:39], v1, s[52:55], s61 offen sc1
    buffer_load_dwordx4 v[40:43], v1, s[52:55], s60 offen offset:1024 sc1
    s_sleep 2
    buffer_load_dwordx4 v[44:47], v1, s[52:55], s61 offen sc1
    buffer_load_dwordx4 v[48:51], v1, s[52:55], s60 offen offset:1024 sc1
R_cp0:
    s_waitcnt vmcnt(3)
    ds_write_b128 v1, v[36:39] offset:47104
    v_max3_u32 v0, v36, v37, v38
    s_waitcnt vmcnt(2)
    ds_write_b128 v1, v[40:43] offset:48128
    v_max3_u32 v0, v0, v39, v40
    v_max3_u32 v0, v0, v41, v42
    v_max_u32 v0, v0, v43
    v_cmp_eq_u32 vcc, -1, v0
    s_cbranch_vccnz R_cf0
R_cdj0:
    s_waitcnt lgkmcnt(0)
    s_barrier
    ds_read_b128 v[36:39], v8 offset:47104
    ds_read_b128 v[40:43], v8 offset:47616
    s_waitcnt vmcnt(0)
    ds_read_b128 v[44:47], v8 offset:48128
    ds_read_b128 v[48:51], v8 offset:48640
    s_waitcnt lgkmcnt(3)
    v_smfmac_f32_16x16x64_bf16 v[24:27], v[36:39], a[0:7], v2
    v_smfmac_f32_16x16x64_bf16 v[28:31], v[36:39], a[144:151], v2
    v_smfmac_f32_16x16x64_bf16 v[32:35], v[36:39], v[52:59], v2
    ds_read_b128 v[52:55], v9 offset:6144
    ds_read_b128 v[56:59], v9 offset:7168
    ds_read_b128 v[36:39], v8 offset:49152
    s_waitcnt lgkmcnt(5)
    v_smfmac_f32_16x16x64_bf16 v[24:27], v[40:43], a[8:15], v2
    buffer_load_dwordx4 v7, s[52:55], s62 offen sc1 lds
    v_smfmac_f32_16x16x64_bf16 v[28:31], v[40:43], a[152:159], v2
    s_add_u32 m0, s85, 154624
    v_smfmac_f32_16x16x64_bf16 v[32:35], v[40:43], v[60:67], v2
    ds_read_b128 v[60:63], v9 offset:8192
    ds_read_b128 v[64:67], v9 offset:9216
    ds_read_b128 v[40:43], v8 offset:49664
    s_waitcnt lgkmcnt(7)
    v_smfmac_f32_16x16x64_bf16 v[24:27], v[44:47], a[16:23], v2
    buffer_load_dwordx4 v7, s[52:55], s95 offen sc1 lds
    v_smfmac_f32_16x16x64_bf16 v[28:31], v[44:47], a[160:167], v2
    s_add_u32 m0, s85, 158720
    s_add_u32 s95, s95, 4096
    v_smfmac_f32_16x16x64_bf16 v[32:35], v[44:47], v[68:75], v2
    ds_read_b128 v[68:71], v9 offset:10240
    ds_read_b128 v[72:75], v9 offset:11264
    ds_read_b128 v[44:47], v8 offset:50176
    s_waitcnt lgkmcnt(9)
    v_smfmac_f32_16x16x64_bf16 v[24:27], v[48:51], a[24:31], v2
    buffer_load_dwordx4 v7, s[52:55], s95 offen sc1 lds
    v_smfmac_f32_16x16x64_bf16 v[28:31], v[48:51], a[168:175], v2
    s_mov_b32 m0, s57
    s_add_u32 s60, s71, 18874368
    s_waitcnt lgkmcnt(7)
    v_smfmac_f32_16x16x64_bf16 v[32:35], v[48:51], v[52:59], v2
    ds_read_b128 v[52:55], v9 offset:12288
    ds_read_b128 v[56:59], v9 offset:13312
    ds_read_b128 v[48:51], v8 offset:50688
    s_waitcnt lgkmcnt(9)
    v_smfmac_f32_16x16x64_bf16 v[24:27], v[36:39], a[32:39], v2
    v_smfmac_f32_16x16x64_bf16 v[28:31], v[36:39], a[176:183], v2
    s_waitcnt lgkmcnt(7)
    v_smfmac_f32_16x16x64_bf16 v[32:35], v[36:39], v[60:67], v2
    ds_read_b128 v[60:63], v9 offset:14336
    ds_read_b128 v[64:67], v9 offset:15360
    s_waitcnt lgkmcnt(8)
    v_smfmac_f32_16x16x64_bf16 v[24:27], v[40:43], a[40:47], v2
    v_smfmac_f32_16x16x64_bf16 v[28:31], v[40:43], a[184:191], v2
    s_waitcnt lgkmcnt(6)
    v_smfmac_f32_16x16x64_bf16 v[32:35], v[40:43], v[68:75], v2
    ds_read_b128 v[68:71], v9 offset:16384
    ds_read_b128 v[72:75], v9 offset:17408
    s_waitcnt lgkmcnt(7)
    v_smfmac_f32_16x16x64_bf16 v[24:27], v[44:47], a[48:55], v2
    v_smfmac_f32_16x16x64_bf16 v[28:31], v[44:47], a[192:199], v2
    s_waitcnt vmcnt(2)
    s_barrier
    ds_read_b128 v[36:39], v8 offset:51200
    ds_read_b128 v[40:43], v8 offset:51712
    s_waitcnt lgkmcnt(7)
    v_smfmac_f32_16x16x64_bf16 v[32:35], v[44:47], v[52:59], v2
    ds_read_b128 v[52:55], v9 offset:18432
    ds_read_b128 v[56:59], v9 offset:19456
    ds_read_b128 v[44:47], v8 offset:52224
    s_waitcnt lgkmcnt(9)
    v_smfmac_f32_16x16x64_bf16 v[24:27], v[48:51], a[56:63], v2
    buffer_load_dwordx4 v7, s[52:55], s94 offen sc1 lds
    v_smfmac_f32_16x16x64_bf16 v[28:31], v[48:51], a[200:207], v2
    s_waitcnt lgkmcnt(7)
    v_smfmac_f32_16x16x64_bf16 v[32:35], v[48:51], v[60:67], v2
    ds_read_b128 v[60:63], v9 offset:20480
    ds_read_b128 v[64:67], v9 offset:21504
    ds_read_b128 v[48:51], v8 offset:52736
    s_waitcnt lgkmcnt(7)
    v_smfmac_f32_16x16x64_bf16 v[24:27], v[36:39], a[64:71], v2
    buffer_load_dwordx4 v[76:79], v14, s[52:55], s60 offen sc1
    v_smfmac_f32_16x16x64_bf16 v[28:31], v[36:39], a[208:215], v2
    s_lshr_b32 s62, s71, 1
    v_smfmac_f32_16x16x64_bf16 v[32:35], v[36:39], v[68:75], v2
    ds_read_b128 v[68:71], v9 offset:22528
    ds_read_b128 v[72:75], v9 offset:23552
    ds_read_b128 v[36:39], v8 offset:53248
    s_waitcnt lgkmcnt(9)
    v_smfmac_f32_16x16x64_bf16 v[24:27], v[40:43], a[72:79], v2
    v_smfmac_f32_16x16x64_bf16 v[28:31], v[40:43], a[216:223], v2
    s_add_u32 s61, s62, 52396032
    s_add_u32 s95, s62, 52393984
    s_waitcnt lgkmcnt(7)
    v_smfmac_f32_16x16x64_bf16 v[32:35], v[40:43], v[52:59], v2
    ds_read_b128 v[52:55], v9 offset:24576
    ds_read_b128 v[56:59], v9 offset:25600
    ds_read_b128 v[40:43], v8 offset:53760
    s_waitcnt lgkmcnt(9)
    v_smfmac_f32_16x16x64_bf16 v[24:27], v[44:47], a[80:87], v2
    v_smfmac_f32_16x16x64_bf16 v[28:31], v[44:47], a[224:231], v2
    s_add_u32 s94, s71, s80
    s_add_u32 s62, s94, 16777216
    s_waitcnt lgkmcnt(7)
    v_smfmac_f32_16x16x64_bf16 v[32:35], v[44:47], v[60:67], v2
    ds_read_b128 v[60:63], v9 offset:26624
    ds_read_b128 v[64:67], v9 offset:27648
    ds_read_b128 v[44:47], v8 offset:54272
    s_waitcnt lgkmcnt(9)
    v_smfmac_f32_16x16x64_bf16 v[24:27], v[48:51], a[88:95], v2
    v_smfmac_f32_16x16x64_bf16 v[28:31], v[48:51], a[232:239], v2
    s_waitcnt lgkmcnt(7)
    v_smfmac_f32_16x16x64_bf16 v[32:35], v[48:51], v[68:75], v2
    ds_read_b128 v[68:71], v9 offset:28672
    ds_read_b128 v[72:75], v9 offset:29696
    buffer_load_dwordx4 v[48:51], v14, s[52:55], s60 offen offset:256 sc1
    s_waitcnt lgkmcnt(8)
    v_smfmac_f32_16x16x64_bf16 v[24:27], v[36:39], a[96:103], v2
    s_cmp_eq_u32 s70, 0
    s_cselect_b32 s97, 0x40000000, s68
    v_smfmac_f32_16x16x64_bf16 v[28:31], v[36:39], a[240:247], v2
    s_waitcnt lgkmcnt(6)
    v_smfmac_f32_16x16x64_bf16 v[32:35], v[36:39], v[52:59], v2
    ds_read_b128 v[52:55], v9 offset:30720
    ds_read_b128 v[56:59], v9 offset:31744
    ds_read_b128 v[36:39], v8 offset:54784
    s_waitcnt lgkmcnt(8)
    v_smfmac_f32_16x16x64_bf16 v[24:27], v[40:43], a[104:111], v2
    buffer_store_dword v15, v6, s[52:55], s97 offen
    v_smfmac_f32_16x16x64_bf16 v[28:31], v[40:43], a[248:255], v2
    s_waitcnt vmcnt(3)
    s_barrier
    s_waitcnt lgkmcnt(6)
    v_smfmac_f32_16x16x64_bf16 v[32:35], v[40:43], v[60:67], v2
    ds_read_b128 v[60:63], v9 offset:32768
    ds_read_b128 v[64:67], v9 offset:33792
    ds_read_b128 v[40:43], v8 offset:55296
    s_waitcnt lgkmcnt(8)
    v_smfmac_f32_16x16x64_bf16 v[24:27], v[44:47], a[112:119], v2
    buffer_load_dword v0, v5, s[52:55], s94 offen sc1
    v_smfmac_f32_16x16x64_bf16 v[28:31], v[44:47], v[80:87], v2
    s_waitcnt lgkmcnt(6)
    v_smfmac_f32_16x16x64_bf16 v[32:35], v[44:47], v[68:75], v2
    ds_read_b128 v[44:47], v8 offset:55808
    ds_read_b128 v[68:71], v12 offset:56320
    ds_read_b128 v[72:75], v12 offset:56448
    s_waitcnt lgkmcnt(6)
    v_smfmac_f32_16x16x64_bf16 v[24:27], v[36:39], a[120:127], v2
    buffer_load_dword v0, v5, s[52:55], s62 offen sc1
    v_smfmac_f32_16x16x64_bf16 v[28:31], v[36:39], v[88:95], v2
    v_smfmac_f32_16x16x64_bf16 v[32:35], v[36:39], v[52:59], v2
    ds_read_b128 v[52:55], v12 offset:58368
    ds_read_b128 v[56:59], v12 offset:58496
    s_waitcnt lgkmcnt(5)
    v_smfmac_f32_16x16x64_bf16 v[24:27], v[40:43], a[128:135], v2
    buffer_store_dword v15, off, s[52:55], s4 sc1
    v_smfmac_f32_16x16x64_bf16 v[28:31], v[40:43], v[96:103], v2
    s_waitcnt lgkmcnt(4)
    v_smfmac_f32_16x16x64_bf16 v[24:27], v[44:47], a[136:143], v2
    buffer_load_dword v0, v6, s[52:55], s3 offen sc1
    v_smfmac_f32_16x16x64_bf16 v[28:31], v[44:47], v[104:111], v2
    v_smfmac_f32_16x16x64_bf16 v[32:35], v[40:43], v[60:67], v2
    s_nop 2
    v_cvt_pk_bf16_f32 v24, v24, v25
    v_cvt_pk_bf16_f32 v25, v26, v27
    ds_write_b64 v10, v[24:25]
    v_cvt_pk_bf16_f32 v36, v28, v29
    v_cvt_pk_bf16_f32 v37, v30, v31
    ds_write_b64 v10, v[36:37] offset:36864
    v_smfmac_f32_16x16x64_bf16 v[32:35], v[44:47], v[16:23], v2
    ds_read_b128 v[60:63], v12 offset:60416
    ds_read_b128 v[64:67], v12 offset:60544
    v_cmp_u_f32 vcc, v28, v29
    v_cmp_u_f32 s[96:97], v30, v31
    s_or_b64 vcc, vcc, s[96:97]
    s_cbranch_vccnz R_slow0
R_slowret0:
    s_waitcnt lgkmcnt(2)
    s_barrier
    ds_read_b64_tr_b16 v[24:25], v11 offset:0
    ds_read_b64_tr_b16 v[26:27], v11 offset:128
    ds_read_b64_tr_b16 v[40:41], v11 offset:36864
    ds_read_b64_tr_b16 v[42:43], v11 offset:36992
    ds_read_b64_tr_b16 v[28:29], v11 offset:512
    ds_read_b64_tr_b16 v[30:31], v11 offset:640
    ds_read_b64_tr_b16 v[44:45], v11 offset:37376
    ds_read_b64_tr_b16 v[46:47], v11 offset:37504
    v_cvt_pk_bf16_f32 v38, v32, v33
    v_cvt_pk_bf16_f32 v39, v34, v35
    s_waitcnt lgkmcnt(6)
    v_mfma_f32_16x16x32_bf16 v[32:35], v[68:71], v[24:27], 0
    buffer_store_dwordx2 v[36:37], v10, s[52:55], s95 offen sc1
    v_mfma_f32_16x16x32_bf16 v[68:71], v[72:75], v[24:27], 0
    s_waitcnt lgkmcnt(4)
    v_mfma_f32_16x16x32_bf16 v[72:75], v[40:43], v[24:27], 0
    ds_read_b64_tr_b16 v[24:25], v11 offset:1024
    ds_read_b64_tr_b16 v[26:27], v11 offset:1152
    ds_read_b64_tr_b16 v[40:41], v11 offset:37888
    ds_read_b64_tr_b16 v[42:43], v11 offset:38016
    s_waitcnt lgkmcnt(6)
    v_mfma_f32_16x16x32_bf16 v[32:35], v[52:55], v[28:31], v[32:35]
    ds_read_b128 v[52:55], v12 offset:62464
    v_mfma_f32_16x16x32_bf16 v[68:71], v[56:59], v[28:31], v[68:71]
    ds_read_b128 v[56:59], v12 offset:62592
    buffer_store_dwordx2 v[38:39], v10, s[52:55], s61 offen sc1
    s_waitcnt lgkmcnt(6)
    v_mfma_f32_16x16x32_bf16 v[72:75], v[44:47], v[28:31], v[72:75]
    ds_read_b64_tr_b16 v[28:29], v11 offset:1536
    ds_read_b64_tr_b16 v[30:31], v11 offset:1664
    ds_read_b64_tr_b16 v[44:45], v11 offset:38400
    ds_read_b64_tr_b16 v[46:47], v11 offset:38528
    s_waitcnt lgkmcnt(8)
    v_mfma_f32_16x16x32_bf16 v[32:35], v[60:63], v[24:27], v[32:35]
    v_cndmask_b32 v60, 0, v38, s[72:73]
    v_cndmask_b32 v61, 0, v39, s[72:73]
    v_mfma_f32_16x16x32_bf16 v[68:71], v[64:67], v[24:27], v[68:71]
    v_mov_b32 v62, 0
    v_mov_b32 v63, 0
    s_waitcnt lgkmcnt(6)
    v_mfma_f32_16x16x32_bf16 v[72:75], v[40:43], v[24:27], v[72:75]
    v_cndmask_b32 v64, 0, v38, s[74:75]
    v_cndmask_b32 v65, 0, v39, s[74:75]
    s_waitcnt lgkmcnt(2)
    v_mfma_f32_16x16x32_bf16 v[32:35], v[52:55], v[28:31], v[32:35]
    v_mov_b32 v40, 0x3f803f80
    v_mov_b32 v41, 0x3f803f80
    v_mfma_f32_16x16x32_bf16 v[68:71], v[56:59], v[28:31], v[68:71]
    v_mov_b32 v42, 0x3f803f80
    v_mov_b32 v43, 0x3f803f80
    s_waitcnt lgkmcnt(0)
    v_mfma_f32_16x16x32_bf16 v[72:75], v[44:47], v[28:31], v[72:75]
    v_mov_b32 v44, 0x3f003f00
    v_mov_b32 v45, 0x3f003f00
    v_mov_b32 v46, 0
    v_mov_b32 v47, 0
    v_max3_f32 v66, v32, v33, v34
    s_nop 0
    v_max3_f32 v67, v35, v68, v69
    v_max3_f32 v66, v66, v70, v71
    v_max3_f32 v67, v67, v72, v73
    v_max3_f32 v66, v66, v74, v75
    v_max_f32 v66, v66, v67
    v_max_f32 v67, v66, v67
    v_mov_b32 v36, 0
    v_mov_b32 v37, 0
    v_permlane32_swap_b32 v66, v67
    v_max_f32 v66, v66, v67
    v_max_f32 v67, v66, v67
    v_mov_b32 v38, 0
    v_mov_b32 v39, 0
    v_permlane16_swap_b32 v66, v67
    v_max_f32 v66, v66, v67
    v_mul_f32 v66, s82, v66
    v_pk_fma_f32 v[32:33], v[32:33], s[82:83], v[66:67] op_sel_hi:[1,1,0] neg_lo:[0,0,1] neg_hi:[0,0,1]
    v_pk_fma_f32 v[34:35], v[34:35], s[82:83], v[66:67] op_sel_hi:[1,1,0] neg_lo:[0,0,1] neg_hi:[0,0,1]
    v_pk_fma_f32 v[68:69], v[68:69], s[82:83], v[66:67] op_sel_hi:[1,1,0] neg_lo:[0,0,1] neg_hi:[0,0,1]
    v_pk_fma_f32 v[70:71], v[70:71], s[82:83], v[66:67] op_sel_hi:[1,1,0] neg_lo:[0,0,1] neg_hi:[0,0,1]
    v_pk_fma_f32 v[72:73], v[72:73], s[82:83], v[66:67] op_sel_hi:[1,1,0] neg_lo:[0,0,1] neg_hi:[0,0,1]
    v_pk_fma_f32 v[74:75], v[74:75], s[82:83], v[66:67] op_sel_hi:[1,1,0] neg_lo:[0,0,1] neg_hi:[0,0,1]
    v_exp_f32 v32, v32
    v_exp_f32 v33, v33
    v_exp_f32 v34, v34
    v_cvt_pk_bf16_f32 v24, v32, v33
    v_exp_f32 v35, v35
    v_exp_f32 v68, v68
    v_cvt_pk_bf16_f32 v25, v34, v35
    v_exp_f32 v69, v69
    v_exp_f32 v70, v70
    v_cvt_pk_bf16_f32 v26, v68, v69
    v_exp_f32 v71, v71
    v_exp_f32 v72, v72
    v_cvt_pk_bf16_f32 v27, v70, v71
    s_waitcnt vmcnt(7)
    v_exp_f32 v73, v73
    v_mfma_f32_16x16x32_bf16 v[32:35], v[40:43], v[24:27], 0
    v_exp_f32 v74, v74
    v_mfma_f32_16x16x32_bf16 v[52:55], v[76:79], v[24:27], 0
    v_exp_f32 v75, v75
    v_cvt_pk_bf16_f32 v28, v72, v73
    v_mfma_f32_16x16x32_bf16 v[56:59], v[48:51], v[24:27], 0
    v_cvt_pk_bf16_f32 v29, v74, v75
    s_nop 1
    v_mfma_f32_16x16x32_bf16 v[32:35], v[44:47], v[28:31], v[32:35]
    v_mfma_f32_16x16x32_bf16 v[52:55], v[60:63], v[28:31], v[52:55]
    v_mfma_f32_16x16x32_bf16 v[56:59], v[62:65], v[26:29], v[56:59]
    v_mov_b32 v68, 0
    v_mov_b32 v69, 0
    v_mov_b32 v70, 0
    v_rcp_f32 v66, v32
    v_mov_b32 v71, 0
    v_mov_b32 v72, 0
    v_pk_mul_f32 v[52:53], v[52:53], v[66:67] op_sel_hi:[1,0]
    v_pk_mul_f32 v[54:55], v[54:55], v[66:67] op_sel_hi:[1,0]
    v_cvt_pk_bf16_f32 v52, v52, v53
    v_cvt_pk_bf16_f32 v53, v54, v55
    ds_write_b64 v13, v[52:53]
    v_pk_mul_f32 v[56:57], v[56:57], v[66:67] op_sel_hi:[1,0]
    v_pk_mul_f32 v[58:59], v[58:59], v[66:67] op_sel_hi:[1,0]
    v_cvt_pk_bf16_f32 v56, v56, v57
    v_cvt_pk_bf16_f32 v57, v58, v59
    ds_write_b64 v13, v[56:57] offset:256
    v_mov_b32 v73, 0
    v_mov_b32 v74, 0
    v_mov_b32 v75, 0
    v_mov_b32 v40, 0
    v_mov_b32 v41, 0
    v_mov_b32 v42, 0
    v_mov_b32 v43, 0
    s_add_u32 s60, s65, 262144
    s_add_u32 s61, s65, 65536
    s_waitcnt lgkmcnt(0)
    s_barrier
    ds_read_b128 v[24:27], v8 offset:10240
    ds_read_b128 v[28:31], v8 offset:10752
    ds_read_b128 v[60:63], v8 offset:11264
    ds_read_b128 v[64:67], v8 offset:11776
    s_add_u32 s62, s65, 131072
    s_add_u32 s94, s65, 196608
    s_add_u32 s64, s64, 1
    s_add_u32 s71, s71, 262144
    s_mov_b32 s63, 200000
    s_waitcnt lgkmcnt(3)
    v_smfmac_f32_16x16x64_bf16 v[68:71], v[24:27], v[112:119], v2
    s_waitcnt lgkmcnt(2)
    v_smfmac_f32_16x16x64_bf16 v[68:71], v[28:31], v[120:127], v2
    s_waitcnt lgkmcnt(1)
    v_smfmac_f32_16x16x64_bf16 v[68:71], v[60:63], v[128:135], v2
    s_waitcnt lgkmcnt(0)
    v_smfmac_f32_16x16x64_bf16 v[68:71], v[64:67], v[136:143], v2
    v_smfmac_f32_16x16x64_bf16 v[72:75], v[24:27], v[144:151], v2
    v_smfmac_f32_16x16x64_bf16 v[72:75], v[28:31], v[152:159], v2
    v_smfmac_f32_16x16x64_bf16 v[72:75], v[60:63], v[160:167], v2
    v_cvt_pk_bf16_f32 v68, v68, v69
    v_cvt_pk_bf16_f32 v69, v70, v71
    v_smfmac_f32_16x16x64_bf16 v[72:75], v[64:67], v[168:175], v2
    v_and_b32 v68, -2, v68
    v_and_b32 v69, -2, v69
    v_smfmac_f32_16x16x64_bf16 v[36:39], v[24:27], v[176:183], v2
    buffer_store_dwordx2 v[68:69], v4, s[52:55], s65 offen
    v_smfmac_f32_16x16x64_bf16 v[36:39], v[28:31], v[184:191], v2
    v_cvt_pk_bf16_f32 v72, v72, v73
    v_cvt_pk_bf16_f32 v73, v74, v75
    v_smfmac_f32_16x16x64_bf16 v[36:39], v[60:63], v[192:199], v2
    v_and_b32 v72, -2, v72
    v_and_b32 v73, -2, v73
    v_smfmac_f32_16x16x64_bf16 v[36:39], v[64:67], v[200:207], v2
    buffer_store_dwordx2 v[72:73], v4, s[52:55], s61 offen
    v_smfmac_f32_16x16x64_bf16 v[40:43], v[24:27], v[208:215], v2
    v_smfmac_f32_16x16x64_bf16 v[40:43], v[28:31], v[216:223], v2
    v_smfmac_f32_16x16x64_bf16 v[40:43], v[60:63], v[224:231], v2
    v_cvt_pk_bf16_f32 v36, v36, v37
    v_cvt_pk_bf16_f32 v37, v38, v39
    v_smfmac_f32_16x16x64_bf16 v[40:43], v[64:67], v[232:239], v2
    v_and_b32 v36, -2, v36
    v_and_b32 v37, -2, v37
    v_mfma_f32_16x16x32_bf16 v[44:47], v[24:27], v[240:243], 0
    buffer_store_dwordx2 v[36:37], v4, s[52:55], s62 offen
    v_mfma_f32_16x16x32_bf16 v[44:47], v[28:31], v[244:247], v[44:47]
    v_cvt_pk_bf16_f32 v40, v40, v41
    v_cvt_pk_bf16_f32 v41, v42, v43
    v_mfma_f32_16x16x32_bf16 v[44:47], v[60:63], v[248:251], v[44:47]
    v_and_b32 v40, -2, v40
    v_and_b32 v41, -2, v41
    v_mfma_f32_16x16x32_bf16 v[44:47], v[64:67], v[252:255], v[44:47]
    buffer_store_dwordx2 v[40:41], v4, s[52:55], s94 offen
    s_nop 6
    v_cvt_pk_bf16_f32 v44, v44, v45
    v_cvt_pk_bf16_f32 v45, v46, v47
    v_and_b32 v44, -2, v44
    v_and_b32 v45, -2, v45
    s_mov_b64 exec, s[72:73]
    buffer_store_dwordx2 v[44:45], v4, s[52:55], s60 offen
    s_mov_b64 exec, -1
    s_cmp_eq_u32 s70, 0
    s_cbranch_scc1 R_nored0
    s_mov_b32 s60, s84
R_rdl0:
    s_cmp_eq_u32 s60, 0
    s_cbranch_scc1 R_rgo0
    s_sleep 1
    s_sub_u32 s60, s60, 1
    s_branch R_rdl0
R_rgo0:
    buffer_load_dwordx4 v[52:55], v5, s[52:55], s65 offen offset:0 sc1
    buffer_load_dwordx4 v[56:59], v5, s[52:55], s65 offen offset:1024 sc1
    buffer_load_dwordx4 v[76:79], v5, s[52:55], s65 offen offset:2048 sc1
    buffer_load_dwordx4 v[48:51], v5, s[52:55], s65 offen offset:3072 sc1
    v_mov_b32 v24, 0
    v_mov_b32 v25, 0
    v_mov_b32 v26, 0
    v_mov_b32 v27, 0
    v_mov_b32 v28, 0
    v_mov_b32 v29, 0
    v_mov_b32 v30, 0
    v_mov_b32 v31, 0
    v_mov_b32 v32, 0
    v_mov_b32 v33, 0
    v_mov_b32 v34, 0
    v_mov_b32 v35, 0
    v_cndmask_b32 v60, 0, v3, s[86:87]
    v_cndmask_b32 v61, 0, v3, s[88:89]
    v_cndmask_b32 v62, 0, v3, s[90:91]
    v_cndmask_b32 v63, 0, v3, s[92:93]
R_rp00:
    s_waitcnt vmcnt(3)
    v_mfma_f32_16x16x32_bf16 v[40:43], v[60:63], v[52:55], 0
    v_or3_b32 v64, v52, v53, v54
    v_or3_b32 v64, v64, v55, v55
    s_waitcnt vmcnt(2)
    v_mfma_f32_16x16x32_bf16 v[40:43], v[60:63], v[56:59], v[40:43]
    v_or3_b32 v64, v64, v56, v57
    v_or3_b32 v64, v64, v58, v59
    s_waitcnt vmcnt(1)
    v_mfma_f32_16x16x32_bf16 v[40:43], v[60:63], v[76:79], v[40:43]
    v_or3_b32 v64, v64, v76, v77
    v_or3_b32 v64, v64, v78, v79
    s_waitcnt vmcnt(0)
    v_mfma_f32_16x16x32_bf16 v[40:43], v[60:63], v[48:51], v[40:43]
    v_or3_b32 v64, v64, v48, v49
    v_or3_b32 v64, v64, v50, v51
    v_and_b32 v64, 1, v64
    v_cmp_ne_u32 vcc, 0, v64
    s_cbranch_vccnz R_rf00
R_rdone0:
    s_nop 0
    s_nop 0
    s_nop 0
    v_add_f32_dpp v64, v40, v40 row_ror:8 row_mask:0xf bank_mask:0xf
    v_add_f32_dpp v65, v41, v41 row_ror:8 row_mask:0xf bank_mask:0xf
    v_cvt_pk_bf16_f32 v64, v64, v65
    v_min_u32 v0, -2, v64
    buffer_store_dword v0, v6, s[52:55], s67 offen
    s_branch R_loop1
R_nored0:
    v_mov_b32 v24, 0
    v_mov_b32 v25, 0
    v_mov_b32 v26, 0
    v_mov_b32 v27, 0
    v_mov_b32 v28, 0
    v_mov_b32 v29, 0
    v_mov_b32 v30, 0
    v_mov_b32 v31, 0
    v_mov_b32 v32, 0
    v_mov_b32 v33, 0
    v_mov_b32 v34, 0
    v_mov_b32 v35, 0
    s_cmp_lg_u32 s56, 3
    s_cbranch_scc1 R_nkv0
    v_mov_b32 v15, s64
    s_cmp_ge_u32 s5, 64
    s_cbranch_scc1 R_nkv0
    s_waitcnt vmcnt(7)
    v_cmp_ne_u32 vcc, 4, v0
    s_ff1_i32_b64 s5, vcc
    s_cmp_lt_i32 s5, 0
    s_cselect_b32 s5, 64, s5
    s_cselect_b32 s3, 0x40000000, s3
    s_add_u32 s60, s64, 3
    s_min_u32 s60, s60, 64
    s_cmp_ge_u32 s5, s60
    s_cbranch_scc1 R_kv0_ok
    s_waitcnt vmcnt(0)
    s_lshl_b32 s61, s58, 8
    s_add_u32 s61, s61, 86573056
    v_lshrrev_b32 v0, 2, v7
    v_and_b32 v0, 255, v0
R_kv0_p:
    buffer_load_dword v64, v0, s[52:55], s61 offen sc1
    s_sub_u32 s63, s63, 1
    s_cbranch_scc1 M_abort
    s_waitcnt vmcnt(0)
    v_cmp_ne_u32 vcc, 4, v64
    s_ff1_i32_b64 s5, vcc
    s_cmp_lt_i32 s5, 0
    s_cselect_b32 s5, 64, s5
    s_cmp_ge_u32 s5, s60
    s_cbranch_scc1 R_kv0_ok
    s_sleep 4
    s_branch R_kv0_p
R_kv0_ok:
R_nkv0:
    s_sleep 9
    s_branch R_loop1x
R_rf00:
    buffer_load_dwordx4 v[52:55], v5, s[52:55], s65 offen offset:0 sc1
    buffer_load_dwordx4 v[56:59], v5, s[52:55], s65 offen offset:1024 sc1
    buffer_load_dwordx4 v[76:79], v5, s[52:55], s65 offen offset:2048 sc1
    buffer_load_dwordx4 v[48:51], v5, s[52:55], s65 offen offset:3072 sc1
    s_sub_u32 s63, s63, 1
    s_cbranch_scc1 M_abort
    s_branch R_rp00
R_cf0:
    buffer_load_dwordx4 v[36:39], v1, s[52:55], s61 offen sc1
    buffer_load_dwordx4 v[40:43], v1, s[52:55], s60 offen offset:1024 sc1
    s_sub_u32 s63, s63, 1
    s_cbranch_scc1 M_abort
    s_waitcnt vmcnt(3)
    ds_write_b128 v1, v[44:47] offset:47104
    v_max3_u32 v0, v44, v45, v46
    s_waitcnt vmcnt(2)
    ds_write_b128 v1, v[48:51] offset:48128
    v_max3_u32 v0, v0, v47, v48
    v_max3_u32 v0, v0, v49, v50
    v_max_u32 v0, v0, v51
    v_cmp_eq_u32 vcc, -1, v0
    s_cbranch_vccz R_cok0
    buffer_load_dwordx4 v[44:47], v1, s[52:55], s61 offen sc1
    buffer_load_dwordx4 v[48:51], v1, s[52:55], s60 offen offset:1024 sc1
    s_sub_u32 s63, s63, 1
    s_cbranch_scc1 M_abort
    s_branch R_cp0
R_cok0:
    s_waitcnt vmcnt(0)
    s_branch R_cdj0
R_slow0:
    s_sub_u32 s97, s69, 98304
    s_waitcnt lgkmcnt(0)
    s_nop 7
    v_mov_b32 v24, 0
    v_mov_b32 v25, 0
    v_mov_b32 v26, 0
    v_mov_b32 v27, 0
    v_mov_b32 v28, 0
    v_mov_b32 v29, 0
    v_mov_b32 v30, 0
    v_mov_b32 v31, 0
    v_mov_b32 v32, 0
    v_mov_b32 v33, 0
    v_mov_b32 v34, 0
    v_mov_b32 v35, 0
    ds_read_b128 v[52:55], v9 offset:0
    ds_read_b128 v[56:59], v9 offset:1024
    ds_read_b128 v[60:63], v9 offset:2048
    ds_read_b128 v[64:67], v9 offset:3072
R_sp0_0:
    buffer_load_dwordx4 v[36:39], v8, s[52:55], s97 offen sc1
    buffer_load_dwordx4 v[40:43], v8, s[52:55], s97 offen offset:512 sc1
    s_sub_u32 s63, s63, 1
    s_cbranch_scc1 M_abort
    s_waitcnt vmcnt(0) lgkmcnt(0)
    v_max3_u32 v0, v36, v37, v38
    v_max3_u32 v0, v0, v39, v40
    v_max3_u32 v0, v0, v41, v42
    v_max_u32 v0, v0, v43
    v_cmp_eq_u32 vcc, -1, v0
    s_cbranch_vccnz R_sp0_0
    v_smfmac_f32_16x16x64_bf16 v[24:27], v[36:39], a[0:7], v2
    v_smfmac_f32_16x16x64_bf16 v[28:31], v[36:39], a[144:151], v2
    v_smfmac_f32_16x16x64_bf16 v[32:35], v[36:39], v[52:59], v2
    v_smfmac_f32_16x16x64_bf16 v[24:27], v[40:43], a[8:15], v2
    v_smfmac_f32_16x16x64_bf16 v[28:31], v[40:43], a[152:159], v2
    v_smfmac_f32_16x16x64_bf16 v[32:35], v[40:43], v[60:67], v2
    s_add_u32 s97, s97, 1024
    ds_read_b128 v[52:55], v9 offset:4096
    ds_read_b128 v[56:59], v9 offset:5120
    ds_read_b128 v[60:63], v9 offset:6144
    ds_read_b128 v[64:67], v9 offset:7168
R_sp1_0:
    buffer_load_dwordx4 v[36:39], v8, s[52:55], s97 offen sc1
    buffer_load_dwordx4 v[40:43], v8, s[52:55], s97 offen offset:512 sc1
    s_sub_u32 s63, s63, 1
    s_cbranch_scc1 M_abort
    s_waitcnt vmcnt(0) lgkmcnt(0)
    v_max3_u32 v0, v36, v37, v38
    v_max3_u32 v0, v0, v39, v40
    v_max3_u32 v0, v0, v41, v42
    v_max_u32 v0, v0, v43
    v_cmp_eq_u32 vcc, -1, v0
    s_cbranch_vccnz R_sp1_0
    v_smfmac_f32_16x16x64_bf16 v[24:27], v[36:39], a[16:23], v2
    v_smfmac_f32_16x16x64_bf16 v[28:31], v[36:39], a[160:167], v2
    v_smfmac_f32_16x16x64_bf16 v[32:35], v[36:39], v[52:59], v2
    v_smfmac_f32_16x16x64_bf16 v[24:27], v[40:43], a[24:31], v2
    v_smfmac_f32_16x16x64_bf16 v[28:31], v[40:43], a[168:175], v2
    v_smfmac_f32_16x16x64_bf16 v[32:35], v[40:43], v[60:67], v2
    s_add_u32 s97, s97, 1024
    ds_read_b128 v[52:55], v9 offset:8192
    ds_read_b128 v[56:59], v9 offset:9216
    ds_read_b128 v[60:63], v9 offset:10240
    ds_read_b128 v[64:67], v9 offset:11264
R_sp2_0:
    buffer_load_dwordx4 v[36:39], v8, s[52:55], s97 offen sc1
    buffer_load_dwordx4 v[40:43], v8, s[52:55], s97 offen offset:512 sc1
    s_sub_u32 s63, s63, 1
    s_cbranch_scc1 M_abort
    s_waitcnt vmcnt(0) lgkmcnt(0)
    v_max3_u32 v0, v36, v37, v38
    v_max3_u32 v0, v0, v39, v40
    v_max3_u32 v0, v0, v41, v42
    v_max_u32 v0, v0, v43
    v_cmp_eq_u32 vcc, -1, v0
    s_cbranch_vccnz R_sp2_0
    v_smfmac_f32_16x16x64_bf16 v[24:27], v[36:39], a[32:39], v2
    v_smfmac_f32_16x16x64_bf16 v[28:31], v[36:39], a[176:183], v2
    v_smfmac_f32_16x16x64_bf16 v[32:35], v[36:39], v[52:59], v2
    v_smfmac_f32_16x16x64_bf16 v[24:27], v[40:43], a[40:47], v2
    v_smfmac_f32_16x16x64_bf16 v[28:31], v[40:43], a[184:191], v2
    v_smfmac_f32_16x16x64_bf16 v[32:35], v[40:43], v[60:67], v2
    s_add_u32 s97, s97, 1024
    ds_read_b128 v[52:55], v9 offset:12288
    ds_read_b128 v[56:59], v9 offset:13312
    ds_read_b128 v[60:63], v9 offset:14336
    ds_read_b128 v[64:67], v9 offset:15360
R_sp3_0:
    buffer_load_dwordx4 v[36:39], v8, s[52:55], s97 offen sc1
    buffer_load_dwordx4 v[40:43], v8, s[52:55], s97 offen offset:512 sc1
    s_sub_u32 s63, s63, 1
    s_cbranch_scc1 M_abort
    s_waitcnt vmcnt(0) lgkmcnt(0)
    v_max3_u32 v0, v36, v37, v38
    v_max3_u32 v0, v0, v39, v40
    v_max3_u32 v0, v0, v41, v42
    v_max_u32 v0, v0, v43
    v_cmp_eq_u32 vcc, -1, v0
    s_cbranch_vccnz R_sp3_0
    v_smfmac_f32_16x16x64_bf16 v[24:27], v[36:39], a[48:55], v2
    v_smfmac_f32_16x16x64_bf16 v[28:31], v[36:39], a[192:199], v2
    v_smfmac_f32_16x16x64_bf16 v[32:35], v[36:39], v[52:59], v2
    v_smfmac_f32_16x16x64_bf16 v[24:27], v[40:43], a[56:63], v2
    v_smfmac_f32_16x16x64_bf16 v[28:31], v[40:43], a[200:207], v2
    v_smfmac_f32_16x16x64_bf16 v[32:35], v[40:43], v[60:67], v2
    s_add_u32 s97, s97, 1024
    ds_read_b128 v[52:55], v9 offset:16384
    ds_read_b128 v[56:59], v9 offset:17408
    ds_read_b128 v[60:63], v9 offset:18432
    ds_read_b128 v[64:67], v9 offset:19456
R_sp4_0:
    buffer_load_dwordx4 v[36:39], v8, s[52:55], s97 offen sc1
    buffer_load_dwordx4 v[40:43], v8, s[52:55], s97 offen offset:512 sc1
    s_sub_u32 s63, s63, 1
    s_cbranch_scc1 M_abort
    s_waitcnt vmcnt(0) lgkmcnt(0)
    v_max3_u32 v0, v36, v37, v38
    v_max3_u32 v0, v0, v39, v40
    v_max3_u32 v0, v0, v41, v42
    v_max_u32 v0, v0, v43
    v_cmp_eq_u32 vcc, -1, v0
    s_cbranch_vccnz R_sp4_0
    v_smfmac_f32_16x16x64_bf16 v[24:27], v[36:39], a[64:71], v2
    v_smfmac_f32_16x16x64_bf16 v[28:31], v[36:39], a[208:215], v2
    v_smfmac_f32_16x16x64_bf16 v[32:35], v[36:39], v[52:59], v2
    v_smfmac_f32_16x16x64_bf16 v[24:27], v[40:43], a[72:79], v2
    v_smfmac_f32_16x16x64_bf16 v[28:31], v[40:43], a[216:223], v2
    v_smfmac_f32_16x16x64_bf16 v[32:35], v[40:43], v[60:67], v2
    s_add_u32 s97, s97, 1024
    ds_read_b128 v[52:55], v9 offset:20480
    ds_read_b128 v[56:59], v9 offset:21504
    ds_read_b128 v[60:63], v9 offset:22528
    ds_read_b128 v[64:67], v9 offset:23552
R_sp5_0:
    buffer_load_dwordx4 v[36:39], v8, s[52:55], s97 offen sc1
    buffer_load_dwordx4 v[40:43], v8, s[52:55], s97 offen offset:512 sc1
    s_sub_u32 s63, s63, 1
    s_cbranch_scc1 M_abort
    s_waitcnt vmcnt(0) lgkmcnt(0)
    v_max3_u32 v0, v36, v37, v38
    v_max3_u32 v0, v0, v39, v40
    v_max3_u32 v0, v0, v41, v42
    v_max_u32 v0, v0, v43
    v_cmp_eq_u32 vcc, -1, v0
    s_cbranch_vccnz R_sp5_0
    v_smfmac_f32_16x16x64_bf16 v[24:27], v[36:39], a[80:87], v2
    v_smfmac_f32_16x16x64_bf16 v[28:31], v[36:39], a[224:231], v2
    v_smfmac_f32_16x16x64_bf16 v[32:35], v[36:39], v[52:59], v2
    v_smfmac_f32_16x16x64_bf16 v[24:27], v[40:43], a[88:95], v2
    v_smfmac_f32_16x16x64_bf16 v[28:31], v[40:43], a[232:239], v2
    v_smfmac_f32_16x16x64_bf16 v[32:35], v[40:43], v[60:67], v2
    s_add_u32 s97, s97, 1024
    ds_read_b128 v[52:55], v9 offset:24576
    ds_read_b128 v[56:59], v9 offset:25600
    ds_read_b128 v[60:63], v9 offset:26624
    ds_read_b128 v[64:67], v9 offset:27648
R_sp6_0:
    buffer_load_dwordx4 v[36:39], v8, s[52:55], s97 offen sc1
    buffer_load_dwordx4 v[40:43], v8, s[52:55], s97 offen offset:512 sc1
    s_sub_u32 s63, s63, 1
    s_cbranch_scc1 M_abort
    s_waitcnt vmcnt(0) lgkmcnt(0)
    v_max3_u32 v0, v36, v37, v38
    v_max3_u32 v0, v0, v39, v40
    v_max3_u32 v0, v0, v41, v42
    v_max_u32 v0, v0, v43
    v_cmp_eq_u32 vcc, -1, v0
    s_cbranch_vccnz R_sp6_0
    v_smfmac_f32_16x16x64_bf16 v[24:27], v[36:39], a[96:103], v2
    v_smfmac_f32_16x16x64_bf16 v[28:31], v[36:39], a[240:247], v2
    v_smfmac_f32_16x16x64_bf16 v[32:35], v[36:39], v[52:59], v2
    v_smfmac_f32_16x16x64_bf16 v[24:27], v[40:43], a[104:111], v2
    v_smfmac_f32_16x16x64_bf16 v[28:31], v[40:43], a[248:255], v2
    v_smfmac_f32_16x16x64_bf16 v[32:35], v[40:43], v[60:67], v2
    s_add_u32 s97, s97, 1024
    ds_read_b128 v[52:55], v9 offset:28672
    ds_read_b128 v[56:59], v9 offset:29696
    ds_read_b128 v[60:63], v9 offset:30720
    ds_read_b128 v[64:67], v9 offset:31744
R_sp7_0:
    buffer_load_dwordx4 v[36:39], v8, s[52:55], s97 offen sc1
    buffer_load_dwordx4 v[40:43], v8, s[52:55], s97 offen offset:512 sc1
    s_sub_u32 s63, s63, 1
    s_cbranch_scc1 M_abort
    s_waitcnt vmcnt(0) lgkmcnt(0)
    v_max3_u32 v0, v36, v37, v38
    v_max3_u32 v0, v0, v39, v40
    v_max3_u32 v0, v0, v41, v42
    v_max_u32 v0, v0, v43
    v_cmp_eq_u32 vcc, -1, v0
    s_cbranch_vccnz R_sp7_0
    v_smfmac_f32_16x16x64_bf16 v[24:27], v[36:39], a[112:119], v2
    v_smfmac_f32_16x16x64_bf16 v[28:31], v[36:39], v[80:87], v2
    v_smfmac_f32_16x16x64_bf16 v[32:35], v[36:39], v[52:59], v2
    v_smfmac_f32_16x16x64_bf16 v[24:27], v[40:43], a[120:127], v2
    v_smfmac_f32_16x16x64_bf16 v[28:31], v[40:43], v[88:95], v2
    v_smfmac_f32_16x16x64_bf16 v[32:35], v[40:43], v[60:67], v2
    s_add_u32 s97, s97, 1024
    ds_read_b128 v[52:55], v9 offset:32768
    ds_read_b128 v[56:59], v9 offset:33792
R_sp8_0:
    buffer_load_dwordx4 v[36:39], v8, s[52:55], s97 offen sc1
    buffer_load_dwordx4 v[40:43], v8, s[52:55], s97 offen offset:512 sc1
    s_sub_u32 s63, s63, 1
    s_cbranch_scc1 M_abort
    s_waitcnt vmcnt(0) lgkmcnt(0)
    v_max3_u32 v0, v36, v37, v38
    v_max3_u32 v0, v0, v39, v40
    v_max3_u32 v0, v0, v41, v42
    v_max_u32 v0, v0, v43
    v_cmp_eq_u32 vcc, -1, v0
    s_cbranch_vccnz R_sp8_0
    v_smfmac_f32_16x16x64_bf16 v[24:27], v[36:39], a[128:135], v2
    v_smfmac_f32_16x16x64_bf16 v[28:31], v[36:39], v[96:103], v2
    v_smfmac_f32_16x16x64_bf16 v[32:35], v[36:39], v[52:59], v2
    v_smfmac_f32_16x16x64_bf16 v[24:27], v[40:43], a[136:143], v2
    v_smfmac_f32_16x16x64_bf16 v[28:31], v[40:43], v[104:111], v2
    v_smfmac_f32_16x16x64_bf16 v[32:35], v[40:43], v[16:23], v2
    s_add_u32 s97, s97, 1024
    s_nop 7
    v_cvt_pk_bf16_f32 v24, v24, v25
    v_cvt_pk_bf16_f32 v25, v26, v27
    ds_write_b64 v10, v[24:25]
    v_cvt_pk_bf16_f32 v36, v28, v29
    v_cvt_pk_bf16_f32 v37, v30, v31
    ds_write_b64 v10, v[36:37] offset:36864
    ds_read_b128 v[52:55], v12 offset:58368
    ds_read_b128 v[56:59], v12 offset:58496
    ds_read_b128 v[60:63], v12 offset:60416
    ds_read_b128 v[64:67], v12 offset:60544
    s_waitcnt lgkmcnt(0)
    s_branch R_slowret0
R_loop1:
R_loop1x:
    s_mov_b32 s94, s69
    s_mov_b32 s69, s67
    s_mov_b32 s67, s68
    s_mov_b32 s68, s94
    s_mov_b32 s63, 200000
    s_sub_u32 s60, s69, 98304
    s_mov_b32 s61, s60
    s_add_u32 s62, s60, 4096
    s_add_u32 s94, s60, s66
    s_add_u32 s95, s71, 1998848
    s_add_u32 m0, s85, 149504
    ds_read_b128 v[52:55], v9 offset:0
    ds_read_b128 v[56:59], v9 offset:1024
    ds_read_b128 v[60:63], v9 offset:2048
    ds_read_b128 v[64:67], v9 offset:3072
    ds_read_b128 v[68:71], v9 offset:4096
    ds_read_b128 v[72:75], v9 offset:5120
    s_cmp_lt_u32 s56, 2
    s_cbranch_scc1 R_cdj1
    s_sleep 1
    buffer_load_dwordx4 v[36:39], v1, s[52:55], s61 offen sc1
    buffer_load_dwordx4 v[40:43], v1, s[52:55], s60 offen offset:1024 sc1
    s_sleep 2
    buffer_load_dwordx4 v[44:47], v1, s[52:55], s61 offen sc1
    buffer_load_dwordx4 v[48:51], v1, s[52:55], s60 offen offset:1024 sc1
R_cp1:
    s_waitcnt vmcnt(3)
    ds_write_b128 v1, v[36:39] offset:47104
    v_max3_u32 v0, v36, v37, v38
    s_waitcnt vmcnt(2)
    ds_write_b128 v1, v[40:43] offset:48128
    v_max3_u32 v0, v0, v39, v40
    v_max3_u32 v0, v0, v41, v42
    v_max_u32 v0, v0, v43
    v_cmp_eq_u32 vcc, -1, v0
    s_cbranch_vccnz R_cf1
R_cdj1:
    s_waitcnt lgkmcnt(0)
    s_barrier
    ds_read_b128 v[36:39], v8 offset:47104
    ds_read_b128 v[40:43], v8 offset:47616
    s_waitcnt vmcnt(0)
    ds_read_b128 v[44:47], v8 offset:48128
    ds_read_b128 v[48:51], v8 offset:48640
    s_waitcnt lgkmcnt(3)
    v_smfmac_f32_16x16x64_bf16 v[24:27], v[36:39], a[0:7], v2
    v_smfmac_f32_16x16x64_bf16 v[28:31], v[36:39], a[144:151], v2
    v_smfmac_f32_16x16x64_bf16 v[32:35], v[36:39], v[52:59], v2
    ds_read_b128 v[52:55], v9 offset:6144
    ds_read_b128 v[56:59], v9 offset:7168
    ds_read_b128 v[36:39], v8 offset:49152
    s_waitcnt lgkmcnt(5)
    v_smfmac_f32_16x16x64_bf16 v[24:27], v[40:43], a[8:15], v2
    buffer_load_dwordx4 v7, s[52:55], s62 offen sc1 lds
    v_smfmac_f32_16x16x64_bf16 v[28:31], v[40:43], a[152:159], v2
    s_add_u32 m0, s85, 154624
    v_smfmac_f32_16x16x64_bf16 v[32:35], v[40:43], v[60:67], v2
    ds_read_b128 v[60:63], v9 offset:8192
    ds_read_b128 v[64:67], v9 offset:9216
    ds_read_b128 v[40:43], v8 offset:49664
    s_waitcnt lgkmcnt(7)
    v_smfmac_f32_16x16x64_bf16 v[24:27], v[44:47], a[16:23], v2
    buffer_load_dwordx4 v7, s[52:55], s95 offen sc1 lds
    v_smfmac_f32_16x16x64_bf16 v[28:31], v[44:47], a[160:167], v2
    s_add_u32 m0, s85, 158720
    s_add_u32 s95, s95, 4096
    v_smfmac_f32_16x16x64_bf16 v[32:35], v[44:47], v[68:75], v2
    ds_read_b128 v[68:71], v9 offset:10240
    ds_read_b128 v[72:75], v9 offset:11264
    ds_read_b128 v[44:47], v8 offset:50176
    s_waitcnt lgkmcnt(9)
    v_smfmac_f32_16x16x64_bf16 v[24:27], v[48:51], a[24:31], v2
    buffer_load_dwordx4 v7, s[52:55], s95 offen sc1 lds
    v_smfmac_f32_16x16x64_bf16 v[28:31], v[48:51], a[168:175], v2
    s_mov_b32 m0, s57
    s_add_u32 s60, s71, 18874368
    s_waitcnt lgkmcnt(7)
    v_smfmac_f32_16x16x64_bf16 v[32:35], v[48:51], v[52:59], v2
    ds_read_b128 v[52:55], v9 offset:12288
    ds_read_b128 v[56:59], v9 offset:13312
    ds_read_b128 v[48:51], v8 offset:50688
    s_waitcnt lgkmcnt(9)
    v_smfmac_f32_16x16x64_bf16 v[24:27], v[36:39], a[32:39], v2
    v_smfmac_f32_16x16x64_bf16 v[28:31], v[36:39], a[176:183], v2
    s_waitcnt lgkmcnt(7)
    v_smfmac_f32_16x16x64_bf16 v[32:35], v[36:39], v[60:67], v2
    ds_read_b128 v[60:63], v9 offset:14336
    ds_read_b128 v[64:67], v9 offset:15360
    s_waitcnt lgkmcnt(8)
    v_smfmac_f32_16x16x64_bf16 v[24:27], v[40:43], a[40:47], v2
    v_smfmac_f32_16x16x64_bf16 v[28:31], v[40:43], a[184:191], v2
    s_waitcnt lgkmcnt(6)
    v_smfmac_f32_16x16x64_bf16 v[32:35], v[40:43], v[68:75], v2
    ds_read_b128 v[68:71], v9 offset:16384
    ds_read_b128 v[72:75], v9 offset:17408
    s_waitcnt lgkmcnt(7)
    v_smfmac_f32_16x16x64_bf16 v[24:27], v[44:47], a[48:55], v2
    v_smfmac_f32_16x16x64_bf16 v[28:31], v[44:47], a[192:199], v2
    s_waitcnt vmcnt(2)
    s_barrier
    ds_read_b128 v[36:39], v8 offset:51200
    ds_read_b128 v[40:43], v8 offset:51712
    s_waitcnt lgkmcnt(7)
    v_smfmac_f32_16x16x64_bf16 v[32:35], v[44:47], v[52:59], v2
    ds_read_b128 v[52:55], v9 offset:18432
    ds_read_b128 v[56:59], v9 offset:19456
    ds_read_b128 v[44:47], v8 offset:52224
    s_waitcnt lgkmcnt(9)
    v_smfmac_f32_16x16x64_bf16 v[24:27], v[48:51], a[56:63], v2
    buffer_load_dwordx4 v7, s[52:55], s94 offen sc1 lds
    v_smfmac_f32_16x16x64_bf16 v[28:31], v[48:51], a[200:207], v2
    s_waitcnt lgkmcnt(7)
    v_smfmac_f32_16x16x64_bf16 v[32:35], v[48:51], v[60:67], v2
    ds_read_b128 v[60:63], v9 offset:20480
    ds_read_b128 v[64:67], v9 offset:21504
    ds_read_b128 v[48:51], v8 offset:52736
    s_waitcnt lgkmcnt(7)
    v_smfmac_f32_16x16x64_bf16 v[24:27], v[36:39], a[64:71], v2
    buffer_load_dwordx4 v[76:79], v14, s[52:55], s60 offen sc1
    v_smfmac_f32_16x16x64_bf16 v[28:31], v[36:39], a[208:215], v2
    s_lshr_b32 s62, s71, 1
    v_smfmac_f32_16x16x64_bf16 v[32:35], v[36:39], v[68:75], v2
    ds_read_b128 v[68:71], v9 offset:22528
    ds_read_b128 v[72:75], v9 offset:23552
    ds_read_b128 v[36:39], v8 offset:53248
    s_waitcnt lgkmcnt(9)
    v_smfmac_f32_16x16x64_bf16 v[24:27], v[40:43], a[72:79], v2
    v_smfmac_f32_16x16x64_bf16 v[28:31], v[40:43], a[216:223], v2
    s_add_u32 s61, s62, 52396032
    s_add_u32 s95, s62, 52393984
    s_waitcnt lgkmcnt(7)
    v_smfmac_f32_16x16x64_bf16 v[32:35], v[40:43], v[52:59], v2
    ds_read_b128 v[52:55], v9 offset:24576
    ds_read_b128 v[56:59], v9 offset:25600
    ds_read_b128 v[40:43], v8 offset:53760
    s_waitcnt lgkmcnt(9)
    v_smfmac_f32_16x16x64_bf16 v[24:27], v[44:47], a[80:87], v2
    v_smfmac_f32_16x16x64_bf16 v[28:31], v[44:47], a[224:231], v2
    s_add_u32 s94, s71, s80
    s_add_u32 s62, s94, 16777216
    s_waitcnt lgkmcnt(7)
    v_smfmac_f32_16x16x64_bf16 v[32:35], v[44:47], v[60:67], v2
    ds_read_b128 v[60:63], v9 offset:26624
    ds_read_b128 v[64:67], v9 offset:27648
    ds_read_b128 v[44:47], v8 offset:54272
    s_waitcnt lgkmcnt(9)
    v_smfmac_f32_16x16x64_bf16 v[24:27], v[48:51], a[88:95], v2
    v_smfmac_f32_16x16x64_bf16 v[28:31], v[48:51], a[232:239], v2
    s_waitcnt lgkmcnt(7)
    v_smfmac_f32_16x16x64_bf16 v[32:35], v[48:51], v[68:75], v2
    ds_read_b128 v[68:71], v9 offset:28672
    ds_read_b128 v[72:75], v9 offset:29696
    buffer_load_dwordx4 v[48:51], v14, s[52:55], s60 offen offset:256 sc1
    s_waitcnt lgkmcnt(8)
    v_smfmac_f32_16x16x64_bf16 v[24:27], v[36:39], a[96:103], v2
    s_cmp_eq_u32 s70, 0
    s_cselect_b32 s97, 0x40000000, s68
    v_smfmac_f32_16x16x64_bf16 v[28:31], v[36:39], a[240:247], v2
    s_waitcnt lgkmcnt(6)
    v_smfmac_f32_16x16x64_bf16 v[32:35], v[36:39], v[52:59], v2
    ds_read_b128 v[52:55], v9 offset:30720
    ds_read_b128 v[56:59], v9 offset:31744
    ds_read_b128 v[36:39], v8 offset:54784
    s_waitcnt lgkmcnt(8)
    v_smfmac_f32_16x16x64_bf16 v[24:27], v[40:43], a[104:111], v2
    buffer_store_dword v15, v6, s[52:55], s97 offen
    v_smfmac_f32_16x16x64_bf16 v[28:31], v[40:43], a[248:255], v2
    s_waitcnt vmcnt(3)
    s_barrier
    s_waitcnt lgkmcnt(6)
    v_smfmac_f32_16x16x64_bf16 v[32:35], v[40:43], v[60:67], v2
    ds_read_b128 v[60:63], v9 offset:32768
    ds_read_b128 v[64:67], v9 offset:33792
    ds_read_b128 v[40:43], v8 offset:55296
    s_waitcnt lgkmcnt(8)
    v_smfmac_f32_16x16x64_bf16 v[24:27], v[44:47], a[112:119], v2
    buffer_load_dword v0, v5, s[52:55], s94 offen sc1
    v_smfmac_f32_16x16x64_bf16 v[28:31], v[44:47], v[80:87], v2
    s_waitcnt lgkmcnt(6)
    v_smfmac_f32_16x16x64_bf16 v[32:35], v[44:47], v[68:75], v2
    ds_read_b128 v[44:47], v8 offset:55808
    ds_read_b128 v[68:71], v12 offset:56320
    ds_read_b128 v[72:75], v12 offset:56448
    s_waitcnt lgkmcnt(6)
    v_smfmac_f32_16x16x64_bf16 v[24:27], v[36:39], a[120:127], v2
    buffer_load_dword v0, v5, s[52:55], s62 offen sc1
    v_smfmac_f32_16x16x64_bf16 v[28:31], v[36:39], v[88:95], v2
    v_smfmac_f32_16x16x64_bf16 v[32:35], v[36:39], v[52:59], v2
    ds_read_b128 v[52:55], v12 offset:58368
    ds_read_b128 v[56:59], v12 offset:58496
    s_waitcnt lgkmcnt(5)
    v_smfmac_f32_16x16x64_bf16 v[24:27], v[40:43], a[128:135], v2
    buffer_store_dword v15, off, s[52:55], s4 sc1
    v_smfmac_f32_16x16x64_bf16 v[28:31], v[40:43], v[96:103], v2
    s_waitcnt lgkmcnt(4)
    v_smfmac_f32_16x16x64_bf16 v[24:27], v[44:47], a[136:143], v2
    buffer_load_dword v0, v6, s[52:55], s3 offen sc1
    v_smfmac_f32_16x16x64_bf16 v[28:31], v[44:47], v[104:111], v2
    v_smfmac_f32_16x16x64_bf16 v[32:35], v[40:43], v[60:67], v2
    s_nop 2
    v_cvt_pk_bf16_f32 v24, v24, v25
    v_cvt_pk_bf16_f32 v25, v26, v27
    ds_write_b64 v10, v[24:25]
    v_cvt_pk_bf16_f32 v36, v28, v29
    v_cvt_pk_bf16_f32 v37, v30, v31
    ds_write_b64 v10, v[36:37] offset:36864
    v_smfmac_f32_16x16x64_bf16 v[32:35], v[44:47], v[16:23], v2
    ds_read_b128 v[60:63], v12 offset:60416
    ds_read_b128 v[64:67], v12 offset:60544
    v_cmp_u_f32 vcc, v28, v29
    v_cmp_u_f32 s[96:97], v30, v31
    s_or_b64 vcc, vcc, s[96:97]
    s_cbranch_vccnz R_slow1
R_slowret1:
    s_cmp_eq_u32 s64, 63
    s_cbranch_scc1 R_done
    s_waitcnt lgkmcnt(2)
    s_barrier
    ds_read_b64_tr_b16 v[24:25], v11 offset:0
    ds_read_b64_tr_b16 v[26:27], v11 offset:128
    ds_read_b64_tr_b16 v[40:41], v11 offset:36864
    ds_read_b64_tr_b16 v[42:43], v11 offset:36992
    ds_read_b64_tr_b16 v[28:29], v11 offset:512
    ds_read_b64_tr_b16 v[30:31], v11 offset:640
    ds_read_b64_tr_b16 v[44:45], v11 offset:37376
    ds_read_b64_tr_b16 v[46:47], v11 offset:37504
    v_cvt_pk_bf16_f32 v38, v32, v33
    v_cvt_pk_bf16_f32 v39, v34, v35
    s_waitcnt lgkmcnt(6)
    v_mfma_f32_16x16x32_bf16 v[32:35], v[68:71], v[24:27], 0
    buffer_store_dwordx2 v[36:37], v10, s[52:55], s95 offen sc1
    v_mfma_f32_16x16x32_bf16 v[68:71], v[72:75], v[24:27], 0
    s_waitcnt lgkmcnt(4)
    v_mfma_f32_16x16x32_bf16 v[72:75], v[40:43], v[24:27], 0
    ds_read_b64_tr_b16 v[24:25], v11 offset:1024
    ds_read_b64_tr_b16 v[26:27], v11 offset:1152
    ds_read_b64_tr_b16 v[40:41], v11 offset:37888
    ds_read_b64_tr_b16 v[42:43], v11 offset:38016
    s_waitcnt lgkmcnt(6)
    v_mfma_f32_16x16x32_bf16 v[32:35], v[52:55], v[28:31], v[32:35]
    ds_read_b128 v[52:55], v12 offset:62464
    v_mfma_f32_16x16x32_bf16 v[68:71], v[56:59], v[28:31], v[68:71]
    ds_read_b128 v[56:59], v12 offset:62592
    buffer_store_dwordx2 v[38:39], v10, s[52:55], s61 offen sc1
    s_waitcnt lgkmcnt(6)
    v_mfma_f32_16x16x32_bf16 v[72:75], v[44:47], v[28:31], v[72:75]
    ds_read_b64_tr_b16 v[28:29], v11 offset:1536
    ds_read_b64_tr_b16 v[30:31], v11 offset:1664
    ds_read_b64_tr_b16 v[44:45], v11 offset:38400
    ds_read_b64_tr_b16 v[46:47], v11 offset:38528
    s_waitcnt lgkmcnt(8)
    v_mfma_f32_16x16x32_bf16 v[32:35], v[60:63], v[24:27], v[32:35]
    v_cndmask_b32 v60, 0, v38, s[72:73]
    v_cndmask_b32 v61, 0, v39, s[72:73]
    v_mfma_f32_16x16x32_bf16 v[68:71], v[64:67], v[24:27], v[68:71]
    v_mov_b32 v62, 0
    v_mov_b32 v63, 0
    s_waitcnt lgkmcnt(6)
    v_mfma_f32_16x16x32_bf16 v[72:75], v[40:43], v[24:27], v[72:75]
    v_cndmask_b32 v64, 0, v38, s[74:75]
    v_cndmask_b32 v65, 0, v39, s[74:75]
    s_waitcnt lgkmcnt(2)
    v_mfma_f32_16x16x32_bf16 v[32:35], v[52:55], v[28:31], v[32:35]
    v_mov_b32 v40, 0x3f803f80
    v_mov_b32 v41, 0x3f803f80
    v_mfma_f32_16x16x32_bf16 v[68:71], v[56:59], v[28:31], v[68:71]
    v_mov_b32 v42, 0x3f803f80
    v_mov_b32 v43, 0x3f803f80
    s_waitcnt lgkmcnt(0)
    v_mfma_f32_16x16x32_bf16 v[72:75], v[44:47], v[28:31], v[72:75]
    v_mov_b32 v44, 0x3f003f00
    v_mov_b32 v45, 0x3f003f00
    v_mov_b32 v46, 0
    v_mov_b32 v47, 0
    v_max3_f32 v66, v32, v33, v34
    s_nop 0
    v_max3_f32 v67, v35, v68, v69
    v_max3_f32 v66, v66, v70, v71
    v_max3_f32 v67, v67, v72, v73
    v_max3_f32 v66, v66, v74, v75
    v_max_f32 v66, v66, v67
    v_max_f32 v67, v66, v67
    v_mov_b32 v36, 0
    v_mov_b32 v37, 0
    v_permlane32_swap_b32 v66, v67
    v_max_f32 v66, v66, v67
    v_max_f32 v67, v66, v67
    v_mov_b32 v38, 0
    v_mov_b32 v39, 0
    v_permlane16_swap_b32 v66, v67
    v_max_f32 v66, v66, v67
    v_mul_f32 v66, s82, v66
    v_pk_fma_f32 v[32:33], v[32:33], s[82:83], v[66:67] op_sel_hi:[1,1,0] neg_lo:[0,0,1] neg_hi:[0,0,1]
    v_pk_fma_f32 v[34:35], v[34:35], s[82:83], v[66:67] op_sel_hi:[1,1,0] neg_lo:[0,0,1] neg_hi:[0,0,1]
    v_pk_fma_f32 v[68:69], v[68:69], s[82:83], v[66:67] op_sel_hi:[1,1,0] neg_lo:[0,0,1] neg_hi:[0,0,1]
    v_pk_fma_f32 v[70:71], v[70:71], s[82:83], v[66:67] op_sel_hi:[1,1,0] neg_lo:[0,0,1] neg_hi:[0,0,1]
    v_pk_fma_f32 v[72:73], v[72:73], s[82:83], v[66:67] op_sel_hi:[1,1,0] neg_lo:[0,0,1] neg_hi:[0,0,1]
    v_pk_fma_f32 v[74:75], v[74:75], s[82:83], v[66:67] op_sel_hi:[1,1,0] neg_lo:[0,0,1] neg_hi:[0,0,1]
    v_exp_f32 v32, v32
    v_exp_f32 v33, v33
    v_exp_f32 v34, v34
    v_cvt_pk_bf16_f32 v24, v32, v33
    v_exp_f32 v35, v35
    v_exp_f32 v68, v68
    v_cvt_pk_bf16_f32 v25, v34, v35
    v_exp_f32 v69, v69
    v_exp_f32 v70, v70
    v_cvt_pk_bf16_f32 v26, v68, v69
    v_exp_f32 v71, v71
    v_exp_f32 v72, v72
    v_cvt_pk_bf16_f32 v27, v70, v71
    s_waitcnt vmcnt(7)
    v_exp_f32 v73, v73
    v_mfma_f32_16x16x32_bf16 v[32:35], v[40:43], v[24:27], 0
    v_exp_f32 v74, v74
    v_mfma_f32_16x16x32_bf16 v[52:55], v[76:79], v[24:27], 0
    v_exp_f32 v75, v75
    v_cvt_pk_bf16_f32 v28, v72, v73
    v_mfma_f32_16x16x32_bf16 v[56:59], v[48:51], v[24:27], 0
    v_cvt_pk_bf16_f32 v29, v74, v75
    s_nop 1
    v_mfma_f32_16x16x32_bf16 v[32:35], v[44:47], v[28:31], v[32:35]
    v_mfma_f32_16x16x32_bf16 v[52:55], v[60:63], v[28:31], v[52:55]
    v_mfma_f32_16x16x32_bf16 v[56:59], v[62:65], v[26:29], v[56:59]
    v_mov_b32 v68, 0
    v_mov_b32 v69, 0
    v_mov_b32 v70, 0
    v_rcp_f32 v66, v32
    v_mov_b32 v71, 0
    v_mov_b32 v72, 0
    v_pk_mul_f32 v[52:53], v[52:53], v[66:67] op_sel_hi:[1,0]
    v_pk_mul_f32 v[54:55], v[54:55], v[66:67] op_sel_hi:[1,0]
    v_cvt_pk_bf16_f32 v52, v52, v53
    v_cvt_pk_bf16_f32 v53, v54, v55
    ds_write_b64 v13, v[52:53]
    v_pk_mul_f32 v[56:57], v[56:57], v[66:67] op_sel_hi:[1,0]
    v_pk_mul_f32 v[58:59], v[58:59], v[66:67] op_sel_hi:[1,0]
    v_cvt_pk_bf16_f32 v56, v56, v57
    v_cvt_pk_bf16_f32 v57, v58, v59
    ds_write_b64 v13, v[56:57] offset:256
    v_mov_b32 v73, 0
    v_mov_b32 v74, 0
    v_mov_b32 v75, 0
    v_mov_b32 v40, 0
    v_mov_b32 v41, 0
    v_mov_b32 v42, 0
    v_mov_b32 v43, 0
    s_add_u32 s60, s65, 262144
    s_add_u32 s61, s65, 65536
    s_waitcnt lgkmcnt(0)
    s_barrier
    ds_read_b128 v[24:27], v8 offset:10240
    ds_read_b128 v[28:31], v8 offset:10752
    ds_read_b128 v[60:63], v8 offset:11264
    ds_read_b128 v[64:67], v8 offset:11776
    s_add_u32 s62, s65, 131072
    s_add_u32 s94, s65, 196608
    s_add_u32 s64, s64, 1
    s_add_u32 s71, s71, 262144
    s_mov_b32 s63, 200000
    s_waitcnt lgkmcnt(3)
    v_smfmac_f32_16x16x64_bf16 v[68:71], v[24:27], v[112:119], v2
    s_waitcnt lgkmcnt(2)
    v_smfmac_f32_16x16x64_bf16 v[68:71], v[28:31], v[120:127], v2
    s_waitcnt lgkmcnt(1)
    v_smfmac_f32_16x16x64_bf16 v[68:71], v[60:63], v[128:135], v2
    s_waitcnt lgkmcnt(0)
    v_smfmac_f32_16x16x64_bf16 v[68:71], v[64:67], v[136:143], v2
    v_smfmac_f32_16x16x64_bf16 v[72:75], v[24:27], v[144:151], v2
    v_smfmac_f32_16x16x64_bf16 v[72:75], v[28:31], v[152:159], v2
    v_smfmac_f32_16x16x64_bf16 v[72:75], v[60:63], v[160:167], v2
    v_cvt_pk_bf16_f32 v68, v68, v69
    v_cvt_pk_bf16_f32 v69, v70, v71
    v_smfmac_f32_16x16x64_bf16 v[72:75], v[64:67], v[168:175], v2
    v_or_b32 v68, 1, v68
    v_or_b32 v69, 1, v69
    v_smfmac_f32_16x16x64_bf16 v[36:39], v[24:27], v[176:183], v2
    buffer_store_dwordx2 v[68:69], v4, s[52:55], s65 offen
    v_smfmac_f32_16x16x64_bf16 v[36:39], v[28:31], v[184:191], v2
    v_cvt_pk_bf16_f32 v72, v72, v73
    v_cvt_pk_bf16_f32 v73, v74, v75
    v_smfmac_f32_16x16x64_bf16 v[36:39], v[60:63], v[192:199], v2
    v_or_b32 v72, 1, v72
    v_or_b32 v73, 1, v73
    v_smfmac_f32_16x16x64_bf16 v[36:39], v[64:67], v[200:207], v2
    buffer_store_dwordx2 v[72:73], v4, s[52:55], s61 offen
    v_smfmac_f32_16x16x64_bf16 v[40:43], v[24:27], v[208:215], v2
    v_smfmac_f32_16x16x64_bf16 v[40:43], v[28:31], v[216:223], v2
    v_smfmac_f32_16x16x64_bf16 v[40:43], v[60:63], v[224:231], v2
    v_cvt_pk_bf16_f32 v36, v36, v37
    v_cvt_pk_bf16_f32 v37, v38, v39
    v_smfmac_f32_16x16x64_bf16 v[40:43], v[64:67], v[232:239], v2
    v_or_b32 v36, 1, v36
    v_or_b32 v37, 1, v37
    v_mfma_f32_16x16x32_bf16 v[44:47], v[24:27], v[240:243], 0
    buffer_store_dwordx2 v[36:37], v4, s[52:55], s62 offen
    v_mfma_f32_16x16x32_bf16 v[44:47], v[28:31], v[244:247], v[44:47]
    v_cvt_pk_bf16_f32 v40, v40, v41
    v_cvt_pk_bf16_f32 v41, v42, v43
    v_mfma_f32_16x16x32_bf16 v[44:47], v[60:63], v[248:251], v[44:47]
    v_or_b32 v40, 1, v40
    v_or_b32 v41, 1, v41
    v_mfma_f32_16x16x32_bf16 v[44:47], v[64:67], v[252:255], v[44:47]
    buffer_store_dwordx2 v[40:41], v4, s[52:55], s94 offen
    s_nop 6
    v_cvt_pk_bf16_f32 v44, v44, v45
    v_cvt_pk_bf16_f32 v45, v46, v47
    v_or_b32 v44, 1, v44
    v_or_b32 v45, 1, v45
    s_mov_b64 exec, s[72:73]
    buffer_store_dwordx2 v[44:45], v4, s[52:55], s60 offen
    s_mov_b64 exec, -1
    s_cmp_eq_u32 s70, 0
    s_cbranch_scc1 R_nored1
    s_mov_b32 s60, s84
R_rdl1:
    s_cmp_eq_u32 s60, 0
    s_cbranch_scc1 R_rgo1
    s_sleep 1
    s_sub_u32 s60, s60, 1
    s_branch R_rdl1
R_rgo1:
    buffer_load_dwordx4 v[52:55], v5, s[52:55], s65 offen offset:0 sc1
    buffer_load_dwordx4 v[56:59], v5, s[52:55], s65 offen offset:1024 sc1
    buffer_load_dwordx4 v[76:79], v5, s[52:55], s65 offen offset:2048 sc1
    buffer_load_dwordx4 v[48:51], v5, s[52:55], s65 offen offset:3072 sc1
    v_mov_b32 v24, 0
    v_mov_b32 v25, 0
    v_mov_b32 v26, 0
    v_mov_b32 v27, 0
    v_mov_b32 v28, 0
    v_mov_b32 v29, 0
    v_mov_b32 v30, 0
    v_mov_b32 v31, 0
    v_mov_b32 v32, 0
    v_mov_b32 v33, 0
    v_mov_b32 v34, 0
    v_mov_b32 v35, 0
    v_cndmask_b32 v60, 0, v3, s[86:87]
    v_cndmask_b32 v61, 0, v3, s[88:89]
    v_cndmask_b32 v62, 0, v3, s[90:91]
    v_cndmask_b32 v63, 0, v3, s[92:93]
R_rp01:
    s_waitcnt vmcnt(3)
    v_mfma_f32_16x16x32_bf16 v[40:43], v[60:63], v[52:55], 0
    v_bitop3_b32 v64, v52, v53, v54 bitop3:0x80
    v_bitop3_b32 v64, v64, v55, v55 bitop3:0x80
    s_waitcnt vmcnt(2)
    v_mfma_f32_16x16x32_bf16 v[40:43], v[60:63], v[56:59], v[40:43]
    v_bitop3_b32 v64, v64, v56, v57 bitop3:0x80
    v_bitop3_b32 v64, v64, v58, v59 bitop3:0x80
    s_waitcnt vmcnt(1)
    v_mfma_f32_16x16x32_bf16 v[40:43], v[60:63], v[76:79], v[40:43]
    v_bitop3_b32 v64, v64, v76, v77 bitop3:0x80
    v_bitop3_b32 v64, v64, v78, v79 bitop3:0x80
    s_waitcnt vmcnt(0)
    v_mfma_f32_16x16x32_bf16 v[40:43], v[60:63], v[48:51], v[40:43]
    v_bitop3_b32 v64, v64, v48, v49 bitop3:0x80
    v_bitop3_b32 v64, v64, v50, v51 bitop3:0x80
    v_and_b32 v64, 1, v64
    v_cmp_ne_u32 vcc, 1, v64
    s_cbranch_vccnz R_rf01
R_rdone1:
    s_nop 0
    s_nop 0
    s_nop 0
    v_add_f32_dpp v64, v40, v40 row_ror:8 row_mask:0xf bank_mask:0xf
    v_add_f32_dpp v65, v41, v41 row_ror:8 row_mask:0xf bank_mask:0xf
    v_cvt_pk_bf16_f32 v64, v64, v65
    v_min_u32 v0, -2, v64
    buffer_store_dword v0, v6, s[52:55], s67 offen
    s_branch R_loop0
R_nored1:
    v_mov_b32 v24, 0
    v_mov_b32 v25, 0
    v_mov_b32 v26, 0
    v_mov_b32 v27, 0
    v_mov_b32 v28, 0
    v_mov_b32 v29, 0
    v_mov_b32 v30, 0
    v_mov_b32 v31, 0
    v_mov_b32 v32, 0
    v_mov_b32 v33, 0
    v_mov_b32 v34, 0
    v_mov_b32 v35, 0
    s_cmp_lg_u32 s56, 3
    s_cbranch_scc1 R_nkv1
    v_mov_b32 v15, s64
    s_cmp_ge_u32 s5, 64
    s_cbranch_scc1 R_nkv1
    s_waitcnt vmcnt(7)
    v_cmp_ne_u32 vcc, 4, v0
    s_ff1_i32_b64 s5, vcc
    s_cmp_lt_i32 s5, 0
    s_cselect_b32 s5, 64, s5
    s_cselect_b32 s3, 0x40000000, s3
    s_add_u32 s60, s64, 3
    s_min_u32 s60, s60, 64
    s_cmp_ge_u32 s5, s60
    s_cbranch_scc1 R_kv1_ok
    s_waitcnt vmcnt(0)
    s_lshl_b32 s61, s58, 8
    s_add_u32 s61, s61, 86573056
    v_lshrrev_b32 v0, 2, v7
    v_and_b32 v0, 255, v0
R_kv1_p:
    buffer_load_dword v64, v0, s[52:55], s61 offen sc1
    s_sub_u32 s63, s63, 1
    s_cbranch_scc1 M_abort
    s_waitcnt vmcnt(0)
    v_cmp_ne_u32 vcc, 4, v64
    s_ff1_i32_b64 s5, vcc
    s_cmp_lt_i32 s5, 0
    s_cselect_b32 s5, 64, s5
    s_cmp_ge_u32 s5, s60
    s_cbranch_scc1 R_kv1_ok
    s_sleep 4
    s_branch R_kv1_p
R_kv1_ok:
R_nkv1:
    s_sleep 9
    s_branch R_loop0x
R_rf01:
    buffer_load_dwordx4 v[52:55], v5, s[52:55], s65 offen offset:0 sc1
    buffer_load_dwordx4 v[56:59], v5, s[52:55], s65 offen offset:1024 sc1
    buffer_load_dwordx4 v[76:79], v5, s[52:55], s65 offen offset:2048 sc1
    buffer_load_dwordx4 v[48:51], v5, s[52:55], s65 offen offset:3072 sc1
    s_sub_u32 s63, s63, 1
    s_cbranch_scc1 M_abort
    s_branch R_rp01
R_cf1:
    buffer_load_dwordx4 v[36:39], v1, s[52:55], s61 offen sc1
    buffer_load_dwordx4 v[40:43], v1, s[52:55], s60 offen offset:1024 sc1
    s_sub_u32 s63, s63, 1
    s_cbranch_scc1 M_abort
    s_waitcnt vmcnt(3)
    ds_write_b128 v1, v[44:47] offset:47104
    v_max3_u32 v0, v44, v45, v46
    s_waitcnt vmcnt(2)
    ds_write_b128 v1, v[48:51] offset:48128
    v_max3_u32 v0, v0, v47, v48
    v_max3_u32 v0, v0, v49, v50
    v_max_u32 v0, v0, v51
    v_cmp_eq_u32 vcc, -1, v0
    s_cbranch_vccz R_cok1
    buffer_load_dwordx4 v[44:47], v1, s[52:55], s61 offen sc1
    buffer_load_dwordx4 v[48:51], v1, s[52:55], s60 offen offset:1024 sc1
    s_sub_u32 s63, s63, 1
    s_cbranch_scc1 M_abort
    s_branch R_cp1
R_cok1:
    s_waitcnt vmcnt(0)
    s_branch R_cdj1
R_slow1:
    s_sub_u32 s97, s69, 98304
    s_waitcnt lgkmcnt(0)
    s_nop 7
    v_mov_b32 v24, 0
    v_mov_b32 v25, 0
    v_mov_b32 v26, 0
    v_mov_b32 v27, 0
    v_mov_b32 v28, 0
    v_mov_b32 v29, 0
    v_mov_b32 v30, 0
    v_mov_b32 v31, 0
    v_mov_b32 v32, 0
    v_mov_b32 v33, 0
    v_mov_b32 v34, 0
    v_mov_b32 v35, 0
    ds_read_b128 v[52:55], v9 offset:0
    ds_read_b128 v[56:59], v9 offset:1024
    ds_read_b128 v[60:63], v9 offset:2048
    ds_read_b128 v[64:67], v9 offset:3072
R_sp0_1:
    buffer_load_dwordx4 v[36:39], v8, s[52:55], s97 offen sc1
    buffer_load_dwordx4 v[40:43], v8, s[52:55], s97 offen offset:512 sc1
    s_sub_u32 s63, s63, 1
    s_cbranch_scc1 M_abort
    s_waitcnt vmcnt(0) lgkmcnt(0)
    v_max3_u32 v0, v36, v37, v38
    v_max3_u32 v0, v0, v39, v40
    v_max3_u32 v0, v0, v41, v42
    v_max_u32 v0, v0, v43
    v_cmp_eq_u32 vcc, -1, v0
    s_cbranch_vccnz R_sp0_1
    v_smfmac_f32_16x16x64_bf16 v[24:27], v[36:39], a[0:7], v2
    v_smfmac_f32_16x16x64_bf16 v[28:31], v[36:39], a[144:151], v2
    v_smfmac_f32_16x16x64_bf16 v[32:35], v[36:39], v[52:59], v2
    v_smfmac_f32_16x16x64_bf16 v[24:27], v[40:43], a[8:15], v2
    v_smfmac_f32_16x16x64_bf16 v[28:31], v[40:43], a[152:159], v2
    v_smfmac_f32_16x16x64_bf16 v[32:35], v[40:43], v[60:67], v2
    s_add_u32 s97, s97, 1024
    ds_read_b128 v[52:55], v9 offset:4096
    ds_read_b128 v[56:59], v9 offset:5120
    ds_read_b128 v[60:63], v9 offset:6144
    ds_read_b128 v[64:67], v9 offset:7168
R_sp1_1:
    buffer_load_dwordx4 v[36:39], v8, s[52:55], s97 offen sc1
    buffer_load_dwordx4 v[40:43], v8, s[52:55], s97 offen offset:512 sc1
    s_sub_u32 s63, s63, 1
    s_cbranch_scc1 M_abort
    s_waitcnt vmcnt(0) lgkmcnt(0)
    v_max3_u32 v0, v36, v37, v38
    v_max3_u32 v0, v0, v39, v40
    v_max3_u32 v0, v0, v41, v42
    v_max_u32 v0, v0, v43
    v_cmp_eq_u32 vcc, -1, v0
    s_cbranch_vccnz R_sp1_1
    v_smfmac_f32_16x16x64_bf16 v[24:27], v[36:39], a[16:23], v2
    v_smfmac_f32_16x16x64_bf16 v[28:31], v[36:39], a[160:167], v2
    v_smfmac_f32_16x16x64_bf16 v[32:35], v[36:39], v[52:59], v2
    v_smfmac_f32_16x16x64_bf16 v[24:27], v[40:43], a[24:31], v2
    v_smfmac_f32_16x16x64_bf16 v[28:31], v[40:43], a[168:175], v2
    v_smfmac_f32_16x16x64_bf16 v[32:35], v[40:43], v[60:67], v2
    s_add_u32 s97, s97, 1024
    ds_read_b128 v[52:55], v9 offset:8192
    ds_read_b128 v[56:59], v9 offset:9216
    ds_read_b128 v[60:63], v9 offset:10240
    ds_read_b128 v[64:67], v9 offset:11264
R_sp2_1:
    buffer_load_dwordx4 v[36:39], v8, s[52:55], s97 offen sc1
    buffer_load_dwordx4 v[40:43], v8, s[52:55], s97 offen offset:512 sc1
    s_sub_u32 s63, s63, 1
    s_cbranch_scc1 M_abort
    s_waitcnt vmcnt(0) lgkmcnt(0)
    v_max3_u32 v0, v36, v37, v38
    v_max3_u32 v0, v0, v39, v40
    v_max3_u32 v0, v0, v41, v42
    v_max_u32 v0, v0, v43
    v_cmp_eq_u32 vcc, -1, v0
    s_cbranch_vccnz R_sp2_1
    v_smfmac_f32_16x16x64_bf16 v[24:27], v[36:39], a[32:39], v2
    v_smfmac_f32_16x16x64_bf16 v[28:31], v[36:39], a[176:183], v2
    v_smfmac_f32_16x16x64_bf16 v[32:35], v[36:39], v[52:59], v2
    v_smfmac_f32_16x16x64_bf16 v[24:27], v[40:43], a[40:47], v2
    v_smfmac_f32_16x16x64_bf16 v[28:31], v[40:43], a[184:191], v2
    v_smfmac_f32_16x16x64_bf16 v[32:35], v[40:43], v[60:67], v2
    s_add_u32 s97, s97, 1024
    ds_read_b128 v[52:55], v9 offset:12288
    ds_read_b128 v[56:59], v9 offset:13312
    ds_read_b128 v[60:63], v9 offset:14336
    ds_read_b128 v[64:67], v9 offset:15360
R_sp3_1:
    buffer_load_dwordx4 v[36:39], v8, s[52:55], s97 offen sc1
    buffer_load_dwordx4 v[40:43], v8, s[52:55], s97 offen offset:512 sc1
    s_sub_u32 s63, s63, 1
    s_cbranch_scc1 M_abort
    s_waitcnt vmcnt(0) lgkmcnt(0)
    v_max3_u32 v0, v36, v37, v38
    v_max3_u32 v0, v0, v39, v40
    v_max3_u32 v0, v0, v41, v42
    v_max_u32 v0, v0, v43
    v_cmp_eq_u32 vcc, -1, v0
    s_cbranch_vccnz R_sp3_1
    v_smfmac_f32_16x16x64_bf16 v[24:27], v[36:39], a[48:55], v2
    v_smfmac_f32_16x16x64_bf16 v[28:31], v[36:39], a[192:199], v2
    v_smfmac_f32_16x16x64_bf16 v[32:35], v[36:39], v[52:59], v2
    v_smfmac_f32_16x16x64_bf16 v[24:27], v[40:43], a[56:63], v2
    v_smfmac_f32_16x16x64_bf16 v[28:31], v[40:43], a[200:207], v2
    v_smfmac_f32_16x16x64_bf16 v[32:35], v[40:43], v[60:67], v2
    s_add_u32 s97, s97, 1024
    ds_read_b128 v[52:55], v9 offset:16384
    ds_read_b128 v[56:59], v9 offset:17408
    ds_read_b128 v[60:63], v9 offset:18432
    ds_read_b128 v[64:67], v9 offset:19456
R_sp4_1:
    buffer_load_dwordx4 v[36:39], v8, s[52:55], s97 offen sc1
    buffer_load_dwordx4 v[40:43], v8, s[52:55], s97 offen offset:512 sc1
    s_sub_u32 s63, s63, 1
    s_cbranch_scc1 M_abort
    s_waitcnt vmcnt(0) lgkmcnt(0)
    v_max3_u32 v0, v36, v37, v38
    v_max3_u32 v0, v0, v39, v40
    v_max3_u32 v0, v0, v41, v42
    v_max_u32 v0, v0, v43
    v_cmp_eq_u32 vcc, -1, v0
    s_cbranch_vccnz R_sp4_1
    v_smfmac_f32_16x16x64_bf16 v[24:27], v[36:39], a[64:71], v2
    v_smfmac_f32_16x16x64_bf16 v[28:31], v[36:39], a[208:215], v2
    v_smfmac_f32_16x16x64_bf16 v[32:35], v[36:39], v[52:59], v2
    v_smfmac_f32_16x16x64_bf16 v[24:27], v[40:43], a[72:79], v2
    v_smfmac_f32_16x16x64_bf16 v[28:31], v[40:43], a[216:223], v2
    v_smfmac_f32_16x16x64_bf16 v[32:35], v[40:43], v[60:67], v2
    s_add_u32 s97, s97, 1024
    ds_read_b128 v[52:55], v9 offset:20480
    ds_read_b128 v[56:59], v9 offset:21504
    ds_read_b128 v[60:63], v9 offset:22528
    ds_read_b128 v[64:67], v9 offset:23552
R_sp5_1:
    buffer_load_dwordx4 v[36:39], v8, s[52:55], s97 offen sc1
    buffer_load_dwordx4 v[40:43], v8, s[52:55], s97 offen offset:512 sc1
    s_sub_u32 s63, s63, 1
    s_cbranch_scc1 M_abort
    s_waitcnt vmcnt(0) lgkmcnt(0)
    v_max3_u32 v0, v36, v37, v38
    v_max3_u32 v0, v0, v39, v40
    v_max3_u32 v0, v0, v41, v42
    v_max_u32 v0, v0, v43
    v_cmp_eq_u32 vcc, -1, v0
    s_cbranch_vccnz R_sp5_1
    v_smfmac_f32_16x16x64_bf16 v[24:27], v[36:39], a[80:87], v2
    v_smfmac_f32_16x16x64_bf16 v[28:31], v[36:39], a[224:231], v2
    v_smfmac_f32_16x16x64_bf16 v[32:35], v[36:39], v[52:59], v2
    v_smfmac_f32_16x16x64_bf16 v[24:27], v[40:43], a[88:95], v2
    v_smfmac_f32_16x16x64_bf16 v[28:31], v[40:43], a[232:239], v2
    v_smfmac_f32_16x16x64_bf16 v[32:35], v[40:43], v[60:67], v2
    s_add_u32 s97, s97, 1024
    ds_read_b128 v[52:55], v9 offset:24576
    ds_read_b128 v[56:59], v9 offset:25600
    ds_read_b128 v[60:63], v9 offset:26624
    ds_read_b128 v[64:67], v9 offset:27648
R_sp6_1:
    buffer_load_dwordx4 v[36:39], v8, s[52:55], s97 offen sc1
    buffer_load_dwordx4 v[40:43], v8, s[52:55], s97 offen offset:512 sc1
    s_sub_u32 s63, s63, 1
    s_cbranch_scc1 M_abort
    s_waitcnt vmcnt(0) lgkmcnt(0)
    v_max3_u32 v0, v36, v37, v38
    v_max3_u32 v0, v0, v39, v40
    v_max3_u32 v0, v0, v41, v42
    v_max_u32 v0, v0, v43
    v_cmp_eq_u32 vcc, -1, v0
    s_cbranch_vccnz R_sp6_1
    v_smfmac_f32_16x16x64_bf16 v[24:27], v[36:39], a[96:103], v2
    v_smfmac_f32_16x16x64_bf16 v[28:31], v[36:39], a[240:247], v2
    v_smfmac_f32_16x16x64_bf16 v[32:35], v[36:39], v[52:59], v2
    v_smfmac_f32_16x16x64_bf16 v[24:27], v[40:43], a[104:111], v2
    v_smfmac_f32_16x16x64_bf16 v[28:31], v[40:43], a[248:255], v2
    v_smfmac_f32_16x16x64_bf16 v[32:35], v[40:43], v[60:67], v2
    s_add_u32 s97, s97, 1024
    ds_read_b128 v[52:55], v9 offset:28672
    ds_read_b128 v[56:59], v9 offset:29696
    ds_read_b128 v[60:63], v9 offset:30720
    ds_read_b128 v[64:67], v9 offset:31744
R_sp7_1:
    buffer_load_dwordx4 v[36:39], v8, s[52:55], s97 offen sc1
    buffer_load_dwordx4 v[40:43], v8, s[52:55], s97 offen offset:512 sc1
    s_sub_u32 s63, s63, 1
    s_cbranch_scc1 M_abort
    s_waitcnt vmcnt(0) lgkmcnt(0)
    v_max3_u32 v0, v36, v37, v38
    v_max3_u32 v0, v0, v39, v40
    v_max3_u32 v0, v0, v41, v42
    v_max_u32 v0, v0, v43
    v_cmp_eq_u32 vcc, -1, v0
    s_cbranch_vccnz R_sp7_1
    v_smfmac_f32_16x16x64_bf16 v[24:27], v[36:39], a[112:119], v2
    v_smfmac_f32_16x16x64_bf16 v[28:31], v[36:39], v[80:87], v2
    v_smfmac_f32_16x16x64_bf16 v[32:35], v[36:39], v[52:59], v2
    v_smfmac_f32_16x16x64_bf16 v[24:27], v[40:43], a[120:127], v2
    v_smfmac_f32_16x16x64_bf16 v[28:31], v[40:43], v[88:95], v2
    v_smfmac_f32_16x16x64_bf16 v[32:35], v[40:43], v[60:67], v2
    s_add_u32 s97, s97, 1024
    ds_read_b128 v[52:55], v9 offset:32768
    ds_read_b128 v[56:59], v9 offset:33792
R_sp8_1:
    buffer_load_dwordx4 v[36:39], v8, s[52:55], s97 offen sc1
    buffer_load_dwordx4 v[40:43], v8, s[52:55], s97 offen offset:512 sc1
    s_sub_u32 s63, s63, 1
    s_cbranch_scc1 M_abort
    s_waitcnt vmcnt(0) lgkmcnt(0)
    v_max3_u32 v0, v36, v37, v38
    v_max3_u32 v0, v0, v39, v40
    v_max3_u32 v0, v0, v41, v42
    v_max_u32 v0, v0, v43
    v_cmp_eq_u32 vcc, -1, v0
    s_cbranch_vccnz R_sp8_1
    v_smfmac_f32_16x16x64_bf16 v[24:27], v[36:39], a[128:135], v2
    v_smfmac_f32_16x16x64_bf16 v[28:31], v[36:39], v[96:103], v2
    v_smfmac_f32_16x16x64_bf16 v[32:35], v[36:39], v[52:59], v2
    v_smfmac_f32_16x16x64_bf16 v[24:27], v[40:43], a[136:143], v2
    v_smfmac_f32_16x16x64_bf16 v[28:31], v[40:43], v[104:111], v2
    v_smfmac_f32_16x16x64_bf16 v[32:35], v[40:43], v[16:23], v2
    s_add_u32 s97, s97, 1024
    s_nop 7
    v_cvt_pk_bf16_f32 v24, v24, v25
    v_cvt_pk_bf16_f32 v25, v26, v27
    ds_write_b64 v10, v[24:25]
    v_cvt_pk_bf16_f32 v36, v28, v29
    v_cvt_pk_bf16_f32 v37, v30, v31
    ds_write_b64 v10, v[36:37] offset:36864
    ds_read_b128 v[52:55], v12 offset:58368
    ds_read_b128 v[56:59], v12 offset:58496
    ds_read_b128 v[60:63], v12 offset:60416
    ds_read_b128 v[64:67], v12 offset:60544
    s_waitcnt lgkmcnt(0)
    s_branch R_slowret1
R_loopS0:
R_loopS0x:
    s_mov_b32 s94, s69
    s_mov_b32 s69, s67
    s_mov_b32 s67, s68
    s_mov_b32 s68, s94
    s_mov_b32 s63, 200000
    s_sub_u32 s60, s69, 98304
    s_mov_b32 s61, s60
    s_add_u32 s62, s60, 4096
    s_add_u32 s94, s60, s66
    s_add_u32 s95, s71, 1998848
    s_add_u32 m0, s85, 149504
    ds_read_b128 v[52:55], v9 offset:0
    ds_read_b128 v[56:59], v9 offset:1024
    ds_read_b128 v[60:63], v9 offset:2048
    ds_read_b128 v[64:67], v9 offset:3072
    ds_read_b128 v[68:71], v9 offset:4096
    ds_read_b128 v[72:75], v9 offset:5120
    s_cmp_lt_u32 s56, 2
    s_cbranch_scc1 R_cdjS0
    s_sleep 1
    buffer_load_dwordx4 v[36:39], v1, s[52:55], s61 offen sc1
    buffer_load_dwordx4 v[40:43], v1, s[52:55], s60 offen offset:1024 sc1
    s_sleep 2
    buffer_load_dwordx4 v[44:47], v1, s[52:55], s61 offen sc1
    buffer_load_dwordx4 v[48:51], v1, s[52:55], s60 offen offset:1024 sc1
R_cpS0:
    s_waitcnt vmcnt(3)
    ds_write_b128 v1, v[36:39] offset:47104
    v_max3_u32 v0, v36, v37, v38
    s_waitcnt vmcnt(2)
    ds_write_b128 v1, v[40:43] offset:48128
    v_max3_u32 v0, v0, v39, v40
    v_max3_u32 v0, v0, v41, v42
    v_max_u32 v0, v0, v43
    v_cmp_eq_u32 vcc, -1, v0
    s_cbranch_vccnz R_cfS0
R_cdjS0:
    s_waitcnt lgkmcnt(0)
    s_barrier
    ds_read_b128 v[36:39], v8 offset:47104
    ds_read_b128 v[40:43], v8 offset:47616
    s_waitcnt vmcnt(0)
    ds_read_b128 v[44:47], v8 offset:48128
    ds_read_b128 v[48:51], v8 offset:48640
    s_waitcnt lgkmcnt(3)
    v_smfmac_f32_16x16x64_bf16 v[24:27], v[36:39], a[0:7], v2
    v_smfmac_f32_16x16x64_bf16 v[28:31], v[36:39], a[144:151], v2
    v_smfmac_f32_16x16x64_bf16 v[32:35], v[36:39], v[52:59], v2
    ds_read_b128 v[52:55], v9 offset:6144
    ds_read_b128 v[56:59], v9 offset:7168
    ds_read_b128 v[36:39], v8 offset:49152
    s_waitcnt lgkmcnt(5)
    v_smfmac_f32_16x16x64_bf16 v[24:27], v[40:43], a[8:15], v2
    buffer_load_dwordx4 v7, s[52:55], s62 offen sc1 lds
    v_smfmac_f32_16x16x64_bf16 v[28:31], v[40:43], a[152:159], v2
    s_add_u32 m0, s85, 154624
    v_smfmac_f32_16x16x64_bf16 v[32:35], v[40:43], v[60:67], v2
    ds_read_b128 v[60:63], v9 offset:8192
    ds_read_b128 v[64:67], v9 offset:9216
    ds_read_b128 v[40:43], v8 offset:49664
    s_waitcnt lgkmcnt(7)
    v_smfmac_f32_16x16x64_bf16 v[24:27], v[44:47], a[16:23], v2
    buffer_load_dwordx4 v7, s[52:55], s95 offen sc1 lds
    v_smfmac_f32_16x16x64_bf16 v[28:31], v[44:47], a[160:167], v2
    s_add_u32 m0, s85, 158720
    s_add_u32 s95, s95, 4096
    v_smfmac_f32_16x16x64_bf16 v[32:35], v[44:47], v[68:75], v2
    ds_read_b128 v[68:71], v9 offset:10240
    ds_read_b128 v[72:75], v9 offset:11264
    ds_read_b128 v[44:47], v8 offset:50176
    s_waitcnt lgkmcnt(9)
    v_smfmac_f32_16x16x64_bf16 v[24:27], v[48:51], a[24:31], v2
    buffer_load_dwordx4 v7, s[52:55], s95 offen sc1 lds
    v_smfmac_f32_16x16x64_bf16 v[28:31], v[48:51], a[168:175], v2
    s_mov_b32 m0, s57
    s_add_u32 s60, s71, 18874368
    s_waitcnt lgkmcnt(7)
    v_smfmac_f32_16x16x64_bf16 v[32:35], v[48:51], v[52:59], v2
    ds_read_b128 v[52:55], v9 offset:12288
    ds_read_b128 v[56:59], v9 offset:13312
    ds_read_b128 v[48:51], v8 offset:50688
    s_waitcnt lgkmcnt(9)
    v_smfmac_f32_16x16x64_bf16 v[24:27], v[36:39], a[32:39], v2
    v_smfmac_f32_16x16x64_bf16 v[28:31], v[36:39], a[176:183], v2
    s_waitcnt lgkmcnt(7)
    v_smfmac_f32_16x16x64_bf16 v[32:35], v[36:39], v[60:67], v2
    ds_read_b128 v[60:63], v9 offset:14336
    ds_read_b128 v[64:67], v9 offset:15360
    s_waitcnt lgkmcnt(8)
    v_smfmac_f32_16x16x64_bf16 v[24:27], v[40:43], a[40:47], v2
    v_smfmac_f32_16x16x64_bf16 v[28:31], v[40:43], a[184:191], v2
    s_waitcnt lgkmcnt(6)
    v_smfmac_f32_16x16x64_bf16 v[32:35], v[40:43], v[68:75], v2
    ds_read_b128 v[68:71], v9 offset:16384
    ds_read_b128 v[72:75], v9 offset:17408
    s_waitcnt lgkmcnt(7)
    v_smfmac_f32_16x16x64_bf16 v[24:27], v[44:47], a[48:55], v2
    v_smfmac_f32_16x16x64_bf16 v[28:31], v[44:47], a[192:199], v2
    s_waitcnt vmcnt(2)
    s_barrier
    ds_read_b128 v[36:39], v8 offset:51200
    ds_read_b128 v[40:43], v8 offset:51712
    s_waitcnt lgkmcnt(7)
    v_smfmac_f32_16x16x64_bf16 v[32:35], v[44:47], v[52:59], v2
    ds_read_b128 v[52:55], v9 offset:18432
    ds_read_b128 v[56:59], v9 offset:19456
    ds_read_b128 v[44:47], v8 offset:52224
    s_waitcnt lgkmcnt(9)
    v_smfmac_f32_16x16x64_bf16 v[24:27], v[48:51], a[56:63], v2
    buffer_load_dwordx4 v7, s[52:55], s94 offen sc1 lds
    v_smfmac_f32_16x16x64_bf16 v[28:31], v[48:51], a[200:207], v2
    s_waitcnt lgkmcnt(7)
    v_smfmac_f32_16x16x64_bf16 v[32:35], v[48:51], v[60:67], v2
    ds_read_b128 v[60:63], v9 offset:20480
    ds_read_b128 v[64:67], v9 offset:21504
    ds_read_b128 v[48:51], v8 offset:52736
    s_waitcnt lgkmcnt(7)
    v_smfmac_f32_16x16x64_bf16 v[24:27], v[36:39], a[64:71], v2
    buffer_load_dwordx4 v[76:79], v14, s[52:55], s60 offen sc1
    v_smfmac_f32_16x16x64_bf16 v[28:31], v[36:39], a[208:215], v2
    s_lshr_b32 s62, s71, 1
    v_smfmac_f32_16x16x64_bf16 v[32:35], v[36:39], v[68:75], v2
    ds_read_b128 v[68:71], v9 offset:22528
    ds_read_b128 v[72:75], v9 offset:23552
    ds_read_b128 v[36:39], v8 offset:53248
    s_waitcnt lgkmcnt(9)
    v_smfmac_f32_16x16x64_bf16 v[24:27], v[40:43], a[72:79], v2
    v_smfmac_f32_16x16x64_bf16 v[28:31], v[40:43], a[216:223], v2
    s_add_u32 s61, s62, 52396032
    s_add_u32 s95, s62, 52393984
    s_waitcnt lgkmcnt(7)
    v_smfmac_f32_16x16x64_bf16 v[32:35], v[40:43], v[52:59], v2
    ds_read_b128 v[52:55], v9 offset:24576
    ds_read_b128 v[56:59], v9 offset:25600
    ds_read_b128 v[40:43], v8 offset:53760
    s_waitcnt lgkmcnt(9)
    v_smfmac_f32_16x16x64_bf16 v[24:27], v[44:47], a[80:87], v2
    v_smfmac_f32_16x16x64_bf16 v[28:31], v[44:47], a[224:231], v2
    s_add_u32 s94, s71, s80
    s_add_u32 s62, s94, 16777216
    s_waitcnt lgkmcnt(7)
    v_smfmac_f32_16x16x64_bf16 v[32:35], v[44:47], v[60:67], v2
    ds_read_b128 v[60:63], v9 offset:26624
    ds_read_b128 v[64:67], v9 offset:27648
    ds_read_b128 v[44:47], v8 offset:54272
    s_waitcnt lgkmcnt(9)
    v_smfmac_f32_16x16x64_bf16 v[24:27], v[48:51], a[88:95], v2
    v_smfmac_f32_16x16x64_bf16 v[28:31], v[48:51], a[232:239], v2
    s_waitcnt lgkmcnt(7)
    v_smfmac_f32_16x16x64_bf16 v[32:35], v[48:51], v[68:75], v2
    ds_read_b128 v[68:71], v9 offset:28672
    ds_read_b128 v[72:75], v9 offset:29696
    buffer_load_dwordx4 v[48:51], v14, s[52:55], s60 offen offset:256 sc1
    s_waitcnt lgkmcnt(8)
    v_smfmac_f32_16x16x64_bf16 v[24:27], v[36:39], a[96:103], v2
    s_cmp_eq_u32 s70, 0
    s_cselect_b32 s97, 0x40000000, s68
    v_smfmac_f32_16x16x64_bf16 v[28:31], v[36:39], a[240:247], v2
    s_waitcnt lgkmcnt(6)
    v_smfmac_f32_16x16x64_bf16 v[32:35], v[36:39], v[52:59], v2
    ds_read_b128 v[52:55], v9 offset:30720
    ds_read_b128 v[56:59], v9 offset:31744
    ds_read_b128 v[36:39], v8 offset:54784
    s_waitcnt lgkmcnt(8)
    v_smfmac_f32_16x16x64_bf16 v[24:27], v[40:43], a[104:111], v2
    buffer_store_dword v15, v6, s[52:55], s97 offen sc1
    v_smfmac_f32_16x16x64_bf16 v[28:31], v[40:43], a[248:255], v2
    s_waitcnt vmcnt(3)
    s_barrier
    s_waitcnt lgkmcnt(6)
    v_smfmac_f32_16x16x64_bf16 v[32:35], v[40:43], v[60:67], v2
    ds_read_b128 v[60:63], v9 offset:32768
    ds_read_b128 v[64:67], v9 offset:33792
    ds_read_b128 v[40:43], v8 offset:55296
    s_waitcnt lgkmcnt(8)
    v_smfmac_f32_16x16x64_bf16 v[24:27], v[44:47], a[112:119], v2
    buffer_load_dword v0, v5, s[52:55], s94 offen sc1
    v_smfmac_f32_16x16x64_bf16 v[28:31], v[44:47], v[80:87], v2
    s_waitcnt lgkmcnt(6)
    v_smfmac_f32_16x16x64_bf16 v[32:35], v[44:47], v[68:75], v2
    ds_read_b128 v[44:47], v8 offset:55808
    ds_read_b128 v[68:71], v12 offset:56320
    ds_read_b128 v[72:75], v12 offset:56448
    s_waitcnt lgkmcnt(6)
    v_smfmac_f32_16x16x64_bf16 v[24:27], v[36:39], a[120:127], v2
    buffer_load_dword v0, v5, s[52:55], s62 offen sc1
    v_smfmac_f32_16x16x64_bf16 v[28:31], v[36:39], v[88:95], v2
    v_smfmac_f32_16x16x64_bf16 v[32:35], v[36:39], v[52:59], v2
    ds_read_b128 v[52:55], v12 offset:58368
    ds_read_b128 v[56:59], v12 offset:58496
    s_waitcnt lgkmcnt(5)
    v_smfmac_f32_16x16x64_bf16 v[24:27], v[40:43], a[128:135], v2
    buffer_store_dword v15, off, s[52:55], s4 sc1
    v_smfmac_f32_16x16x64_bf16 v[28:31], v[40:43], v[96:103], v2
    s_waitcnt lgkmcnt(4)
    v_smfmac_f32_16x16x64_bf16 v[24:27], v[44:47], a[136:143], v2
    buffer_load_dword v0, v6, s[52:55], s3 offen sc1
    v_smfmac_f32_16x16x64_bf16 v[28:31], v[44:47], v[104:111], v2
    v_smfmac_f32_16x16x64_bf16 v[32:35], v[40:43], v[60:67], v2
    s_nop 2
    v_cvt_pk_bf16_f32 v24, v24, v25
    v_cvt_pk_bf16_f32 v25, v26, v27
    ds_write_b64 v10, v[24:25]
    v_cvt_pk_bf16_f32 v36, v28, v29
    v_cvt_pk_bf16_f32 v37, v30, v31
    ds_write_b64 v10, v[36:37] offset:36864
    v_smfmac_f32_16x16x64_bf16 v[32:35], v[44:47], v[16:23], v2
    ds_read_b128 v[60:63], v12 offset:60416
    ds_read_b128 v[64:67], v12 offset:60544
    v_cmp_u_f32 vcc, v28, v29
    v_cmp_u_f32 s[96:97], v30, v31
    s_or_b64 vcc, vcc, s[96:97]
    s_cbranch_vccnz R_slowS0
R_slowretS0:
    s_waitcnt lgkmcnt(2)
    s_barrier
    ds_read_b64_tr_b16 v[24:25], v11 offset:0
    ds_read_b64_tr_b16 v[26:27], v11 offset:128
    ds_read_b64_tr_b16 v[40:41], v11 offset:36864
    ds_read_b64_tr_b16 v[42:43], v11 offset:36992
    ds_read_b64_tr_b16 v[28:29], v11 offset:512
    ds_read_b64_tr_b16 v[30:31], v11 offset:640
    ds_read_b64_tr_b16 v[44:45], v11 offset:37376
    ds_read_b64_tr_b16 v[46:47], v11 offset:37504
    v_cvt_pk_bf16_f32 v38, v32, v33
    v_cvt_pk_bf16_f32 v39, v34, v35
    s_waitcnt lgkmcnt(6)
    v_mfma_f32_16x16x32_bf16 v[32:35], v[68:71], v[24:27], 0
    buffer_store_dwordx2 v[36:37], v10, s[52:55], s95 offen sc1
    v_mfma_f32_16x16x32_bf16 v[68:71], v[72:75], v[24:27], 0
    s_waitcnt lgkmcnt(4)
    v_mfma_f32_16x16x32_bf16 v[72:75], v[40:43], v[24:27], 0
    ds_read_b64_tr_b16 v[24:25], v11 offset:1024
    ds_read_b64_tr_b16 v[26:27], v11 offset:1152
    ds_read_b64_tr_b16 v[40:41], v11 offset:37888
    ds_read_b64_tr_b16 v[42:43], v11 offset:38016
    s_waitcnt lgkmcnt(6)
    v_mfma_f32_16x16x32_bf16 v[32:35], v[52:55], v[28:31], v[32:35]
    ds_read_b128 v[52:55], v12 offset:62464
    v_mfma_f32_16x16x32_bf16 v[68:71], v[56:59], v[28:31], v[68:71]
    ds_read_b128 v[56:59], v12 offset:62592
    buffer_store_dwordx2 v[38:39], v10, s[52:55], s61 offen sc1
    s_waitcnt lgkmcnt(6)
    v_mfma_f32_16x16x32_bf16 v[72:75], v[44:47], v[28:31], v[72:75]
    ds_read_b64_tr_b16 v[28:29], v11 offset:1536
    ds_read_b64_tr_b16 v[30:31], v11 offset:1664
    ds_read_b64_tr_b16 v[44:45], v11 offset:38400
    ds_read_b64_tr_b16 v[46:47], v11 offset:38528
    s_waitcnt lgkmcnt(8)
    v_mfma_f32_16x16x32_bf16 v[32:35], v[60:63], v[24:27], v[32:35]
    v_cndmask_b32 v60, 0, v38, s[72:73]
    v_cndmask_b32 v61, 0, v39, s[72:73]
    v_mfma_f32_16x16x32_bf16 v[68:71], v[64:67], v[24:27], v[68:71]
    v_mov_b32 v62, 0
    v_mov_b32 v63, 0
    s_waitcnt lgkmcnt(6)
    v_mfma_f32_16x16x32_bf16 v[72:75], v[40:43], v[24:27], v[72:75]
    v_cndmask_b32 v64, 0, v38, s[74:75]
    v_cndmask_b32 v65, 0, v39, s[74:75]
    s_waitcnt lgkmcnt(2)
    v_mfma_f32_16x16x32_bf16 v[32:35], v[52:55], v[28:31], v[32:35]
    v_mov_b32 v40, 0x3f803f80
    v_mov_b32 v41, 0x3f803f80
    v_mfma_f32_16x16x32_bf16 v[68:71], v[56:59], v[28:31], v[68:71]
    v_mov_b32 v42, 0x3f803f80
    v_mov_b32 v43, 0x3f803f80
    s_waitcnt lgkmcnt(0)
    v_mfma_f32_16x16x32_bf16 v[72:75], v[44:47], v[28:31], v[72:75]
    v_mov_b32 v44, 0x3f003f00
    v_mov_b32 v45, 0x3f003f00
    v_mov_b32 v46, 0
    v_mov_b32 v47, 0
    v_max3_f32 v66, v32, v33, v34
    s_nop 0
    v_max3_f32 v67, v35, v68, v69
    v_max3_f32 v66, v66, v70, v71
    v_max3_f32 v67, v67, v72, v73
    v_max3_f32 v66, v66, v74, v75
    v_max_f32 v66, v66, v67
    v_max_f32 v67, v66, v67
    v_mov_b32 v36, 0
    v_mov_b32 v37, 0
    v_permlane32_swap_b32 v66, v67
    v_max_f32 v66, v66, v67
    v_max_f32 v67, v66, v67
    v_mov_b32 v38, 0
    v_mov_b32 v39, 0
    v_permlane16_swap_b32 v66, v67
    v_max_f32 v66, v66, v67
    v_mul_f32 v66, s82, v66
    v_pk_fma_f32 v[32:33], v[32:33], s[82:83], v[66:67] op_sel_hi:[1,1,0] neg_lo:[0,0,1] neg_hi:[0,0,1]
    v_pk_fma_f32 v[34:35], v[34:35], s[82:83], v[66:67] op_sel_hi:[1,1,0] neg_lo:[0,0,1] neg_hi:[0,0,1]
    v_pk_fma_f32 v[68:69], v[68:69], s[82:83], v[66:67] op_sel_hi:[1,1,0] neg_lo:[0,0,1] neg_hi:[0,0,1]
    v_pk_fma_f32 v[70:71], v[70:71], s[82:83], v[66:67] op_sel_hi:[1,1,0] neg_lo:[0,0,1] neg_hi:[0,0,1]
    v_pk_fma_f32 v[72:73], v[72:73], s[82:83], v[66:67] op_sel_hi:[1,1,0] neg_lo:[0,0,1] neg_hi:[0,0,1]
    v_pk_fma_f32 v[74:75], v[74:75], s[82:83], v[66:67] op_sel_hi:[1,1,0] neg_lo:[0,0,1] neg_hi:[0,0,1]
    v_exp_f32 v32, v32
    v_exp_f32 v33, v33
    v_exp_f32 v34, v34
    v_cvt_pk_bf16_f32 v24, v32, v33
    v_exp_f32 v35, v35
    v_exp_f32 v68, v68
    v_cvt_pk_bf16_f32 v25, v34, v35
    v_exp_f32 v69, v69
    v_exp_f32 v70, v70
    v_cvt_pk_bf16_f32 v26, v68, v69
    v_exp_f32 v71, v71
    v_exp_f32 v72, v72
    v_cvt_pk_bf16_f32 v27, v70, v71
    s_waitcnt vmcnt(7)
    v_exp_f32 v73, v73
    v_mfma_f32_16x16x32_bf16 v[32:35], v[40:43], v[24:27], 0
    v_exp_f32 v74, v74
    v_mfma_f32_16x16x32_bf16 v[52:55], v[76:79], v[24:27], 0
    v_exp_f32 v75, v75
    v_cvt_pk_bf16_f32 v28, v72, v73
    v_mfma_f32_16x16x32_bf16 v[56:59], v[48:51], v[24:27], 0
    v_cvt_pk_bf16_f32 v29, v74, v75
    s_nop 1
    v_mfma_f32_16x16x32_bf16 v[32:35], v[44:47], v[28:31], v[32:35]
    v_mfma_f32_16x16x32_bf16 v[52:55], v[60:63], v[28:31], v[52:55]
    v_mfma_f32_16x16x32_bf16 v[56:59], v[62:65], v[26:29], v[56:59]
    v_mov_b32 v68, 0
    v_mov_b32 v69, 0
    v_mov_b32 v70, 0
    v_rcp_f32 v66, v32
    v_mov_b32 v71, 0
    v_mov_b32 v72, 0
    v_pk_mul_f32 v[52:53], v[52:53], v[66:67] op_sel_hi:[1,0]
    v_pk_mul_f32 v[54:55], v[54:55], v[66:67] op_sel_hi:[1,0]
    v_cvt_pk_bf16_f32 v52, v52, v53
    v_cvt_pk_bf16_f32 v53, v54, v55
    ds_write_b64 v13, v[52:53]
    v_pk_mul_f32 v[56:57], v[56:57], v[66:67] op_sel_hi:[1,0]
    v_pk_mul_f32 v[58:59], v[58:59], v[66:67] op_sel_hi:[1,0]
    v_cvt_pk_bf16_f32 v56, v56, v57
    v_cvt_pk_bf16_f32 v57, v58, v59
    ds_write_b64 v13, v[56:57] offset:256
    v_mov_b32 v73, 0
    v_mov_b32 v74, 0
    v_mov_b32 v75, 0
    v_mov_b32 v40, 0
    v_mov_b32 v41, 0
    v_mov_b32 v42, 0
    v_mov_b32 v43, 0
    s_add_u32 s60, s65, 262144
    s_add_u32 s61, s65, 65536
    s_waitcnt lgkmcnt(0)
    s_barrier
    ds_read_b128 v[24:27], v8 offset:10240
    ds_read_b128 v[28:31], v8 offset:10752
    ds_read_b128 v[60:63], v8 offset:11264
    ds_read_b128 v[64:67], v8 offset:11776
    s_add_u32 s62, s65, 131072
    s_add_u32 s94, s65, 196608
    s_add_u32 s64, s64, 1
    s_add_u32 s71, s71, 262144
    s_mov_b32 s63, 200000
    s_waitcnt lgkmcnt(3)
    v_smfmac_f32_16x16x64_bf16 v[68:71], v[24:27], v[112:119], v2
    s_waitcnt lgkmcnt(2)
    v_smfmac_f32_16x16x64_bf16 v[68:71], v[28:31], v[120:127], v2
    s_waitcnt lgkmcnt(1)
    v_smfmac_f32_16x16x64_bf16 v[68:71], v[60:63], v[128:135], v2
    s_waitcnt lgkmcnt(0)
    v_smfmac_f32_16x16x64_bf16 v[68:71], v[64:67], v[136:143], v2
    v_smfmac_f32_16x16x64_bf16 v[72:75], v[24:27], v[144:151], v2
    v_smfmac_f32_16x16x64_bf16 v[72:75], v[28:31], v[152:159], v2
    v_smfmac_f32_16x16x64_bf16 v[72:75], v[60:63], v[160:167], v2
    v_cvt_pk_bf16_f32 v68, v68, v69
    v_cvt_pk_bf16_f32 v69, v70, v71
    v_smfmac_f32_16x16x64_bf16 v[72:75], v[64:67], v[168:175], v2
    v_and_b32 v68, -2, v68
    v_and_b32 v69, -2, v69
    v_smfmac_f32_16x16x64_bf16 v[36:39], v[24:27], v[176:183], v2
    buffer_store_dwordx2 v[68:69], v4, s[52:55], s65 offen sc1
    v_smfmac_f32_16x16x64_bf16 v[36:39], v[28:31], v[184:191], v2
    v_cvt_pk_bf16_f32 v72, v72, v73
    v_cvt_pk_bf16_f32 v73, v74, v75
    v_smfmac_f32_16x16x64_bf16 v[36:39], v[60:63], v[192:199], v2
    v_and_b32 v72, -2, v72
    v_and_b32 v73, -2, v73
    v_smfmac_f32_16x16x64_bf16 v[36:39], v[64:67], v[200:207], v2
    buffer_store_dwordx2 v[72:73], v4, s[52:55], s61 offen sc1
    v_smfmac_f32_16x16x64_bf16 v[40:43], v[24:27], v[208:215], v2
    v_smfmac_f32_16x16x64_bf16 v[40:43], v[28:31], v[216:223], v2
    v_smfmac_f32_16x16x64_bf16 v[40:43], v[60:63], v[224:231], v2
    v_cvt_pk_bf16_f32 v36, v36, v37
    v_cvt_pk_bf16_f32 v37, v38, v39
    v_smfmac_f32_16x16x64_bf16 v[40:43], v[64:67], v[232:239], v2
    v_and_b32 v36, -2, v36
    v_and_b32 v37, -2, v37
    v_mfma_f32_16x16x32_bf16 v[44:47], v[24:27], v[240:243], 0
    buffer_store_dwordx2 v[36:37], v4, s[52:55], s62 offen sc1
    v_mfma_f32_16x16x32_bf16 v[44:47], v[28:31], v[244:247], v[44:47]
    v_cvt_pk_bf16_f32 v40, v40, v41
    v_cvt_pk_bf16_f32 v41, v42, v43
    v_mfma_f32_16x16x32_bf16 v[44:47], v[60:63], v[248:251], v[44:47]
    v_and_b32 v40, -2, v40
    v_and_b32 v41, -2, v41
    v_mfma_f32_16x16x32_bf16 v[44:47], v[64:67], v[252:255], v[44:47]
    buffer_store_dwordx2 v[40:41], v4, s[52:55], s94 offen sc1
    s_nop 6
    v_cvt_pk_bf16_f32 v44, v44, v45
    v_cvt_pk_bf16_f32 v45, v46, v47
    v_and_b32 v44, -2, v44
    v_and_b32 v45, -2, v45
    s_mov_b64 exec, s[72:73]
    buffer_store_dwordx2 v[44:45], v4, s[52:55], s60 offen sc1
    s_mov_b64 exec, -1
    s_cmp_eq_u32 s70, 0
    s_cbranch_scc1 R_noredS0
    s_mov_b32 s60, s84
R_rdlS0:
    s_cmp_eq_u32 s60, 0
    s_cbranch_scc1 R_rgoS0
    s_sleep 1
    s_sub_u32 s60, s60, 1
    s_branch R_rdlS0
R_rgoS0:
    buffer_load_dwordx4 v[52:55], v5, s[52:55], s65 offen offset:0 sc1
    buffer_load_dwordx4 v[56:59], v5, s[52:55], s65 offen offset:1024 sc1
    buffer_load_dwordx4 v[76:79], v5, s[52:55], s65 offen offset:2048 sc1
    buffer_load_dwordx4 v[48:51], v5, s[52:55], s65 offen offset:3072 sc1
    v_mov_b32 v24, 0
    v_mov_b32 v25, 0
    v_mov_b32 v26, 0
    v_mov_b32 v27, 0
    v_mov_b32 v28, 0
    v_mov_b32 v29, 0
    v_mov_b32 v30, 0
    v_mov_b32 v31, 0
    v_mov_b32 v32, 0
    v_mov_b32 v33, 0
    v_mov_b32 v34, 0
    v_mov_b32 v35, 0
    v_cndmask_b32 v60, 0, v3, s[86:87]
    v_cndmask_b32 v61, 0, v3, s[88:89]
    v_cndmask_b32 v62, 0, v3, s[90:91]
    v_cndmask_b32 v63, 0, v3, s[92:93]
R_rp0S0:
    s_waitcnt vmcnt(3)
    v_mfma_f32_16x16x32_bf16 v[40:43], v[60:63], v[52:55], 0
    v_or3_b32 v64, v52, v53, v54
    v_or3_b32 v64, v64, v55, v55
    s_waitcnt vmcnt(2)
    v_mfma_f32_16x16x32_bf16 v[40:43], v[60:63], v[56:59], v[40:43]
    v_or3_b32 v64, v64, v56, v57
    v_or3_b32 v64, v64, v58, v59
    s_waitcnt vmcnt(1)
    v_mfma_f32_16x16x32_bf16 v[40:43], v[60:63], v[76:79], v[40:43]
    v_or3_b32 v64, v64, v76, v77
    v_or3_b32 v64, v64, v78, v79
    s_waitcnt vmcnt(0)
    v_mfma_f32_16x16x32_bf16 v[40:43], v[60:63], v[48:51], v[40:43]
    v_or3_b32 v64, v64, v48, v49
    v_or3_b32 v64, v64, v50, v51
    v_and_b32 v64, 1, v64
    v_cmp_ne_u32 vcc, 0, v64
    s_cbranch_vccnz R_rf0S0
R_rdoneS0:
    s_nop 0
    s_nop 0
    s_nop 0
    v_add_f32_dpp v64, v40, v40 row_ror:8 row_mask:0xf bank_mask:0xf
    v_add_f32_dpp v65, v41, v41 row_ror:8 row_mask:0xf bank_mask:0xf
    v_cvt_pk_bf16_f32 v64, v64, v65
    v_min_u32 v0, -2, v64
    buffer_store_dword v0, v6, s[52:55], s67 offen sc1
    s_branch R_loopS1
R_noredS0:
    v_mov_b32 v24, 0
    v_mov_b32 v25, 0
    v_mov_b32 v26, 0
    v_mov_b32 v27, 0
    v_mov_b32 v28, 0
    v_mov_b32 v29, 0
    v_mov_b32 v30, 0
    v_mov_b32 v31, 0
    v_mov_b32 v32, 0
    v_mov_b32 v33, 0
    v_mov_b32 v34, 0
    v_mov_b32 v35, 0
    s_cmp_lg_u32 s56, 3
    s_cbranch_scc1 R_nkvS0
    v_mov_b32 v15, s64
    s_cmp_ge_u32 s5, 64
    s_cbranch_scc1 R_nkvS0
    s_waitcnt vmcnt(7)
    v_cmp_ne_u32 vcc, 4, v0
    s_ff1_i32_b64 s5, vcc
    s_cmp_lt_i32 s5, 0
    s_cselect_b32 s5, 64, s5
    s_cselect_b32 s3, 0x40000000, s3
    s_add_u32 s60, s64, 3
    s_min_u32 s60, s60, 64
    s_cmp_ge_u32 s5, s60
    s_cbranch_scc1 R_kvS0_ok
    s_waitcnt vmcnt(0)
    s_lshl_b32 s61, s58, 8
    s_add_u32 s61, s61, 86573056
    v_lshrrev_b32 v0, 2, v7
    v_and_b32 v0, 255, v0
R_kvS0_p:
    buffer_load_dword v64, v0, s[52:55], s61 offen sc1
    s_sub_u32 s63, s63, 1
    s_cbranch_scc1 M_abort
    s_waitcnt vmcnt(0)
    v_cmp_ne_u32 vcc, 4, v64
    s_ff1_i32_b64 s5, vcc
    s_cmp_lt_i32 s5, 0
    s_cselect_b32 s5, 64, s5
    s_cmp_ge_u32 s5, s60
    s_cbranch_scc1 R_kvS0_ok
    s_sleep 4
    s_branch R_kvS0_p
R_kvS0_ok:
R_nkvS0:
    s_sleep 9
    s_branch R_loopS1x
R_rf0S0:
    buffer_load_dwordx4 v[52:55], v5, s[52:55], s65 offen offset:0 sc1
    buffer_load_dwordx4 v[56:59], v5, s[52:55], s65 offen offset:1024 sc1
    buffer_load_dwordx4 v[76:79], v5, s[52:55], s65 offen offset:2048 sc1
    buffer_load_dwordx4 v[48:51], v5, s[52:55], s65 offen offset:3072 sc1
    s_sub_u32 s63, s63, 1
    s_cbranch_scc1 M_abort
    s_branch R_rp0S0
R_cfS0:
    buffer_load_dwordx4 v[36:39], v1, s[52:55], s61 offen sc1
    buffer_load_dwordx4 v[40:43], v1, s[52:55], s60 offen offset:1024 sc1
    s_sub_u32 s63, s63, 1
    s_cbranch_scc1 M_abort
    s_waitcnt vmcnt(3)
    ds_write_b128 v1, v[44:47] offset:47104
    v_max3_u32 v0, v44, v45, v46
    s_waitcnt vmcnt(2)
    ds_write_b128 v1, v[48:51] offset:48128
    v_max3_u32 v0, v0, v47, v48
    v_max3_u32 v0, v0, v49, v50
    v_max_u32 v0, v0, v51
    v_cmp_eq_u32 vcc, -1, v0
    s_cbranch_vccz R_cokS0
    buffer_load_dwordx4 v[44:47], v1, s[52:55], s61 offen sc1
    buffer_load_dwordx4 v[48:51], v1, s[52:55], s60 offen offset:1024 sc1
    s_sub_u32 s63, s63, 1
    s_cbranch_scc1 M_abort
    s_branch R_cpS0
R_cokS0:
    s_waitcnt vmcnt(0)
    s_branch R_cdjS0
R_slowS0:
    s_sub_u32 s97, s69, 98304
    s_waitcnt lgkmcnt(0)
    s_nop 7
    v_mov_b32 v24, 0
    v_mov_b32 v25, 0
    v_mov_b32 v26, 0
    v_mov_b32 v27, 0
    v_mov_b32 v28, 0
    v_mov_b32 v29, 0
    v_mov_b32 v30, 0
    v_mov_b32 v31, 0
    v_mov_b32 v32, 0
    v_mov_b32 v33, 0
    v_mov_b32 v34, 0
    v_mov_b32 v35, 0
    ds_read_b128 v[52:55], v9 offset:0
    ds_read_b128 v[56:59], v9 offset:1024
    ds_read_b128 v[60:63], v9 offset:2048
    ds_read_b128 v[64:67], v9 offset:3072
R_sp0_S0:
    buffer_load_dwordx4 v[36:39], v8, s[52:55], s97 offen sc1
    buffer_load_dwordx4 v[40:43], v8, s[52:55], s97 offen offset:512 sc1
    s_sub_u32 s63, s63, 1
    s_cbranch_scc1 M_abort
    s_waitcnt vmcnt(0) lgkmcnt(0)
    v_max3_u32 v0, v36, v37, v38
    v_max3_u32 v0, v0, v39, v40
    v_max3_u32 v0, v0, v41, v42
    v_max_u32 v0, v0, v43
    v_cmp_eq_u32 vcc, -1, v0
    s_cbranch_vccnz R_sp0_S0
    v_smfmac_f32_16x16x64_bf16 v[24:27], v[36:39], a[0:7], v2
    v_smfmac_f32_16x16x64_bf16 v[28:31], v[36:39], a[144:151], v2
    v_smfmac_f32_16x16x64_bf16 v[32:35], v[36:39], v[52:59], v2
    v_smfmac_f32_16x16x64_bf16 v[24:27], v[40:43], a[8:15], v2
    v_smfmac_f32_16x16x64_bf16 v[28:31], v[40:43], a[152:159], v2
    v_smfmac_f32_16x16x64_bf16 v[32:35], v[40:43], v[60:67], v2
    s_add_u32 s97, s97, 1024
    ds_read_b128 v[52:55], v9 offset:4096
    ds_read_b128 v[56:59], v9 offset:5120
    ds_read_b128 v[60:63], v9 offset:6144
    ds_read_b128 v[64:67], v9 offset:7168
R_sp1_S0:
    buffer_load_dwordx4 v[36:39], v8, s[52:55], s97 offen sc1
    buffer_load_dwordx4 v[40:43], v8, s[52:55], s97 offen offset:512 sc1
    s_sub_u32 s63, s63, 1
    s_cbranch_scc1 M_abort
    s_waitcnt vmcnt(0) lgkmcnt(0)
    v_max3_u32 v0, v36, v37, v38
    v_max3_u32 v0, v0, v39, v40
    v_max3_u32 v0, v0, v41, v42
    v_max_u32 v0, v0, v43
    v_cmp_eq_u32 vcc, -1, v0
    s_cbranch_vccnz R_sp1_S0
    v_smfmac_f32_16x16x64_bf16 v[24:27], v[36:39], a[16:23], v2
    v_smfmac_f32_16x16x64_bf16 v[28:31], v[36:39], a[160:167], v2
    v_smfmac_f32_16x16x64_bf16 v[32:35], v[36:39], v[52:59], v2
    v_smfmac_f32_16x16x64_bf16 v[24:27], v[40:43], a[24:31], v2
    v_smfmac_f32_16x16x64_bf16 v[28:31], v[40:43], a[168:175], v2
    v_smfmac_f32_16x16x64_bf16 v[32:35], v[40:43], v[60:67], v2
    s_add_u32 s97, s97, 1024
    ds_read_b128 v[52:55], v9 offset:8192
    ds_read_b128 v[56:59], v9 offset:9216
    ds_read_b128 v[60:63], v9 offset:10240
    ds_read_b128 v[64:67], v9 offset:11264
R_sp2_S0:
    buffer_load_dwordx4 v[36:39], v8, s[52:55], s97 offen sc1
    buffer_load_dwordx4 v[40:43], v8, s[52:55], s97 offen offset:512 sc1
    s_sub_u32 s63, s63, 1
    s_cbranch_scc1 M_abort
    s_waitcnt vmcnt(0) lgkmcnt(0)
    v_max3_u32 v0, v36, v37, v38
    v_max3_u32 v0, v0, v39, v40
    v_max3_u32 v0, v0, v41, v42
    v_max_u32 v0, v0, v43
    v_cmp_eq_u32 vcc, -1, v0
    s_cbranch_vccnz R_sp2_S0
    v_smfmac_f32_16x16x64_bf16 v[24:27], v[36:39], a[32:39], v2
    v_smfmac_f32_16x16x64_bf16 v[28:31], v[36:39], a[176:183], v2
    v_smfmac_f32_16x16x64_bf16 v[32:35], v[36:39], v[52:59], v2
    v_smfmac_f32_16x16x64_bf16 v[24:27], v[40:43], a[40:47], v2
    v_smfmac_f32_16x16x64_bf16 v[28:31], v[40:43], a[184:191], v2
    v_smfmac_f32_16x16x64_bf16 v[32:35], v[40:43], v[60:67], v2
    s_add_u32 s97, s97, 1024
    ds_read_b128 v[52:55], v9 offset:12288
    ds_read_b128 v[56:59], v9 offset:13312
    ds_read_b128 v[60:63], v9 offset:14336
    ds_read_b128 v[64:67], v9 offset:15360
R_sp3_S0:
    buffer_load_dwordx4 v[36:39], v8, s[52:55], s97 offen sc1
    buffer_load_dwordx4 v[40:43], v8, s[52:55], s97 offen offset:512 sc1
    s_sub_u32 s63, s63, 1
    s_cbranch_scc1 M_abort
    s_waitcnt vmcnt(0) lgkmcnt(0)
    v_max3_u32 v0, v36, v37, v38
    v_max3_u32 v0, v0, v39, v40
    v_max3_u32 v0, v0, v41, v42
    v_max_u32 v0, v0, v43
    v_cmp_eq_u32 vcc, -1, v0
    s_cbranch_vccnz R_sp3_S0
    v_smfmac_f32_16x16x64_bf16 v[24:27], v[36:39], a[48:55], v2
    v_smfmac_f32_16x16x64_bf16 v[28:31], v[36:39], a[192:199], v2
    v_smfmac_f32_16x16x64_bf16 v[32:35], v[36:39], v[52:59], v2
    v_smfmac_f32_16x16x64_bf16 v[24:27], v[40:43], a[56:63], v2
    v_smfmac_f32_16x16x64_bf16 v[28:31], v[40:43], a[200:207], v2
    v_smfmac_f32_16x16x64_bf16 v[32:35], v[40:43], v[60:67], v2
    s_add_u32 s97, s97, 1024
    ds_read_b128 v[52:55], v9 offset:16384
    ds_read_b128 v[56:59], v9 offset:17408
    ds_read_b128 v[60:63], v9 offset:18432
    ds_read_b128 v[64:67], v9 offset:19456
R_sp4_S0:
    buffer_load_dwordx4 v[36:39], v8, s[52:55], s97 offen sc1
    buffer_load_dwordx4 v[40:43], v8, s[52:55], s97 offen offset:512 sc1
    s_sub_u32 s63, s63, 1
    s_cbranch_scc1 M_abort
    s_waitcnt vmcnt(0) lgkmcnt(0)
    v_max3_u32 v0, v36, v37, v38
    v_max3_u32 v0, v0, v39, v40
    v_max3_u32 v0, v0, v41, v42
    v_max_u32 v0, v0, v43
    v_cmp_eq_u32 vcc, -1, v0
    s_cbranch_vccnz R_sp4_S0
    v_smfmac_f32_16x16x64_bf16 v[24:27], v[36:39], a[64:71], v2
    v_smfmac_f32_16x16x64_bf16 v[28:31], v[36:39], a[208:215], v2
    v_smfmac_f32_16x16x64_bf16 v[32:35], v[36:39], v[52:59], v2
    v_smfmac_f32_16x16x64_bf16 v[24:27], v[40:43], a[72:79], v2
    v_smfmac_f32_16x16x64_bf16 v[28:31], v[40:43], a[216:223], v2
    v_smfmac_f32_16x16x64_bf16 v[32:35], v[40:43], v[60:67], v2
    s_add_u32 s97, s97, 1024
    ds_read_b128 v[52:55], v9 offset:20480
    ds_read_b128 v[56:59], v9 offset:21504
    ds_read_b128 v[60:63], v9 offset:22528
    ds_read_b128 v[64:67], v9 offset:23552
R_sp5_S0:
    buffer_load_dwordx4 v[36:39], v8, s[52:55], s97 offen sc1
    buffer_load_dwordx4 v[40:43], v8, s[52:55], s97 offen offset:512 sc1
    s_sub_u32 s63, s63, 1
    s_cbranch_scc1 M_abort
    s_waitcnt vmcnt(0) lgkmcnt(0)
    v_max3_u32 v0, v36, v37, v38
    v_max3_u32 v0, v0, v39, v40
    v_max3_u32 v0, v0, v41, v42
    v_max_u32 v0, v0, v43
    v_cmp_eq_u32 vcc, -1, v0
    s_cbranch_vccnz R_sp5_S0
    v_smfmac_f32_16x16x64_bf16 v[24:27], v[36:39], a[80:87], v2
    v_smfmac_f32_16x16x64_bf16 v[28:31], v[36:39], a[224:231], v2
    v_smfmac_f32_16x16x64_bf16 v[32:35], v[36:39], v[52:59], v2
    v_smfmac_f32_16x16x64_bf16 v[24:27], v[40:43], a[88:95], v2
    v_smfmac_f32_16x16x64_bf16 v[28:31], v[40:43], a[232:239], v2
    v_smfmac_f32_16x16x64_bf16 v[32:35], v[40:43], v[60:67], v2
    s_add_u32 s97, s97, 1024
    ds_read_b128 v[52:55], v9 offset:24576
    ds_read_b128 v[56:59], v9 offset:25600
    ds_read_b128 v[60:63], v9 offset:26624
    ds_read_b128 v[64:67], v9 offset:27648
R_sp6_S0:
    buffer_load_dwordx4 v[36:39], v8, s[52:55], s97 offen sc1
    buffer_load_dwordx4 v[40:43], v8, s[52:55], s97 offen offset:512 sc1
    s_sub_u32 s63, s63, 1
    s_cbranch_scc1 M_abort
    s_waitcnt vmcnt(0) lgkmcnt(0)
    v_max3_u32 v0, v36, v37, v38
    v_max3_u32 v0, v0, v39, v40
    v_max3_u32 v0, v0, v41, v42
    v_max_u32 v0, v0, v43
    v_cmp_eq_u32 vcc, -1, v0
    s_cbranch_vccnz R_sp6_S0
    v_smfmac_f32_16x16x64_bf16 v[24:27], v[36:39], a[96:103], v2
    v_smfmac_f32_16x16x64_bf16 v[28:31], v[36:39], a[240:247], v2
    v_smfmac_f32_16x16x64_bf16 v[32:35], v[36:39], v[52:59], v2
    v_smfmac_f32_16x16x64_bf16 v[24:27], v[40:43], a[104:111], v2
    v_smfmac_f32_16x16x64_bf16 v[28:31], v[40:43], a[248:255], v2
    v_smfmac_f32_16x16x64_bf16 v[32:35], v[40:43], v[60:67], v2
    s_add_u32 s97, s97, 1024
    ds_read_b128 v[52:55], v9 offset:28672
    ds_read_b128 v[56:59], v9 offset:29696
    ds_read_b128 v[60:63], v9 offset:30720
    ds_read_b128 v[64:67], v9 offset:31744
R_sp7_S0:
    buffer_load_dwordx4 v[36:39], v8, s[52:55], s97 offen sc1
    buffer_load_dwordx4 v[40:43], v8, s[52:55], s97 offen offset:512 sc1
    s_sub_u32 s63, s63, 1
    s_cbranch_scc1 M_abort
    s_waitcnt vmcnt(0) lgkmcnt(0)
    v_max3_u32 v0, v36, v37, v38
    v_max3_u32 v0, v0, v39, v40
    v_max3_u32 v0, v0, v41, v42
    v_max_u32 v0, v0, v43
    v_cmp_eq_u32 vcc, -1, v0
    s_cbranch_vccnz R_sp7_S0
    v_smfmac_f32_16x16x64_bf16 v[24:27], v[36:39], a[112:119], v2
    v_smfmac_f32_16x16x64_bf16 v[28:31], v[36:39], v[80:87], v2
    v_smfmac_f32_16x16x64_bf16 v[32:35], v[36:39], v[52:59], v2
    v_smfmac_f32_16x16x64_bf16 v[24:27], v[40:43], a[120:127], v2
    v_smfmac_f32_16x16x64_bf16 v[28:31], v[40:43], v[88:95], v2
    v_smfmac_f32_16x16x64_bf16 v[32:35], v[40:43], v[60:67], v2
    s_add_u32 s97, s97, 1024
    ds_read_b128 v[52:55], v9 offset:32768
    ds_read_b128 v[56:59], v9 offset:33792
R_sp8_S0:
    buffer_load_dwordx4 v[36:39], v8, s[52:55], s97 offen sc1
    buffer_load_dwordx4 v[40:43], v8, s[52:55], s97 offen offset:512 sc1
    s_sub_u32 s63, s63, 1
    s_cbranch_scc1 M_abort
    s_waitcnt vmcnt(0) lgkmcnt(0)
    v_max3_u32 v0, v36, v37, v38
    v_max3_u32 v0, v0, v39, v40
    v_max3_u32 v0, v0, v41, v42
    v_max_u32 v0, v0, v43
    v_cmp_eq_u32 vcc, -1, v0
    s_cbranch_vccnz R_sp8_S0
    v_smfmac_f32_16x16x64_bf16 v[24:27], v[36:39], a[128:135], v2
    v_smfmac_f32_16x16x64_bf16 v[28:31], v[36:39], v[96:103], v2
    v_smfmac_f32_16x16x64_bf16 v[32:35], v[36:39], v[52:59], v2
    v_smfmac_f32_16x16x64_bf16 v[24:27], v[40:43], a[136:143], v2
    v_smfmac_f32_16x16x64_bf16 v[28:31], v[40:43], v[104:111], v2
    v_smfmac_f32_16x16x64_bf16 v[32:35], v[40:43], v[16:23], v2
    s_add_u32 s97, s97, 1024
    s_nop 7
    v_cvt_pk_bf16_f32 v24, v24, v25
    v_cvt_pk_bf16_f32 v25, v26, v27
    ds_write_b64 v10, v[24:25]
    v_cvt_pk_bf16_f32 v36, v28, v29
    v_cvt_pk_bf16_f32 v37, v30, v31
    ds_write_b64 v10, v[36:37] offset:36864
    ds_read_b128 v[52:55], v12 offset:58368
    ds_read_b128 v[56:59], v12 offset:58496
    ds_read_b128 v[60:63], v12 offset:60416
    ds_read_b128 v[64:67], v12 offset:60544
    s_waitcnt lgkmcnt(0)
    s_branch R_slowretS0
R_loopS1:
R_loopS1x:
    s_mov_b32 s94, s69
    s_mov_b32 s69, s67
    s_mov_b32 s67, s68
    s_mov_b32 s68, s94
    s_mov_b32 s63, 200000
    s_sub_u32 s60, s69, 98304
    s_mov_b32 s61, s60
    s_add_u32 s62, s60, 4096
    s_add_u32 s94, s60, s66
    s_add_u32 s95, s71, 1998848
    s_add_u32 m0, s85, 149504
    ds_read_b128 v[52:55], v9 offset:0
    ds_read_b128 v[56:59], v9 offset:1024
    ds_read_b128 v[60:63], v9 offset:2048
    ds_read_b128 v[64:67], v9 offset:3072
    ds_read_b128 v[68:71], v9 offset:4096
    ds_read_b128 v[72:75], v9 offset:5120
    s_cmp_lt_u32 s56, 2
    s_cbranch_scc1 R_cdjS1
    s_sleep 1
    buffer_load_dwordx4 v[36:39], v1, s[52:55], s61 offen sc1
    buffer_load_dwordx4 v[40:43], v1, s[52:55], s60 offen offset:1024 sc1
    s_sleep 2
    buffer_load_dwordx4 v[44:47], v1, s[52:55], s61 offen sc1
    buffer_load_dwordx4 v[48:51], v1, s[52:55], s60 offen offset:1024 sc1
R_cpS1:
    s_waitcnt vmcnt(3)
    ds_write_b128 v1, v[36:39] offset:47104
    v_max3_u32 v0, v36, v37, v38
    s_waitcnt vmcnt(2)
    ds_write_b128 v1, v[40:43] offset:48128
    v_max3_u32 v0, v0, v39, v40
    v_max3_u32 v0, v0, v41, v42
    v_max_u32 v0, v0, v43
    v_cmp_eq_u32 vcc, -1, v0
    s_cbranch_vccnz R_cfS1
R_cdjS1:
    s_waitcnt lgkmcnt(0)
    s_barrier
    ds_read_b128 v[36:39], v8 offset:47104
    ds_read_b128 v[40:43], v8 offset:47616
    s_waitcnt vmcnt(0)
    ds_read_b128 v[44:47], v8 offset:48128
    ds_read_b128 v[48:51], v8 offset:48640
    s_waitcnt lgkmcnt(3)
    v_smfmac_f32_16x16x64_bf16 v[24:27], v[36:39], a[0:7], v2
    v_smfmac_f32_16x16x64_bf16 v[28:31], v[36:39], a[144:151], v2
    v_smfmac_f32_16x16x64_bf16 v[32:35], v[36:39], v[52:59], v2
    ds_read_b128 v[52:55], v9 offset:6144
    ds_read_b128 v[56:59], v9 offset:7168
    ds_read_b128 v[36:39], v8 offset:49152
    s_waitcnt lgkmcnt(5)
    v_smfmac_f32_16x16x64_bf16 v[24:27], v[40:43], a[8:15], v2
    buffer_load_dwordx4 v7, s[52:55], s62 offen sc1 lds
    v_smfmac_f32_16x16x64_bf16 v[28:31], v[40:43], a[152:159], v2
    s_add_u32 m0, s85, 154624
    v_smfmac_f32_16x16x64_bf16 v[32:35], v[40:43], v[60:67], v2
    ds_read_b128 v[60:63], v9 offset:8192
    ds_read_b128 v[64:67], v9 offset:9216
    ds_read_b128 v[40:43], v8 offset:49664
    s_waitcnt lgkmcnt(7)
    v_smfmac_f32_16x16x64_bf16 v[24:27], v[44:47], a[16:23], v2
    buffer_load_dwordx4 v7, s[52:55], s95 offen sc1 lds
    v_smfmac_f32_16x16x64_bf16 v[28:31], v[44:47], a[160:167], v2
    s_add_u32 m0, s85, 158720
    s_add_u32 s95, s95, 4096
    v_smfmac_f32_16x16x64_bf16 v[32:35], v[44:47], v[68:75], v2
    ds_read_b128 v[68:71], v9 offset:10240
    ds_read_b128 v[72:75], v9 offset:11264
    ds_read_b128 v[44:47], v8 offset:50176
    s_waitcnt lgkmcnt(9)
    v_smfmac_f32_16x16x64_bf16 v[24:27], v[48:51], a[24:31], v2
    buffer_load_dwordx4 v7, s[52:55], s95 offen sc1 lds
    v_smfmac_f32_16x16x64_bf16 v[28:31], v[48:51], a[168:175], v2
    s_mov_b32 m0, s57
    s_add_u32 s60, s71, 18874368
    s_waitcnt lgkmcnt(7)
    v_smfmac_f32_16x16x64_bf16 v[32:35], v[48:51], v[52:59], v2
    ds_read_b128 v[52:55], v9 offset:12288
    ds_read_b128 v[56:59], v9 offset:13312
    ds_read_b128 v[48:51], v8 offset:50688
    s_waitcnt lgkmcnt(9)
    v_smfmac_f32_16x16x64_bf16 v[24:27], v[36:39], a[32:39], v2
    v_smfmac_f32_16x16x64_bf16 v[28:31], v[36:39], a[176:183], v2
    s_waitcnt lgkmcnt(7)
    v_smfmac_f32_16x16x64_bf16 v[32:35], v[36:39], v[60:67], v2
    ds_read_b128 v[60:63], v9 offset:14336
    ds_read_b128 v[64:67], v9 offset:15360
    s_waitcnt lgkmcnt(8)
    v_smfmac_f32_16x16x64_bf16 v[24:27], v[40:43], a[40:47], v2
    v_smfmac_f32_16x16x64_bf16 v[28:31], v[40:43], a[184:191], v2
    s_waitcnt lgkmcnt(6)
    v_smfmac_f32_16x16x64_bf16 v[32:35], v[40:43], v[68:75], v2
    ds_read_b128 v[68:71], v9 offset:16384
    ds_read_b128 v[72:75], v9 offset:17408
    s_waitcnt lgkmcnt(7)
    v_smfmac_f32_16x16x64_bf16 v[24:27], v[44:47], a[48:55], v2
    v_smfmac_f32_16x16x64_bf16 v[28:31], v[44:47], a[192:199], v2
    s_waitcnt vmcnt(2)
    s_barrier
    ds_read_b128 v[36:39], v8 offset:51200
    ds_read_b128 v[40:43], v8 offset:51712
    s_waitcnt lgkmcnt(7)
    v_smfmac_f32_16x16x64_bf16 v[32:35], v[44:47], v[52:59], v2
    ds_read_b128 v[52:55], v9 offset:18432
    ds_read_b128 v[56:59], v9 offset:19456
    ds_read_b128 v[44:47], v8 offset:52224
    s_waitcnt lgkmcnt(9)
    v_smfmac_f32_16x16x64_bf16 v[24:27], v[48:51], a[56:63], v2
    buffer_load_dwordx4 v7, s[52:55], s94 offen sc1 lds
    v_smfmac_f32_16x16x64_bf16 v[28:31], v[48:51], a[200:207], v2
    s_waitcnt lgkmcnt(7)
    v_smfmac_f32_16x16x64_bf16 v[32:35], v[48:51], v[60:67], v2
    ds_read_b128 v[60:63], v9 offset:20480
    ds_read_b128 v[64:67], v9 offset:21504
    ds_read_b128 v[48:51], v8 offset:52736
    s_waitcnt lgkmcnt(7)
    v_smfmac_f32_16x16x64_bf16 v[24:27], v[36:39], a[64:71], v2
    buffer_load_dwordx4 v[76:79], v14, s[52:55], s60 offen sc1
    v_smfmac_f32_16x16x64_bf16 v[28:31], v[36:39], a[208:215], v2
    s_lshr_b32 s62, s71, 1
    v_smfmac_f32_16x16x64_bf16 v[32:35], v[36:39], v[68:75], v2
    ds_read_b128 v[68:71], v9 offset:22528
    ds_read_b128 v[72:75], v9 offset:23552
    ds_read_b128 v[36:39], v8 offset:53248
    s_waitcnt lgkmcnt(9)
    v_smfmac_f32_16x16x64_bf16 v[24:27], v[40:43], a[72:79], v2
    v_smfmac_f32_16x16x64_bf16 v[28:31], v[40:43], a[216:223], v2
    s_add_u32 s61, s62, 52396032
    s_add_u32 s95, s62, 52393984
    s_waitcnt lgkmcnt(7)
    v_smfmac_f32_16x16x64_bf16 v[32:35], v[40:43], v[52:59], v2
    ds_read_b128 v[52:55], v9 offset:24576
    ds_read_b128 v[56:59], v9 offset:25600
    ds_read_b128 v[40:43], v8 offset:53760
    s_waitcnt lgkmcnt(9)
    v_smfmac_f32_16x16x64_bf16 v[24:27], v[44:47], a[80:87], v2
    v_smfmac_f32_16x16x64_bf16 v[28:31], v[44:47], a[224:231], v2
    s_add_u32 s94, s71, s80
    s_add_u32 s62, s94, 16777216
    s_waitcnt lgkmcnt(7)
    v_smfmac_f32_16x16x64_bf16 v[32:35], v[44:47], v[60:67], v2
    ds_read_b128 v[60:63], v9 offset:26624
    ds_read_b128 v[64:67], v9 offset:27648
    ds_read_b128 v[44:47], v8 offset:54272
    s_waitcnt lgkmcnt(9)
    v_smfmac_f32_16x16x64_bf16 v[24:27], v[48:51], a[88:95], v2
    v_smfmac_f32_16x16x64_bf16 v[28:31], v[48:51], a[232:239], v2
    s_waitcnt lgkmcnt(7)
    v_smfmac_f32_16x16x64_bf16 v[32:35], v[48:51], v[68:75], v2
    ds_read_b128 v[68:71], v9 offset:28672
    ds_read_b128 v[72:75], v9 offset:29696
    buffer_load_dwordx4 v[48:51], v14, s[52:55], s60 offen offset:256 sc1
    s_waitcnt lgkmcnt(8)
    v_smfmac_f32_16x16x64_bf16 v[24:27], v[36:39], a[96:103], v2
    s_cmp_eq_u32 s70, 0
    s_cselect_b32 s97, 0x40000000, s68
    v_smfmac_f32_16x16x64_bf16 v[28:31], v[36:39], a[240:247], v2
    s_waitcnt lgkmcnt(6)
    v_smfmac_f32_16x16x64_bf16 v[32:35], v[36:39], v[52:59], v2
    ds_read_b128 v[52:55], v9 offset:30720
    ds_read_b128 v[56:59], v9 offset:31744
    ds_read_b128 v[36:39], v8 offset:54784
    s_waitcnt lgkmcnt(8)
    v_smfmac_f32_16x16x64_bf16 v[24:27], v[40:43], a[104:111], v2
    buffer_store_dword v15, v6, s[52:55], s97 offen sc1
    v_smfmac_f32_16x16x64_bf16 v[28:31], v[40:43], a[248:255], v2
    s_waitcnt vmcnt(3)
    s_barrier
    s_waitcnt lgkmcnt(6)
    v_smfmac_f32_16x16x64_bf16 v[32:35], v[40:43], v[60:67], v2
    ds_read_b128 v[60:63], v9 offset:32768
    ds_read_b128 v[64:67], v9 offset:33792
    ds_read_b128 v[40:43], v8 offset:55296
    s_waitcnt lgkmcnt(8)
    v_smfmac_f32_16x16x64_bf16 v[24:27], v[44:47], a[112:119], v2
    buffer_load_dword v0, v5, s[52:55], s94 offen sc1
    v_smfmac_f32_16x16x64_bf16 v[28:31], v[44:47], v[80:87], v2
    s_waitcnt lgkmcnt(6)
    v_smfmac_f32_16x16x64_bf16 v[32:35], v[44:47], v[68:75], v2
    ds_read_b128 v[44:47], v8 offset:55808
    ds_read_b128 v[68:71], v12 offset:56320
    ds_read_b128 v[72:75], v12 offset:56448
    s_waitcnt lgkmcnt(6)
    v_smfmac_f32_16x16x64_bf16 v[24:27], v[36:39], a[120:127], v2
    buffer_load_dword v0, v5, s[52:55], s62 offen sc1
    v_smfmac_f32_16x16x64_bf16 v[28:31], v[36:39], v[88:95], v2
    v_smfmac_f32_16x16x64_bf16 v[32:35], v[36:39], v[52:59], v2
    ds_read_b128 v[52:55], v12 offset:58368
    ds_read_b128 v[56:59], v12 offset:58496
    s_waitcnt lgkmcnt(5)
    v_smfmac_f32_16x16x64_bf16 v[24:27], v[40:43], a[128:135], v2
    buffer_store_dword v15, off, s[52:55], s4 sc1
    v_smfmac_f32_16x16x64_bf16 v[28:31], v[40:43], v[96:103], v2
    s_waitcnt lgkmcnt(4)
    v_smfmac_f32_16x16x64_bf16 v[24:27], v[44:47], a[136:143], v2
    buffer_load_dword v0, v6, s[52:55], s3 offen sc1
    v_smfmac_f32_16x16x64_bf16 v[28:31], v[44:47], v[104:111], v2
    v_smfmac_f32_16x16x64_bf16 v[32:35], v[40:43], v[60:67], v2
    s_nop 2
    v_cvt_pk_bf16_f32 v24, v24, v25
    v_cvt_pk_bf16_f32 v25, v26, v27
    ds_write_b64 v10, v[24:25]
    v_cvt_pk_bf16_f32 v36, v28, v29
    v_cvt_pk_bf16_f32 v37, v30, v31
    ds_write_b64 v10, v[36:37] offset:36864
    v_smfmac_f32_16x16x64_bf16 v[32:35], v[44:47], v[16:23], v2
    ds_read_b128 v[60:63], v12 offset:60416
    ds_read_b128 v[64:67], v12 offset:60544
    v_cmp_u_f32 vcc, v28, v29
    v_cmp_u_f32 s[96:97], v30, v31
    s_or_b64 vcc, vcc, s[96:97]
    s_cbranch_vccnz R_slowS1
R_slowretS1:
    s_cmp_eq_u32 s64, 63
    s_cbranch_scc1 R_done
    s_waitcnt lgkmcnt(2)
    s_barrier
    ds_read_b64_tr_b16 v[24:25], v11 offset:0
    ds_read_b64_tr_b16 v[26:27], v11 offset:128
    ds_read_b64_tr_b16 v[40:41], v11 offset:36864
    ds_read_b64_tr_b16 v[42:43], v11 offset:36992
    ds_read_b64_tr_b16 v[28:29], v11 offset:512
    ds_read_b64_tr_b16 v[30:31], v11 offset:640
    ds_read_b64_tr_b16 v[44:45], v11 offset:37376
    ds_read_b64_tr_b16 v[46:47], v11 offset:37504
    v_cvt_pk_bf16_f32 v38, v32, v33
    v_cvt_pk_bf16_f32 v39, v34, v35
    s_waitcnt lgkmcnt(6)
    v_mfma_f32_16x16x32_bf16 v[32:35], v[68:71], v[24:27], 0
    buffer_store_dwordx2 v[36:37], v10, s[52:55], s95 offen sc1
    v_mfma_f32_16x16x32_bf16 v[68:71], v[72:75], v[24:27], 0
    s_waitcnt lgkmcnt(4)
    v_mfma_f32_16x16x32_bf16 v[72:75], v[40:43], v[24:27], 0
    ds_read_b64_tr_b16 v[24:25], v11 offset:1024
    ds_read_b64_tr_b16 v[26:27], v11 offset:1152
    ds_read_b64_tr_b16 v[40:41], v11 offset:37888
    ds_read_b64_tr_b16 v[42:43], v11 offset:38016
    s_waitcnt lgkmcnt(6)
    v_mfma_f32_16x16x32_bf16 v[32:35], v[52:55], v[28:31], v[32:35]
    ds_read_b128 v[52:55], v12 offset:62464
    v_mfma_f32_16x16x32_bf16 v[68:71], v[56:59], v[28:31], v[68:71]
    ds_read_b128 v[56:59], v12 offset:62592
    buffer_store_dwordx2 v[38:39], v10, s[52:55], s61 offen sc1
    s_waitcnt lgkmcnt(6)
    v_mfma_f32_16x16x32_bf16 v[72:75], v[44:47], v[28:31], v[72:75]
    ds_read_b64_tr_b16 v[28:29], v11 offset:1536
    ds_read_b64_tr_b16 v[30:31], v11 offset:1664
    ds_read_b64_tr_b16 v[44:45], v11 offset:38400
    ds_read_b64_tr_b16 v[46:47], v11 offset:38528
    s_waitcnt lgkmcnt(8)
    v_mfma_f32_16x16x32_bf16 v[32:35], v[60:63], v[24:27], v[32:35]
    v_cndmask_b32 v60, 0, v38, s[72:73]
    v_cndmask_b32 v61, 0, v39, s[72:73]
    v_mfma_f32_16x16x32_bf16 v[68:71], v[64:67], v[24:27], v[68:71]
    v_mov_b32 v62, 0
    v_mov_b32 v63, 0
    s_waitcnt lgkmcnt(6)
    v_mfma_f32_16x16x32_bf16 v[72:75], v[40:43], v[24:27], v[72:75]
    v_cndmask_b32 v64, 0, v38, s[74:75]
    v_cndmask_b32 v65, 0, v39, s[74:75]
    s_waitcnt lgkmcnt(2)
    v_mfma_f32_16x16x32_bf16 v[32:35], v[52:55], v[28:31], v[32:35]
    v_mov_b32 v40, 0x3f803f80
    v_mov_b32 v41, 0x3f803f80
    v_mfma_f32_16x16x32_bf16 v[68:71], v[56:59], v[28:31], v[68:71]
    v_mov_b32 v42, 0x3f803f80
    v_mov_b32 v43, 0x3f803f80
    s_waitcnt lgkmcnt(0)
    v_mfma_f32_16x16x32_bf16 v[72:75], v[44:47], v[28:31], v[72:75]
    v_mov_b32 v44, 0x3f003f00
    v_mov_b32 v45, 0x3f003f00
    v_mov_b32 v46, 0
    v_mov_b32 v47, 0
    v_max3_f32 v66, v32, v33, v34
    s_nop 0
    v_max3_f32 v67, v35, v68, v69
    v_max3_f32 v66, v66, v70, v71
    v_max3_f32 v67, v67, v72, v73
    v_max3_f32 v66, v66, v74, v75
    v_max_f32 v66, v66, v67
    v_max_f32 v67, v66, v67
    v_mov_b32 v36, 0
    v_mov_b32 v37, 0
    v_permlane32_swap_b32 v66, v67
    v_max_f32 v66, v66, v67
    v_max_f32 v67, v66, v67
    v_mov_b32 v38, 0
    v_mov_b32 v39, 0
    v_permlane16_swap_b32 v66, v67
    v_max_f32 v66, v66, v67
    v_mul_f32 v66, s82, v66
    v_pk_fma_f32 v[32:33], v[32:33], s[82:83], v[66:67] op_sel_hi:[1,1,0] neg_lo:[0,0,1] neg_hi:[0,0,1]
    v_pk_fma_f32 v[34:35], v[34:35], s[82:83], v[66:67] op_sel_hi:[1,1,0] neg_lo:[0,0,1] neg_hi:[0,0,1]
    v_pk_fma_f32 v[68:69], v[68:69], s[82:83], v[66:67] op_sel_hi:[1,1,0] neg_lo:[0,0,1] neg_hi:[0,0,1]
    v_pk_fma_f32 v[70:71], v[70:71], s[82:83], v[66:67] op_sel_hi:[1,1,0] neg_lo:[0,0,1] neg_hi:[0,0,1]
    v_pk_fma_f32 v[72:73], v[72:73], s[82:83], v[66:67] op_sel_hi:[1,1,0] neg_lo:[0,0,1] neg_hi:[0,0,1]
    v_pk_fma_f32 v[74:75], v[74:75], s[82:83], v[66:67] op_sel_hi:[1,1,0] neg_lo:[0,0,1] neg_hi:[0,0,1]
    v_exp_f32 v32, v32
    v_exp_f32 v33, v33
    v_exp_f32 v34, v34
    v_cvt_pk_bf16_f32 v24, v32, v33
    v_exp_f32 v35, v35
    v_exp_f32 v68, v68
    v_cvt_pk_bf16_f32 v25, v34, v35
    v_exp_f32 v69, v69
    v_exp_f32 v70, v70
    v_cvt_pk_bf16_f32 v26, v68, v69
    v_exp_f32 v71, v71
    v_exp_f32 v72, v72
    v_cvt_pk_bf16_f32 v27, v70, v71
    s_waitcnt vmcnt(7)
    v_exp_f32 v73, v73
    v_mfma_f32_16x16x32_bf16 v[32:35], v[40:43], v[24:27], 0
    v_exp_f32 v74, v74
    v_mfma_f32_16x16x32_bf16 v[52:55], v[76:79], v[24:27], 0
    v_exp_f32 v75, v75
    v_cvt_pk_bf16_f32 v28, v72, v73
    v_mfma_f32_16x16x32_bf16 v[56:59], v[48:51], v[24:27], 0
    v_cvt_pk_bf16_f32 v29, v74, v75
    s_nop 1
    v_mfma_f32_16x16x32_bf16 v[32:35], v[44:47], v[28:31], v[32:35]
    v_mfma_f32_16x16x32_bf16 v[52:55], v[60:63], v[28:31], v[52:55]
    v_mfma_f32_16x16x32_bf16 v[56:59], v[62:65], v[26:29], v[56:59]
    v_mov_b32 v68, 0
    v_mov_b32 v69, 0
    v_mov_b32 v70, 0
    v_rcp_f32 v66, v32
    v_mov_b32 v71, 0
    v_mov_b32 v72, 0
    v_pk_mul_f32 v[52:53], v[52:53], v[66:67] op_sel_hi:[1,0]
    v_pk_mul_f32 v[54:55], v[54:55], v[66:67] op_sel_hi:[1,0]
    v_cvt_pk_bf16_f32 v52, v52, v53
    v_cvt_pk_bf16_f32 v53, v54, v55
    ds_write_b64 v13, v[52:53]
    v_pk_mul_f32 v[56:57], v[56:57], v[66:67] op_sel_hi:[1,0]
    v_pk_mul_f32 v[58:59], v[58:59], v[66:67] op_sel_hi:[1,0]
    v_cvt_pk_bf16_f32 v56, v56, v57
    v_cvt_pk_bf16_f32 v57, v58, v59
    ds_write_b64 v13, v[56:57] offset:256
    v_mov_b32 v73, 0
    v_mov_b32 v74, 0
    v_mov_b32 v75, 0
    v_mov_b32 v40, 0
    v_mov_b32 v41, 0
    v_mov_b32 v42, 0
    v_mov_b32 v43, 0
    s_add_u32 s60, s65, 262144
    s_add_u32 s61, s65, 65536
    s_waitcnt lgkmcnt(0)
    s_barrier
    ds_read_b128 v[24:27], v8 offset:10240
    ds_read_b128 v[28:31], v8 offset:10752
    ds_read_b128 v[60:63], v8 offset:11264
    ds_read_b128 v[64:67], v8 offset:11776
    s_add_u32 s62, s65, 131072
    s_add_u32 s94, s65, 196608
    s_add_u32 s64, s64, 1
    s_add_u32 s71, s71, 262144
    s_mov_b32 s63, 200000
    s_waitcnt lgkmcnt(3)
    v_smfmac_f32_16x16x64_bf16 v[68:71], v[24:27], v[112:119], v2
    s_waitcnt lgkmcnt(2)
    v_smfmac_f32_16x16x64_bf16 v[68:71], v[28:31], v[120:127], v2
    s_waitcnt lgkmcnt(1)
    v_smfmac_f32_16x16x64_bf16 v[68:71], v[60:63], v[128:135], v2
    s_waitcnt lgkmcnt(0)
    v_smfmac_f32_16x16x64_bf16 v[68:71], v[64:67], v[136:143], v2
    v_smfmac_f32_16x16x64_bf16 v[72:75], v[24:27], v[144:151], v2
    v_smfmac_f32_16x16x64_bf16 v[72:75], v[28:31], v[152:159], v2
    v_smfmac_f32_16x16x64_bf16 v[72:75], v[60:63], v[160:167], v2
    v_cvt_pk_bf16_f32 v68, v68, v69
    v_cvt_pk_bf16_f32 v69, v70, v71
    v_smfmac_f32_16x16x64_bf16 v[72:75], v[64:67], v[168:175], v2
    v_or_b32 v68, 1, v68
    v_or_b32 v69, 1, v69
    v_smfmac_f32_16x16x64_bf16 v[36:39], v[24:27], v[176:183], v2
    buffer_store_dwordx2 v[68:69], v4, s[52:55], s65 offen sc1
    v_smfmac_f32_16x16x64_bf16 v[36:39], v[28:31], v[184:191], v2
    v_cvt_pk_bf16_f32 v72, v72, v73
    v_cvt_pk_bf16_f32 v73, v74, v75
    v_smfmac_f32_16x16x64_bf16 v[36:39], v[60:63], v[192:199], v2
    v_or_b32 v72, 1, v72
    v_or_b32 v73, 1, v73
    v_smfmac_f32_16x16x64_bf16 v[36:39], v[64:67], v[200:207], v2
    buffer_store_dwordx2 v[72:73], v4, s[52:55], s61 offen sc1
    v_smfmac_f32_16x16x64_bf16 v[40:43], v[24:27], v[208:215], v2
    v_smfmac_f32_16x16x64_bf16 v[40:43], v[28:31], v[216:223], v2
    v_smfmac_f32_16x16x64_bf16 v[40:43], v[60:63], v[224:231], v2
    v_cvt_pk_bf16_f32 v36, v36, v37
    v_cvt_pk_bf16_f32 v37, v38, v39
    v_smfmac_f32_16x16x64_bf16 v[40:43], v[64:67], v[232:239], v2
    v_or_b32 v36, 1, v36
    v_or_b32 v37, 1, v37
    v_mfma_f32_16x16x32_bf16 v[44:47], v[24:27], v[240:243], 0
    buffer_store_dwordx2 v[36:37], v4, s[52:55], s62 offen sc1
    v_mfma_f32_16x16x32_bf16 v[44:47], v[28:31], v[244:247], v[44:47]
    v_cvt_pk_bf16_f32 v40, v40, v41
    v_cvt_pk_bf16_f32 v41, v42, v43
    v_mfma_f32_16x16x32_bf16 v[44:47], v[60:63], v[248:251], v[44:47]
    v_or_b32 v40, 1, v40
    v_or_b32 v41, 1, v41
    v_mfma_f32_16x16x32_bf16 v[44:47], v[64:67], v[252:255], v[44:47]
    buffer_store_dwordx2 v[40:41], v4, s[52:55], s94 offen sc1
    s_nop 6
    v_cvt_pk_bf16_f32 v44, v44, v45
    v_cvt_pk_bf16_f32 v45, v46, v47
    v_or_b32 v44, 1, v44
    v_or_b32 v45, 1, v45
    s_mov_b64 exec, s[72:73]
    buffer_store_dwordx2 v[44:45], v4, s[52:55], s60 offen sc1
    s_mov_b64 exec, -1
    s_cmp_eq_u32 s70, 0
    s_cbranch_scc1 R_noredS1
    s_mov_b32 s60, s84
R_rdlS1:
    s_cmp_eq_u32 s60, 0
    s_cbranch_scc1 R_rgoS1
    s_sleep 1
    s_sub_u32 s60, s60, 1
    s_branch R_rdlS1
R_rgoS1:
    buffer_load_dwordx4 v[52:55], v5, s[52:55], s65 offen offset:0 sc1
    buffer_load_dwordx4 v[56:59], v5, s[52:55], s65 offen offset:1024 sc1
    buffer_load_dwordx4 v[76:79], v5, s[52:55], s65 offen offset:2048 sc1
    buffer_load_dwordx4 v[48:51], v5, s[52:55], s65 offen offset:3072 sc1
    v_mov_b32 v24, 0
    v_mov_b32 v25, 0
    v_mov_b32 v26, 0
    v_mov_b32 v27, 0
    v_mov_b32 v28, 0
    v_mov_b32 v29, 0
    v_mov_b32 v30, 0
    v_mov_b32 v31, 0
    v_mov_b32 v32, 0
    v_mov_b32 v33, 0
    v_mov_b32 v34, 0
    v_mov_b32 v35, 0
    v_cndmask_b32 v60, 0, v3, s[86:87]
    v_cndmask_b32 v61, 0, v3, s[88:89]
    v_cndmask_b32 v62, 0, v3, s[90:91]
    v_cndmask_b32 v63, 0, v3, s[92:93]
R_rp0S1:
    s_waitcnt vmcnt(3)
    v_mfma_f32_16x16x32_bf16 v[40:43], v[60:63], v[52:55], 0
    v_bitop3_b32 v64, v52, v53, v54 bitop3:0x80
    v_bitop3_b32 v64, v64, v55, v55 bitop3:0x80
    s_waitcnt vmcnt(2)
    v_mfma_f32_16x16x32_bf16 v[40:43], v[60:63], v[56:59], v[40:43]
    v_bitop3_b32 v64, v64, v56, v57 bitop3:0x80
    v_bitop3_b32 v64, v64, v58, v59 bitop3:0x80
    s_waitcnt vmcnt(1)
    v_mfma_f32_16x16x32_bf16 v[40:43], v[60:63], v[76:79], v[40:43]
    v_bitop3_b32 v64, v64, v76, v77 bitop3:0x80
    v_bitop3_b32 v64, v64, v78, v79 bitop3:0x80
    s_waitcnt vmcnt(0)
    v_mfma_f32_16x16x32_bf16 v[40:43], v[60:63], v[48:51], v[40:43]
    v_bitop3_b32 v64, v64, v48, v49 bitop3:0x80
    v_bitop3_b32 v64, v64, v50, v51 bitop3:0x80
    v_and_b32 v64, 1, v64
    v_cmp_ne_u32 vcc, 1, v64
    s_cbranch_vccnz R_rf0S1
R_rdoneS1:
    s_nop 0
    s_nop 0
    s_nop 0
    v_add_f32_dpp v64, v40, v40 row_ror:8 row_mask:0xf bank_mask:0xf
    v_add_f32_dpp v65, v41, v41 row_ror:8 row_mask:0xf bank_mask:0xf
    v_cvt_pk_bf16_f32 v64, v64, v65
    v_min_u32 v0, -2, v64
    buffer_store_dword v0, v6, s[52:55], s67 offen sc1
    s_branch R_loopS0
R_noredS1:
    v_mov_b32 v24, 0
    v_mov_b32 v25, 0
    v_mov_b32 v26, 0
    v_mov_b32 v27, 0
    v_mov_b32 v28, 0
    v_mov_b32 v29, 0
    v_mov_b32 v30, 0
    v_mov_b32 v31, 0
    v_mov_b32 v32, 0
    v_mov_b32 v33, 0
    v_mov_b32 v34, 0
    v_mov_b32 v35, 0
    s_cmp_lg_u32 s56, 3
    s_cbranch_scc1 R_nkvS1
    v_mov_b32 v15, s64
    s_cmp_ge_u32 s5, 64
    s_cbranch_scc1 R_nkvS1
    s_waitcnt vmcnt(7)
    v_cmp_ne_u32 vcc, 4, v0
    s_ff1_i32_b64 s5, vcc
    s_cmp_lt_i32 s5, 0
    s_cselect_b32 s5, 64, s5
    s_cselect_b32 s3, 0x40000000, s3
    s_add_u32 s60, s64, 3
    s_min_u32 s60, s60, 64
    s_cmp_ge_u32 s5, s60
    s_cbranch_scc1 R_kvS1_ok
    s_waitcnt vmcnt(0)
    s_lshl_b32 s61, s58, 8
    s_add_u32 s61, s61, 86573056
    v_lshrrev_b32 v0, 2, v7
    v_and_b32 v0, 255, v0
R_kvS1_p:
    buffer_load_dword v64, v0, s[52:55], s61 offen sc1
    s_sub_u32 s63, s63, 1
    s_cbranch_scc1 M_abort
    s_waitcnt vmcnt(0)
    v_cmp_ne_u32 vcc, 4, v64
    s_ff1_i32_b64 s5, vcc
    s_cmp_lt_i32 s5, 0
    s_cselect_b32 s5, 64, s5
    s_cmp_ge_u32 s5, s60
    s_cbranch_scc1 R_kvS1_ok
    s_sleep 4
    s_branch R_kvS1_p
R_kvS1_ok:
R_nkvS1:
    s_sleep 9
    s_branch R_loopS0x
R_rf0S1:
    buffer_load_dwordx4 v[52:55], v5, s[52:55], s65 offen offset:0 sc1
    buffer_load_dwordx4 v[56:59], v5, s[52:55], s65 offen offset:1024 sc1
    buffer_load_dwordx4 v[76:79], v5, s[52:55], s65 offen offset:2048 sc1
    buffer_load_dwordx4 v[48:51], v5, s[52:55], s65 offen offset:3072 sc1
    s_sub_u32 s63, s63, 1
    s_cbranch_scc1 M_abort
    s_branch R_rp0S1
R_cfS1:
    buffer_load_dwordx4 v[36:39], v1, s[52:55], s61 offen sc1
    buffer_load_dwordx4 v[40:43], v1, s[52:55], s60 offen offset:1024 sc1
    s_sub_u32 s63, s63, 1
    s_cbranch_scc1 M_abort
    s_waitcnt vmcnt(3)
    ds_write_b128 v1, v[44:47] offset:47104
    v_max3_u32 v0, v44, v45, v46
    s_waitcnt vmcnt(2)
    ds_write_b128 v1, v[48:51] offset:48128
    v_max3_u32 v0, v0, v47, v48
    v_max3_u32 v0, v0, v49, v50
    v_max_u32 v0, v0, v51
    v_cmp_eq_u32 vcc, -1, v0
    s_cbranch_vccz R_cokS1
    buffer_load_dwordx4 v[44:47], v1, s[52:55], s61 offen sc1
    buffer_load_dwordx4 v[48:51], v1, s[52:55], s60 offen offset:1024 sc1
    s_sub_u32 s63, s63, 1
    s_cbranch_scc1 M_abort
    s_branch R_cpS1
R_cokS1:
    s_waitcnt vmcnt(0)
    s_branch R_cdjS1
R_slowS1:
    s_sub_u32 s97, s69, 98304
    s_waitcnt lgkmcnt(0)
    s_nop 7
    v_mov_b32 v24, 0
    v_mov_b32 v25, 0
    v_mov_b32 v26, 0
    v_mov_b32 v27, 0
    v_mov_b32 v28, 0
    v_mov_b32 v29, 0
    v_mov_b32 v30, 0
    v_mov_b32 v31, 0
    v_mov_b32 v32, 0
    v_mov_b32 v33, 0
    v_mov_b32 v34, 0
    v_mov_b32 v35, 0
    ds_read_b128 v[52:55], v9 offset:0
    ds_read_b128 v[56:59], v9 offset:1024
    ds_read_b128 v[60:63], v9 offset:2048
    ds_read_b128 v[64:67], v9 offset:3072
R_sp0_S1:
    buffer_load_dwordx4 v[36:39], v8, s[52:55], s97 offen sc1
    buffer_load_dwordx4 v[40:43], v8, s[52:55], s97 offen offset:512 sc1
    s_sub_u32 s63, s63, 1
    s_cbranch_scc1 M_abort
    s_waitcnt vmcnt(0) lgkmcnt(0)
    v_max3_u32 v0, v36, v37, v38
    v_max3_u32 v0, v0, v39, v40
    v_max3_u32 v0, v0, v41, v42
    v_max_u32 v0, v0, v43
    v_cmp_eq_u32 vcc, -1, v0
    s_cbranch_vccnz R_sp0_S1
    v_smfmac_f32_16x16x64_bf16 v[24:27], v[36:39], a[0:7], v2
    v_smfmac_f32_16x16x64_bf16 v[28:31], v[36:39], a[144:151], v2
    v_smfmac_f32_16x16x64_bf16 v[32:35], v[36:39], v[52:59], v2
    v_smfmac_f32_16x16x64_bf16 v[24:27], v[40:43], a[8:15], v2
    v_smfmac_f32_16x16x64_bf16 v[28:31], v[40:43], a[152:159], v2
    v_smfmac_f32_16x16x64_bf16 v[32:35], v[40:43], v[60:67], v2
    s_add_u32 s97, s97, 1024
    ds_read_b128 v[52:55], v9 offset:4096
    ds_read_b128 v[56:59], v9 offset:5120
    ds_read_b128 v[60:63], v9 offset:6144
    ds_read_b128 v[64:67], v9 offset:7168
R_sp1_S1:
    buffer_load_dwordx4 v[36:39], v8, s[52:55], s97 offen sc1
    buffer_load_dwordx4 v[40:43], v8, s[52:55], s97 offen offset:512 sc1
    s_sub_u32 s63, s63, 1
    s_cbranch_scc1 M_abort
    s_waitcnt vmcnt(0) lgkmcnt(0)
    v_max3_u32 v0, v36, v37, v38
    v_max3_u32 v0, v0, v39, v40
    v_max3_u32 v0, v0, v41, v42
    v_max_u32 v0, v0, v43
    v_cmp_eq_u32 vcc, -1, v0
    s_cbranch_vccnz R_sp1_S1
    v_smfmac_f32_16x16x64_bf16 v[24:27], v[36:39], a[16:23], v2
    v_smfmac_f32_16x16x64_bf16 v[28:31], v[36:39], a[160:167], v2
    v_smfmac_f32_16x16x64_bf16 v[32:35], v[36:39], v[52:59], v2
    v_smfmac_f32_16x16x64_bf16 v[24:27], v[40:43], a[24:31], v2
    v_smfmac_f32_16x16x64_bf16 v[28:31], v[40:43], a[168:175], v2
    v_smfmac_f32_16x16x64_bf16 v[32:35], v[40:43], v[60:67], v2
    s_add_u32 s97, s97, 1024
    ds_read_b128 v[52:55], v9 offset:8192
    ds_read_b128 v[56:59], v9 offset:9216
    ds_read_b128 v[60:63], v9 offset:10240
    ds_read_b128 v[64:67], v9 offset:11264
R_sp2_S1:
    buffer_load_dwordx4 v[36:39], v8, s[52:55], s97 offen sc1
    buffer_load_dwordx4 v[40:43], v8, s[52:55], s97 offen offset:512 sc1
    s_sub_u32 s63, s63, 1
    s_cbranch_scc1 M_abort
    s_waitcnt vmcnt(0) lgkmcnt(0)
    v_max3_u32 v0, v36, v37, v38
    v_max3_u32 v0, v0, v39, v40
    v_max3_u32 v0, v0, v41, v42
    v_max_u32 v0, v0, v43
    v_cmp_eq_u32 vcc, -1, v0
    s_cbranch_vccnz R_sp2_S1
    v_smfmac_f32_16x16x64_bf16 v[24:27], v[36:39], a[32:39], v2
    v_smfmac_f32_16x16x64_bf16 v[28:31], v[36:39], a[176:183], v2
    v_smfmac_f32_16x16x64_bf16 v[32:35], v[36:39], v[52:59], v2
    v_smfmac_f32_16x16x64_bf16 v[24:27], v[40:43], a[40:47], v2
    v_smfmac_f32_16x16x64_bf16 v[28:31], v[40:43], a[184:191], v2
    v_smfmac_f32_16x16x64_bf16 v[32:35], v[40:43], v[60:67], v2
    s_add_u32 s97, s97, 1024
    ds_read_b128 v[52:55], v9 offset:12288
    ds_read_b128 v[56:59], v9 offset:13312
    ds_read_b128 v[60:63], v9 offset:14336
    ds_read_b128 v[64:67], v9 offset:15360
R_sp3_S1:
    buffer_load_dwordx4 v[36:39], v8, s[52:55], s97 offen sc1
    buffer_load_dwordx4 v[40:43], v8, s[52:55], s97 offen offset:512 sc1
    s_sub_u32 s63, s63, 1
    s_cbranch_scc1 M_abort
    s_waitcnt vmcnt(0) lgkmcnt(0)
    v_max3_u32 v0, v36, v37, v38
    v_max3_u32 v0, v0, v39, v40
    v_max3_u32 v0, v0, v41, v42
    v_max_u32 v0, v0, v43
    v_cmp_eq_u32 vcc, -1, v0
    s_cbranch_vccnz R_sp3_S1
    v_smfmac_f32_16x16x64_bf16 v[24:27], v[36:39], a[48:55], v2
    v_smfmac_f32_16x16x64_bf16 v[28:31], v[36:39], a[192:199], v2
    v_smfmac_f32_16x16x64_bf16 v[32:35], v[36:39], v[52:59], v2
    v_smfmac_f32_16x16x64_bf16 v[24:27], v[40:43], a[56:63], v2
    v_smfmac_f32_16x16x64_bf16 v[28:31], v[40:43], a[200:207], v2
    v_smfmac_f32_16x16x64_bf16 v[32:35], v[40:43], v[60:67], v2
    s_add_u32 s97, s97, 1024
    ds_read_b128 v[52:55], v9 offset:16384
    ds_read_b128 v[56:59], v9 offset:17408
    ds_read_b128 v[60:63], v9 offset:18432
    ds_read_b128 v[64:67], v9 offset:19456
R_sp4_S1:
    buffer_load_dwordx4 v[36:39], v8, s[52:55], s97 offen sc1
    buffer_load_dwordx4 v[40:43], v8, s[52:55], s97 offen offset:512 sc1
    s_sub_u32 s63, s63, 1
    s_cbranch_scc1 M_abort
    s_waitcnt vmcnt(0) lgkmcnt(0)
    v_max3_u32 v0, v36, v37, v38
    v_max3_u32 v0, v0, v39, v40
    v_max3_u32 v0, v0, v41, v42
    v_max_u32 v0, v0, v43
    v_cmp_eq_u32 vcc, -1, v0
    s_cbranch_vccnz R_sp4_S1
    v_smfmac_f32_16x16x64_bf16 v[24:27], v[36:39], a[64:71], v2
    v_smfmac_f32_16x16x64_bf16 v[28:31], v[36:39], a[208:215], v2
    v_smfmac_f32_16x16x64_bf16 v[32:35], v[36:39], v[52:59], v2
    v_smfmac_f32_16x16x64_bf16 v[24:27], v[40:43], a[72:79], v2
    v_smfmac_f32_16x16x64_bf16 v[28:31], v[40:43], a[216:223], v2
    v_smfmac_f32_16x16x64_bf16 v[32:35], v[40:43], v[60:67], v2
    s_add_u32 s97, s97, 1024
    ds_read_b128 v[52:55], v9 offset:20480
    ds_read_b128 v[56:59], v9 offset:21504
    ds_read_b128 v[60:63], v9 offset:22528
    ds_read_b128 v[64:67], v9 offset:23552
R_sp5_S1:
    buffer_load_dwordx4 v[36:39], v8, s[52:55], s97 offen sc1
    buffer_load_dwordx4 v[40:43], v8, s[52:55], s97 offen offset:512 sc1
    s_sub_u32 s63, s63, 1
    s_cbranch_scc1 M_abort
    s_waitcnt vmcnt(0) lgkmcnt(0)
    v_max3_u32 v0, v36, v37, v38
    v_max3_u32 v0, v0, v39, v40
    v_max3_u32 v0, v0, v41, v42
    v_max_u32 v0, v0, v43
    v_cmp_eq_u32 vcc, -1, v0
    s_cbranch_vccnz R_sp5_S1
    v_smfmac_f32_16x16x64_bf16 v[24:27], v[36:39], a[80:87], v2
    v_smfmac_f32_16x16x64_bf16 v[28:31], v[36:39], a[224:231], v2
    v_smfmac_f32_16x16x64_bf16 v[32:35], v[36:39], v[52:59], v2
    v_smfmac_f32_16x16x64_bf16 v[24:27], v[40:43], a[88:95], v2
    v_smfmac_f32_16x16x64_bf16 v[28:31], v[40:43], a[232:239], v2
    v_smfmac_f32_16x16x64_bf16 v[32:35], v[40:43], v[60:67], v2
    s_add_u32 s97, s97, 1024
    ds_read_b128 v[52:55], v9 offset:24576
    ds_read_b128 v[56:59], v9 offset:25600
    ds_read_b128 v[60:63], v9 offset:26624
    ds_read_b128 v[64:67], v9 offset:27648
R_sp6_S1:
    buffer_load_dwordx4 v[36:39], v8, s[52:55], s97 offen sc1
    buffer_load_dwordx4 v[40:43], v8, s[52:55], s97 offen offset:512 sc1
    s_sub_u32 s63, s63, 1
    s_cbranch_scc1 M_abort
    s_waitcnt vmcnt(0) lgkmcnt(0)
    v_max3_u32 v0, v36, v37, v38
    v_max3_u32 v0, v0, v39, v40
    v_max3_u32 v0, v0, v41, v42
    v_max_u32 v0, v0, v43
    v_cmp_eq_u32 vcc, -1, v0
    s_cbranch_vccnz R_sp6_S1
    v_smfmac_f32_16x16x64_bf16 v[24:27], v[36:39], a[96:103], v2
    v_smfmac_f32_16x16x64_bf16 v[28:31], v[36:39], a[240:247], v2
    v_smfmac_f32_16x16x64_bf16 v[32:35], v[36:39], v[52:59], v2
    v_smfmac_f32_16x16x64_bf16 v[24:27], v[40:43], a[104:111], v2
    v_smfmac_f32_16x16x64_bf16 v[28:31], v[40:43], a[248:255], v2
    v_smfmac_f32_16x16x64_bf16 v[32:35], v[40:43], v[60:67], v2
    s_add_u32 s97, s97, 1024
    ds_read_b128 v[52:55], v9 offset:28672
    ds_read_b128 v[56:59], v9 offset:29696
    ds_read_b128 v[60:63], v9 offset:30720
    ds_read_b128 v[64:67], v9 offset:31744
R_sp7_S1:
    buffer_load_dwordx4 v[36:39], v8, s[52:55], s97 offen sc1
    buffer_load_dwordx4 v[40:43], v8, s[52:55], s97 offen offset:512 sc1
    s_sub_u32 s63, s63, 1
    s_cbranch_scc1 M_abort
    s_waitcnt vmcnt(0) lgkmcnt(0)
    v_max3_u32 v0, v36, v37, v38
    v_max3_u32 v0, v0, v39, v40
    v_max3_u32 v0, v0, v41, v42
    v_max_u32 v0, v0, v43
    v_cmp_eq_u32 vcc, -1, v0
    s_cbranch_vccnz R_sp7_S1
    v_smfmac_f32_16x16x64_bf16 v[24:27], v[36:39], a[112:119], v2
    v_smfmac_f32_16x16x64_bf16 v[28:31], v[36:39], v[80:87], v2
    v_smfmac_f32_16x16x64_bf16 v[32:35], v[36:39], v[52:59], v2
    v_smfmac_f32_16x16x64_bf16 v[24:27], v[40:43], a[120:127], v2
    v_smfmac_f32_16x16x64_bf16 v[28:31], v[40:43], v[88:95], v2
    v_smfmac_f32_16x16x64_bf16 v[32:35], v[40:43], v[60:67], v2
    s_add_u32 s97, s97, 1024
    ds_read_b128 v[52:55], v9 offset:32768
    ds_read_b128 v[56:59], v9 offset:33792
R_sp8_S1:
    buffer_load_dwordx4 v[36:39], v8, s[52:55], s97 offen sc1
    buffer_load_dwordx4 v[40:43], v8, s[52:55], s97 offen offset:512 sc1
    s_sub_u32 s63, s63, 1
    s_cbranch_scc1 M_abort
    s_waitcnt vmcnt(0) lgkmcnt(0)
    v_max3_u32 v0, v36, v37, v38
    v_max3_u32 v0, v0, v39, v40
    v_max3_u32 v0, v0, v41, v42
    v_max_u32 v0, v0, v43
    v_cmp_eq_u32 vcc, -1, v0
    s_cbranch_vccnz R_sp8_S1
    v_smfmac_f32_16x16x64_bf16 v[24:27], v[36:39], a[128:135], v2
    v_smfmac_f32_16x16x64_bf16 v[28:31], v[36:39], v[96:103], v2
    v_smfmac_f32_16x16x64_bf16 v[32:35], v[36:39], v[52:59], v2
    v_smfmac_f32_16x16x64_bf16 v[24:27], v[40:43], a[136:143], v2
    v_smfmac_f32_16x16x64_bf16 v[28:31], v[40:43], v[104:111], v2
    v_smfmac_f32_16x16x64_bf16 v[32:35], v[40:43], v[16:23], v2
    s_add_u32 s97, s97, 1024
    s_nop 7
    v_cvt_pk_bf16_f32 v24, v24, v25
    v_cvt_pk_bf16_f32 v25, v26, v27
    ds_write_b64 v10, v[24:25]
    v_cvt_pk_bf16_f32 v36, v28, v29
    v_cvt_pk_bf16_f32 v37, v30, v31
    ds_write_b64 v10, v[36:37] offset:36864
    ds_read_b128 v[52:55], v12 offset:58368
    ds_read_b128 v[56:59], v12 offset:58496
    ds_read_b128 v[60:63], v12 offset:60416
    ds_read_b128 v[64:67], v12 offset:60544
    s_waitcnt lgkmcnt(0)
    s_branch R_slowretS1
R_done:
    s_lshr_b32 s62, s71, 1
    s_add_u32 s61, s62, 52396032
    s_add_u32 s95, s62, 52393984
    v_min_u32 v36, -2, v36
    v_min_u32 v37, -2, v37
    buffer_store_dwordx2 v[36:37], v10, s[52:55], s95 offen sc1
    v_cvt_pk_bf16_f32 v38, v32, v33
    v_cvt_pk_bf16_f32 v39, v34, v35
    v_min_u32 v38, -2, v38
    v_min_u32 v39, -2, v39
    buffer_store_dwordx2 v[38:39], v10, s[52:55], s61 offen sc1
    s_waitcnt vmcnt(0) lgkmcnt(0)
    s_barrier
    s_cmp_lg_u32 s56, 3
    s_cbranch_scc1 R_nfin
    v_mov_b32 v0, 64
    v_mov_b32 v76, s4
    s_mov_b64 exec, 1
    buffer_store_dword v0, v76, s[52:55], 0 offen sc1
    s_mov_b64 exec, -1
    s_waitcnt vmcnt(0)
R_nfin:
    s_branch M_end
M_worker:
    s_sub_u32 s76, s58, 32
    s_lshr_b32 s60, s76, 3
    s_mul_hi_u32 s61, s60, 613566757
    s_mul_i32 s62, s61, 7
    s_sub_u32 s78, s60, s62
    s_lshl_b32 s61, s61, 3
    s_and_b32 s62, s76, 7
    s_add_u32 s77, s61, s62
    s_mul_hi_u32 s80, s76, 238609295
    s_mul_i32 s60, s80, 18
    s_sub_u32 s79, s76, s60
    s_and_b32 s60, s80, 11
    s_cmp_eq_u32 s60, 0
    s_cselect_b32 s60, 4, 0
    s_xor_b32 s80, s80, s60
    s_mul_hi_u32 s86, s76, 858993460
    s_mul_i32 s60, s86, 5
    s_sub_u32 s85, s76, s60
    s_mul_i32 s87, s56, 224
    s_add_u32 s87, s87, s76
    v_lshrrev_b32 v72, 4, v1
    v_lshlrev_b32 v73, 2, v72
    v_and_b32 v68, 15, v1
    v_xor_b32 v68, v68, v73
    v_lshlrev_b32 v68, 4, v68
    s_lshl_b32 s60, s56, 2
    v_add_u32 v72, s60, v72
    v_lshlrev_b32 v72, 13, v72
    v_add_u32 v68, v68, v72
    s_lshl_b32 s60, s77, 8
    v_add_u32 v68, s60, v68
    v_bfe_u32 v72, v1, 2, 2
    v_lshrrev_b32 v73, 5, v1
    v_lshl_add_u32 v73, v73, 3, v72
    v_lshlrev_b32 v69, 8, v73
    v_bfe_u32 v73, v1, 4, 1
    v_lshlrev_b32 v73, 1, v73
    v_bfe_u32 v70, v1, 1, 1
    v_add_u32 v73, v73, v70
    s_lshl_b32 s60, s56, 2
    v_add_u32 v73, s60, v73
    v_lshlrev_b32 v72, 2, v72
    v_xor_b32 v73, v73, v72
    v_lshl_add_u32 v69, v73, 4, v69
    v_and_b32 v72, 1, v1
    v_lshl_add_u32 v69, v72, 3, v69
    v_add_u32 v70, 0x10000, v69
    v_add_u32 v71, 0x20000, v69
    s_lshl_b32 s61, s56, 10
    v_lshrrev_b32 v72, 3, v1
    v_and_b32 v73, 6, v72
    s_lshr_b32 s60, s56, 1
    v_or_b32 v73, s60, v73
    v_and_b32 v66, 7, v1
    v_xor_b32 v66, v66, v73
    v_lshlrev_b32 v66, 4, v66
    s_lshl_b32 s60, s56, 3
    v_add_u32 v72, s60, v72
    s_mov_b32 s60, 1152
    v_mul_lo_u32 v72, v72, s60
    v_add_u32 v66, v66, v72
    v_and_b32 v72, 6, v1
    v_bfe_u32 v73, v1, 4, 1
    v_or_b32 v72, v72, v73
    v_lshrrev_b32 v73, 5, v1
    v_xor_b32 v72, v72, v73
    v_and_b32 v73, 31, v1
    v_lshlrev_b32 v73, 7, v73
    v_xor_b32 v62, 0, v72
    v_lshlrev_b32 v62, 4, v62
    v_add_u32 v62, v62, v73
    v_xor_b32 v63, 2, v72
    v_lshlrev_b32 v63, 4, v63
    v_add_u32 v63, v63, v73
    v_xor_b32 v64, 4, v72
    v_lshlrev_b32 v64, 4, v64
    v_add_u32 v64, v64, v73
    v_xor_b32 v65, 6, v72
    v_lshlrev_b32 v65, 4, v65
    v_add_u32 v65, v65, v73
    v_lshlrev_b32 v67, 4, v1
    s_lshl_b32 s60, s56, 11
    v_add_u32 v67, s60, v67
    v_mov_b32 v75, 1
    v_lshlrev_b32 v72, 4, v0
    s_mov_b32 s63, s78
    s_mul_i32 s65, s63, 36864
    s_mov_b32 s64, s61
    s_add_u32 m0, s61, 0
    s_mov_b32 s62, 0
    buffer_load_dwordx4 v68, s[32:35], s62 offen lds
    s_add_u32 m0, s61, 4096
    s_mov_b32 s62, 131072
    buffer_load_dwordx4 v68, s[32:35], s62 offen lds
    s_add_u32 m0, s61, 8192
    s_mov_b32 s62, 262144
    buffer_load_dwordx4 v68, s[32:35], s62 offen lds
    s_add_u32 m0, s61, 12288
    s_mov_b32 s62, 393216
    buffer_load_dwordx4 v68, s[32:35], s62 offen lds
    s_add_u32 m0, s61, 16384
    s_mov_b32 s62, 524288
    buffer_load_dwordx4 v68, s[32:35], s62 offen lds
    s_add_u32 m0, s61, 20480
    s_mov_b32 s62, 655360
    buffer_load_dwordx4 v68, s[32:35], s62 offen lds
    s_add_u32 m0, s61, 24576
    s_mov_b32 s62, 786432
    buffer_load_dwordx4 v68, s[32:35], s62 offen lds
    s_add_u32 m0, s61, 28672
    s_mov_b32 s62, 917504
    buffer_load_dwordx4 v68, s[32:35], s62 offen lds
    s_add_u32 m0, s61, 32768
    s_mov_b32 s62, 1048576
    buffer_load_dwordx4 v68, s[32:35], s62 offen lds
    s_add_u32 m0, s61, 36864
    s_mov_b32 s62, 1179648
    buffer_load_dwordx4 v68, s[32:35], s62 offen lds
    s_add_u32 m0, s61, 40960
    s_mov_b32 s62, 1310720
    buffer_load_dwordx4 v68, s[32:35], s62 offen lds
    s_add_u32 m0, s61, 45056
    s_mov_b32 s62, 1441792
    buffer_load_dwordx4 v68, s[32:35], s62 offen lds
    s_add_u32 m0, s61, 49152
    s_mov_b32 s62, 1572864
    buffer_load_dwordx4 v68, s[32:35], s62 offen lds
    s_add_u32 m0, s61, 53248
    s_mov_b32 s62, 1703936
    buffer_load_dwordx4 v68, s[32:35], s62 offen lds
    s_add_u32 m0, s61, 57344
    s_mov_b32 s62, 1835008
    buffer_load_dwordx4 v68, s[32:35], s62 offen lds
    s_add_u32 m0, s61, 61440
    s_mov_b32 s62, 1966080
    buffer_load_dwordx4 v68, s[32:35], s62 offen lds
    s_add_u32 m0, s61, 65536
    s_mov_b32 s62, 2097152
    buffer_load_dwordx4 v68, s[32:35], s62 offen lds
    s_add_u32 m0, s61, 69632
    s_mov_b32 s62, 2228224
    buffer_load_dwordx4 v68, s[32:35], s62 offen lds
    s_add_u32 m0, s61, 73728
    s_mov_b32 s62, 2359296
    buffer_load_dwordx4 v68, s[32:35], s62 offen lds
    s_add_u32 m0, s61, 77824
    s_mov_b32 s62, 2490368
    buffer_load_dwordx4 v68, s[32:35], s62 offen lds
    s_add_u32 m0, s61, 81920
    s_mov_b32 s62, 2621440
    buffer_load_dwordx4 v68, s[32:35], s62 offen lds
    s_add_u32 m0, s61, 86016
    s_mov_b32 s62, 2752512
    buffer_load_dwordx4 v68, s[32:35], s62 offen lds
    s_add_u32 m0, s61, 90112
    s_mov_b32 s62, 2883584
    buffer_load_dwordx4 v68, s[32:35], s62 offen lds
    s_add_u32 m0, s61, 94208
    s_mov_b32 s62, 3014656
    buffer_load_dwordx4 v68, s[32:35], s62 offen lds
    s_add_u32 m0, s61, 98304
    s_mov_b32 s62, 3145728
    buffer_load_dwordx4 v68, s[32:35], s62 offen lds
    s_add_u32 m0, s61, 102400
    s_mov_b32 s62, 3276800
    buffer_load_dwordx4 v68, s[32:35], s62 offen lds
    s_add_u32 m0, s61, 106496
    s_mov_b32 s62, 3407872
    buffer_load_dwordx4 v68, s[32:35], s62 offen lds
    s_add_u32 m0, s61, 110592
    s_mov_b32 s62, 3538944
    buffer_load_dwordx4 v68, s[32:35], s62 offen lds
    s_add_u32 m0, s61, 114688
    s_mov_b32 s62, 3670016
    buffer_load_dwordx4 v68, s[32:35], s62 offen lds
    s_add_u32 m0, s61, 118784
    s_mov_b32 s62, 3801088
    buffer_load_dwordx4 v68, s[32:35], s62 offen lds
    s_add_u32 m0, s61, 122880
    s_mov_b32 s62, 3932160
    buffer_load_dwordx4 v68, s[32:35], s62 offen lds
    s_add_u32 m0, s61, 126976
    s_mov_b32 s62, 4063232
    buffer_load_dwordx4 v68, s[32:35], s62 offen lds
    s_add_u32 m0, s61, 131072
    s_mov_b32 s62, 4194304
    buffer_load_dwordx4 v68, s[32:35], s62 offen lds
    s_add_u32 m0, s61, 135168
    s_mov_b32 s62, 4325376
    buffer_load_dwordx4 v68, s[32:35], s62 offen lds
    s_add_u32 m0, s61, 139264
    s_mov_b32 s62, 4456448
    buffer_load_dwordx4 v68, s[32:35], s62 offen lds
    s_add_u32 m0, s61, 143360
    s_mov_b32 s62, 4587520
    buffer_load_dwordx4 v68, s[32:35], s62 offen lds
    s_waitcnt vmcnt(32)
    s_barrier
    ds_read_b64_tr_b16 a[144:145], v69 offset:0
    ds_read_b64_tr_b16 a[146:147], v69 offset:1024
    ds_read_b64_tr_b16 a[148:149], v69 offset:4096
    ds_read_b64_tr_b16 a[150:151], v69 offset:5120
    ds_read_b64_tr_b16 a[152:153], v69 offset:8192
    ds_read_b64_tr_b16 a[154:155], v69 offset:9216
    ds_read_b64_tr_b16 a[156:157], v69 offset:12288
    ds_read_b64_tr_b16 a[158:159], v69 offset:13312
    s_waitcnt lgkmcnt(0)
    s_barrier
    s_add_u32 m0, s61, 0
    s_mov_b32 s62, 0
    buffer_load_dwordx4 v68, s[36:39], s62 offen lds
    s_add_u32 m0, s61, 4096
    s_mov_b32 s62, 131072
    buffer_load_dwordx4 v68, s[36:39], s62 offen lds
    s_add_u32 m0, s61, 8192
    s_mov_b32 s62, 262144
    buffer_load_dwordx4 v68, s[36:39], s62 offen lds
    s_add_u32 m0, s61, 12288
    s_mov_b32 s62, 393216
    buffer_load_dwordx4 v68, s[36:39], s62 offen lds
    s_waitcnt vmcnt(32)
    s_barrier
    ds_read_b64_tr_b16 a[160:161], v69 offset:16384
    ds_read_b64_tr_b16 a[162:163], v69 offset:17408
    ds_read_b64_tr_b16 a[164:165], v69 offset:20480
    ds_read_b64_tr_b16 a[166:167], v69 offset:21504
    ds_read_b64_tr_b16 a[168:169], v69 offset:24576
    ds_read_b64_tr_b16 a[170:171], v69 offset:25600
    ds_read_b64_tr_b16 a[172:173], v69 offset:28672
    ds_read_b64_tr_b16 a[174:175], v69 offset:29696
    s_waitcnt lgkmcnt(0)
    s_barrier
    s_add_u32 m0, s61, 16384
    s_mov_b32 s62, 524288
    buffer_load_dwordx4 v68, s[36:39], s62 offen lds
    s_add_u32 m0, s61, 20480
    s_mov_b32 s62, 655360
    buffer_load_dwordx4 v68, s[36:39], s62 offen lds
    s_add_u32 m0, s61, 24576
    s_mov_b32 s62, 786432
    buffer_load_dwordx4 v68, s[36:39], s62 offen lds
    s_add_u32 m0, s61, 28672
    s_mov_b32 s62, 917504
    buffer_load_dwordx4 v68, s[36:39], s62 offen lds
    s_waitcnt vmcnt(32)
    s_barrier
    ds_read_b64_tr_b16 a[176:177], v69 offset:32768
    ds_read_b64_tr_b16 a[178:179], v69 offset:33792
    ds_read_b64_tr_b16 a[180:181], v69 offset:36864
    ds_read_b64_tr_b16 a[182:183], v69 offset:37888
    ds_read_b64_tr_b16 a[184:185], v69 offset:40960
    ds_read_b64_tr_b16 a[186:187], v69 offset:41984
    ds_read_b64_tr_b16 a[188:189], v69 offset:45056
    ds_read_b64_tr_b16 a[190:191], v69 offset:46080
    s_waitcnt lgkmcnt(0)
    s_barrier
    s_add_u32 m0, s61, 32768
    s_mov_b32 s62, 1048576
    buffer_load_dwordx4 v68, s[36:39], s62 offen lds
    s_add_u32 m0, s61, 36864
    s_mov_b32 s62, 1179648
    buffer_load_dwordx4 v68, s[36:39], s62 offen lds
    s_add_u32 m0, s61, 40960
    s_mov_b32 s62, 1310720
    buffer_load_dwordx4 v68, s[36:39], s62 offen lds
    s_add_u32 m0, s61, 45056
    s_mov_b32 s62, 1441792
    buffer_load_dwordx4 v68, s[36:39], s62 offen lds
    s_waitcnt vmcnt(32)
    s_barrier
    ds_read_b64_tr_b16 a[192:193], v69 offset:49152
    ds_read_b64_tr_b16 a[194:195], v69 offset:50176
    ds_read_b64_tr_b16 a[196:197], v69 offset:53248
    ds_read_b64_tr_b16 a[198:199], v69 offset:54272
    ds_read_b64_tr_b16 a[200:201], v69 offset:57344
    ds_read_b64_tr_b16 a[202:203], v69 offset:58368
    ds_read_b64_tr_b16 a[204:205], v69 offset:61440
    ds_read_b64_tr_b16 a[206:207], v69 offset:62464
    s_waitcnt lgkmcnt(0)
    s_barrier
    s_add_u32 m0, s61, 49152
    s_mov_b32 s62, 1572864
    buffer_load_dwordx4 v68, s[36:39], s62 offen lds
    s_add_u32 m0, s61, 53248
    s_mov_b32 s62, 1703936
    buffer_load_dwordx4 v68, s[36:39], s62 offen lds
    s_add_u32 m0, s61, 57344
    s_mov_b32 s62, 1835008
    buffer_load_dwordx4 v68, s[36:39], s62 offen lds
    s_add_u32 m0, s61, 61440
    s_mov_b32 s62, 1966080
    buffer_load_dwordx4 v68, s[36:39], s62 offen lds
    s_waitcnt vmcnt(32)
    s_barrier
    ds_read_b64_tr_b16 a[208:209], v70 offset:0
    ds_read_b64_tr_b16 a[210:211], v70 offset:1024
    ds_read_b64_tr_b16 a[212:213], v70 offset:4096
    ds_read_b64_tr_b16 a[214:215], v70 offset:5120
    ds_read_b64_tr_b16 a[216:217], v70 offset:8192
    ds_read_b64_tr_b16 a[218:219], v70 offset:9216
    ds_read_b64_tr_b16 a[220:221], v70 offset:12288
    ds_read_b64_tr_b16 a[222:223], v70 offset:13312
    s_waitcnt lgkmcnt(0)
    s_barrier
    s_add_u32 m0, s61, 65536
    s_mov_b32 s62, 2097152
    buffer_load_dwordx4 v68, s[36:39], s62 offen lds
    s_add_u32 m0, s61, 69632
    s_mov_b32 s62, 2228224
    buffer_load_dwordx4 v68, s[36:39], s62 offen lds
    s_add_u32 m0, s61, 73728
    s_mov_b32 s62, 2359296
    buffer_load_dwordx4 v68, s[36:39], s62 offen lds
    s_add_u32 m0, s61, 77824
    s_mov_b32 s62, 2490368
    buffer_load_dwordx4 v68, s[36:39], s62 offen lds
    s_waitcnt vmcnt(32)
    s_barrier
    ds_read_b64_tr_b16 a[224:225], v70 offset:16384
    ds_read_b64_tr_b16 a[226:227], v70 offset:17408
    ds_read_b64_tr_b16 a[228:229], v70 offset:20480
    ds_read_b64_tr_b16 a[230:231], v70 offset:21504
    ds_read_b64_tr_b16 a[232:233], v70 offset:24576
    ds_read_b64_tr_b16 a[234:235], v70 offset:25600
    ds_read_b64_tr_b16 a[236:237], v70 offset:28672
    ds_read_b64_tr_b16 a[238:239], v70 offset:29696
    s_waitcnt lgkmcnt(0)
    s_barrier
    s_add_u32 m0, s61, 81920
    s_mov_b32 s62, 2621440
    buffer_load_dwordx4 v68, s[36:39], s62 offen lds
    s_add_u32 m0, s61, 86016
    s_mov_b32 s62, 2752512
    buffer_load_dwordx4 v68, s[36:39], s62 offen lds
    s_add_u32 m0, s61, 90112
    s_mov_b32 s62, 2883584
    buffer_load_dwordx4 v68, s[36:39], s62 offen lds
    s_add_u32 m0, s61, 94208
    s_mov_b32 s62, 3014656
    buffer_load_dwordx4 v68, s[36:39], s62 offen lds
    s_waitcnt vmcnt(32)
    s_barrier
    ds_read_b64_tr_b16 a[240:241], v70 offset:32768
    ds_read_b64_tr_b16 a[242:243], v70 offset:33792
    ds_read_b64_tr_b16 a[244:245], v70 offset:36864
    ds_read_b64_tr_b16 a[246:247], v70 offset:37888
    ds_read_b64_tr_b16 a[248:249], v70 offset:40960
    ds_read_b64_tr_b16 a[250:251], v70 offset:41984
    ds_read_b64_tr_b16 a[252:253], v70 offset:45056
    ds_read_b64_tr_b16 a[254:255], v70 offset:46080
    s_waitcnt lgkmcnt(0)
    s_barrier
    s_add_u32 m0, s61, 98304
    s_mov_b32 s62, 3145728
    buffer_load_dwordx4 v68, s[36:39], s62 offen lds
    s_add_u32 m0, s61, 102400
    s_mov_b32 s62, 3276800
    buffer_load_dwordx4 v68, s[36:39], s62 offen lds
    s_add_u32 m0, s61, 106496
    s_mov_b32 s62, 3407872
    buffer_load_dwordx4 v68, s[36:39], s62 offen lds
    s_add_u32 m0, s61, 110592
    s_mov_b32 s62, 3538944
    buffer_load_dwordx4 v68, s[36:39], s62 offen lds
    s_waitcnt vmcnt(32)
    s_barrier
    ds_read_b64_tr_b16 v[80:81], v70 offset:49152
    ds_read_b64_tr_b16 v[82:83], v70 offset:50176
    ds_read_b64_tr_b16 v[84:85], v70 offset:53248
    ds_read_b64_tr_b16 v[86:87], v70 offset:54272
    ds_read_b64_tr_b16 v[88:89], v70 offset:57344
    ds_read_b64_tr_b16 v[90:91], v70 offset:58368
    ds_read_b64_tr_b16 v[92:93], v70 offset:61440
    ds_read_b64_tr_b16 v[94:95], v70 offset:62464
    s_waitcnt lgkmcnt(0)
    s_barrier
    s_add_u32 m0, s61, 114688
    s_mov_b32 s62, 3670016
    buffer_load_dwordx4 v68, s[36:39], s62 offen lds
    s_add_u32 m0, s61, 118784
    s_mov_b32 s62, 3801088
    buffer_load_dwordx4 v68, s[36:39], s62 offen lds
    s_add_u32 m0, s61, 122880
    s_mov_b32 s62, 3932160
    buffer_load_dwordx4 v68, s[36:39], s62 offen lds
    s_add_u32 m0, s61, 126976
    s_mov_b32 s62, 4063232
    buffer_load_dwordx4 v68, s[36:39], s62 offen lds
    s_waitcnt vmcnt(32)
    s_barrier
    ds_read_b64_tr_b16 v[96:97], v71 offset:0
    ds_read_b64_tr_b16 v[98:99], v71 offset:1024
    ds_read_b64_tr_b16 v[100:101], v71 offset:4096
    ds_read_b64_tr_b16 v[102:103], v71 offset:5120
    ds_read_b64_tr_b16 v[104:105], v71 offset:8192
    ds_read_b64_tr_b16 v[106:107], v71 offset:9216
    ds_read_b64_tr_b16 v[108:109], v71 offset:12288
    ds_read_b64_tr_b16 v[110:111], v71 offset:13312
    s_waitcnt lgkmcnt(0)
    s_barrier
    s_add_u32 m0, s61, 131072
    s_mov_b32 s62, 4194304
    buffer_load_dwordx4 v68, s[36:39], s62 offen lds
    s_add_u32 m0, s61, 135168
    s_mov_b32 s62, 4325376
    buffer_load_dwordx4 v68, s[36:39], s62 offen lds
    s_add_u32 m0, s61, 139264
    s_mov_b32 s62, 4456448
    buffer_load_dwordx4 v68, s[36:39], s62 offen lds
    s_add_u32 m0, s61, 143360
    s_mov_b32 s62, 4587520
    buffer_load_dwordx4 v68, s[36:39], s62 offen lds
    s_waitcnt vmcnt(32)
    s_barrier
    ds_read_b64_tr_b16 v[112:113], v69 offset:0
    ds_read_b64_tr_b16 v[114:115], v69 offset:1024
    ds_read_b64_tr_b16 v[116:117], v69 offset:4096
    ds_read_b64_tr_b16 v[118:119], v69 offset:5120
    ds_read_b64_tr_b16 v[120:121], v69 offset:8192
    ds_read_b64_tr_b16 v[122:123], v69 offset:9216
    ds_read_b64_tr_b16 v[124:125], v69 offset:12288
    ds_read_b64_tr_b16 v[126:127], v69 offset:13312
    s_waitcnt lgkmcnt(0)
    s_barrier
    s_add_u32 m0, s61, 0
    s_mov_b32 s62, 0
    buffer_load_dwordx4 v68, s[28:31], s62 offen lds
    s_add_u32 m0, s61, 4096
    s_mov_b32 s62, 131072
    buffer_load_dwordx4 v68, s[28:31], s62 offen lds
    s_add_u32 m0, s61, 8192
    s_mov_b32 s62, 262144
    buffer_load_dwordx4 v68, s[28:31], s62 offen lds
    s_add_u32 m0, s61, 12288
    s_mov_b32 s62, 393216
    buffer_load_dwordx4 v68, s[28:31], s62 offen lds
    s_waitcnt vmcnt(32)
    s_barrier
    ds_read_b64_tr_b16 v[128:129], v69 offset:16384
    ds_read_b64_tr_b16 v[130:131], v69 offset:17408
    ds_read_b64_tr_b16 v[132:133], v69 offset:20480
    ds_read_b64_tr_b16 v[134:135], v69 offset:21504
    ds_read_b64_tr_b16 v[136:137], v69 offset:24576
    ds_read_b64_tr_b16 v[138:139], v69 offset:25600
    ds_read_b64_tr_b16 v[140:141], v69 offset:28672
    ds_read_b64_tr_b16 v[142:143], v69 offset:29696
    s_waitcnt lgkmcnt(0)
    s_barrier
    s_add_u32 m0, s61, 16384
    s_mov_b32 s62, 524288
    buffer_load_dwordx4 v68, s[28:31], s62 offen lds
    s_add_u32 m0, s61, 20480
    s_mov_b32 s62, 655360
    buffer_load_dwordx4 v68, s[28:31], s62 offen lds
    s_add_u32 m0, s61, 24576
    s_mov_b32 s62, 786432
    buffer_load_dwordx4 v68, s[28:31], s62 offen lds
    s_add_u32 m0, s61, 28672
    s_mov_b32 s62, 917504
    buffer_load_dwordx4 v68, s[28:31], s62 offen lds
    s_waitcnt vmcnt(32)
    s_barrier
    ds_read_b64_tr_b16 v[144:145], v69 offset:32768
    ds_read_b64_tr_b16 v[146:147], v69 offset:33792
    ds_read_b64_tr_b16 v[148:149], v69 offset:36864
    ds_read_b64_tr_b16 v[150:151], v69 offset:37888
    ds_read_b64_tr_b16 v[152:153], v69 offset:40960
    ds_read_b64_tr_b16 v[154:155], v69 offset:41984
    ds_read_b64_tr_b16 v[156:157], v69 offset:45056
    ds_read_b64_tr_b16 v[158:159], v69 offset:46080
    s_waitcnt lgkmcnt(0)
    s_barrier
    s_add_u32 m0, s61, 32768
    s_mov_b32 s62, 1048576
    buffer_load_dwordx4 v68, s[28:31], s62 offen lds
    s_add_u32 m0, s61, 36864
    s_mov_b32 s62, 1179648
    buffer_load_dwordx4 v68, s[28:31], s62 offen lds
    s_add_u32 m0, s61, 40960
    s_mov_b32 s62, 1310720
    buffer_load_dwordx4 v68, s[28:31], s62 offen lds
    s_add_u32 m0, s61, 45056
    s_mov_b32 s62, 1441792
    buffer_load_dwordx4 v68, s[28:31], s62 offen lds
    s_waitcnt vmcnt(32)
    s_barrier
    ds_read_b64_tr_b16 v[160:161], v69 offset:49152
    ds_read_b64_tr_b16 v[162:163], v69 offset:50176
    ds_read_b64_tr_b16 v[164:165], v69 offset:53248
    ds_read_b64_tr_b16 v[166:167], v69 offset:54272
    ds_read_b64_tr_b16 v[168:169], v69 offset:57344
    ds_read_b64_tr_b16 v[170:171], v69 offset:58368
    ds_read_b64_tr_b16 v[172:173], v69 offset:61440
    ds_read_b64_tr_b16 v[174:175], v69 offset:62464
    s_waitcnt lgkmcnt(0)
    s_barrier
    s_add_u32 m0, s61, 49152
    s_mov_b32 s62, 1572864
    buffer_load_dwordx4 v68, s[28:31], s62 offen lds
    s_add_u32 m0, s61, 53248
    s_mov_b32 s62, 1703936
    buffer_load_dwordx4 v68, s[28:31], s62 offen lds
    s_add_u32 m0, s61, 57344
    s_mov_b32 s62, 1835008
    buffer_load_dwordx4 v68, s[28:31], s62 offen lds
    s_add_u32 m0, s61, 61440
    s_mov_b32 s62, 1966080
    buffer_load_dwordx4 v68, s[28:31], s62 offen lds
    s_waitcnt vmcnt(32)
    s_barrier
    ds_read_b64_tr_b16 v[176:177], v70 offset:0
    ds_read_b64_tr_b16 v[178:179], v70 offset:1024
    ds_read_b64_tr_b16 v[180:181], v70 offset:4096
    ds_read_b64_tr_b16 v[182:183], v70 offset:5120
    ds_read_b64_tr_b16 v[184:185], v70 offset:8192
    ds_read_b64_tr_b16 v[186:187], v70 offset:9216
    ds_read_b64_tr_b16 v[188:189], v70 offset:12288
    ds_read_b64_tr_b16 v[190:191], v70 offset:13312
    s_waitcnt lgkmcnt(0)
    s_barrier
    s_add_u32 m0, s61, 65536
    s_mov_b32 s62, 2097152
    buffer_load_dwordx4 v68, s[28:31], s62 offen lds
    s_add_u32 m0, s61, 69632
    s_mov_b32 s62, 2228224
    buffer_load_dwordx4 v68, s[28:31], s62 offen lds
    s_add_u32 m0, s61, 73728
    s_mov_b32 s62, 2359296
    buffer_load_dwordx4 v68, s[28:31], s62 offen lds
    s_add_u32 m0, s61, 77824
    s_mov_b32 s62, 2490368
    buffer_load_dwordx4 v68, s[28:31], s62 offen lds
    s_waitcnt vmcnt(32)
    s_barrier
    ds_read_b64_tr_b16 v[192:193], v70 offset:16384
    ds_read_b64_tr_b16 v[194:195], v70 offset:17408
    ds_read_b64_tr_b16 v[196:197], v70 offset:20480
    ds_read_b64_tr_b16 v[198:199], v70 offset:21504
    ds_read_b64_tr_b16 v[200:201], v70 offset:24576
    ds_read_b64_tr_b16 v[202:203], v70 offset:25600
    ds_read_b64_tr_b16 v[204:205], v70 offset:28672
    ds_read_b64_tr_b16 v[206:207], v70 offset:29696
    s_waitcnt lgkmcnt(0)
    s_barrier
    s_add_u32 m0, s61, 81920
    s_mov_b32 s62, 2621440
    buffer_load_dwordx4 v68, s[28:31], s62 offen lds
    s_add_u32 m0, s61, 86016
    s_mov_b32 s62, 2752512
    buffer_load_dwordx4 v68, s[28:31], s62 offen lds
    s_add_u32 m0, s61, 90112
    s_mov_b32 s62, 2883584
    buffer_load_dwordx4 v68, s[28:31], s62 offen lds
    s_add_u32 m0, s61, 94208
    s_mov_b32 s62, 3014656
    buffer_load_dwordx4 v68, s[28:31], s62 offen lds
    s_waitcnt vmcnt(32)
    s_barrier
    ds_read_b64_tr_b16 v[208:209], v70 offset:32768
    ds_read_b64_tr_b16 v[210:211], v70 offset:33792
    ds_read_b64_tr_b16 v[212:213], v70 offset:36864
    ds_read_b64_tr_b16 v[214:215], v70 offset:37888
    ds_read_b64_tr_b16 v[216:217], v70 offset:40960
    ds_read_b64_tr_b16 v[218:219], v70 offset:41984
    ds_read_b64_tr_b16 v[220:221], v70 offset:45056
    ds_read_b64_tr_b16 v[222:223], v70 offset:46080
    s_waitcnt lgkmcnt(0)
    s_barrier
    s_add_u32 m0, s61, 98304
    s_mov_b32 s62, 3145728
    buffer_load_dwordx4 v68, s[28:31], s62 offen lds
    s_add_u32 m0, s61, 102400
    s_mov_b32 s62, 3276800
    buffer_load_dwordx4 v68, s[28:31], s62 offen lds
    s_add_u32 m0, s61, 106496
    s_mov_b32 s62, 3407872
    buffer_load_dwordx4 v68, s[28:31], s62 offen lds
    s_add_u32 m0, s61, 110592
    s_mov_b32 s62, 3538944
    buffer_load_dwordx4 v68, s[28:31], s62 offen lds
    s_waitcnt vmcnt(32)
    s_barrier
    ds_read_b64_tr_b16 v[224:225], v70 offset:49152
    ds_read_b64_tr_b16 v[226:227], v70 offset:50176
    ds_read_b64_tr_b16 v[228:229], v70 offset:53248
    ds_read_b64_tr_b16 v[230:231], v70 offset:54272
    ds_read_b64_tr_b16 v[232:233], v70 offset:57344
    ds_read_b64_tr_b16 v[234:235], v70 offset:58368
    ds_read_b64_tr_b16 v[236:237], v70 offset:61440
    ds_read_b64_tr_b16 v[238:239], v70 offset:62464
    s_waitcnt lgkmcnt(0)
    s_barrier
    s_add_u32 m0, s61, 114688
    s_mov_b32 s62, 3670016
    buffer_load_dwordx4 v68, s[28:31], s62 offen lds
    s_add_u32 m0, s61, 118784
    s_mov_b32 s62, 3801088
    buffer_load_dwordx4 v68, s[28:31], s62 offen lds
    s_add_u32 m0, s61, 122880
    s_mov_b32 s62, 3932160
    buffer_load_dwordx4 v68, s[28:31], s62 offen lds
    s_add_u32 m0, s61, 126976
    s_mov_b32 s62, 4063232
    buffer_load_dwordx4 v68, s[28:31], s62 offen lds
    s_waitcnt vmcnt(32)
    s_barrier
    ds_read_b64_tr_b16 v[240:241], v71 offset:0
    ds_read_b64_tr_b16 v[242:243], v71 offset:1024
    ds_read_b64_tr_b16 v[244:245], v71 offset:4096
    ds_read_b64_tr_b16 v[246:247], v71 offset:5120
    ds_read_b64_tr_b16 v[248:249], v71 offset:8192
    ds_read_b64_tr_b16 v[250:251], v71 offset:9216
    ds_read_b64_tr_b16 v[252:253], v71 offset:12288
    ds_read_b64_tr_b16 v[254:255], v71 offset:13312
    s_waitcnt lgkmcnt(0)
    s_barrier
    s_add_u32 m0, s61, 131072
    s_mov_b32 s62, 4194304
    buffer_load_dwordx4 v68, s[28:31], s62 offen lds
    s_add_u32 m0, s61, 135168
    s_mov_b32 s62, 4325376
    buffer_load_dwordx4 v68, s[28:31], s62 offen lds
    s_add_u32 m0, s61, 139264
    s_mov_b32 s62, 4456448
    buffer_load_dwordx4 v68, s[28:31], s62 offen lds
    s_add_u32 m0, s61, 143360
    s_mov_b32 s62, 4587520
    buffer_load_dwordx4 v68, s[28:31], s62 offen lds
    s_waitcnt vmcnt(32)
    s_barrier
    ds_read_b64_tr_b16 a[0:1], v69 offset:0
    ds_read_b64_tr_b16 a[2:3], v69 offset:1024
    ds_read_b64_tr_b16 a[4:5], v69 offset:4096
    ds_read_b64_tr_b16 a[6:7], v69 offset:5120
    ds_read_b64_tr_b16 a[8:9], v69 offset:8192
    ds_read_b64_tr_b16 a[10:11], v69 offset:9216
    ds_read_b64_tr_b16 a[12:13], v69 offset:12288
    ds_read_b64_tr_b16 a[14:15], v69 offset:13312
    s_waitcnt lgkmcnt(0)
    s_barrier
    s_waitcnt vmcnt(28)
    s_barrier
    ds_read_b64_tr_b16 a[16:17], v69 offset:16384
    ds_read_b64_tr_b16 a[18:19], v69 offset:17408
    ds_read_b64_tr_b16 a[20:21], v69 offset:20480
    ds_read_b64_tr_b16 a[22:23], v69 offset:21504
    ds_read_b64_tr_b16 a[24:25], v69 offset:24576
    ds_read_b64_tr_b16 a[26:27], v69 offset:25600
    ds_read_b64_tr_b16 a[28:29], v69 offset:28672
    ds_read_b64_tr_b16 a[30:31], v69 offset:29696
    s_waitcnt lgkmcnt(0)
    s_barrier
    s_waitcnt vmcnt(24)
    s_barrier
    ds_read_b64_tr_b16 a[32:33], v69 offset:32768
    ds_read_b64_tr_b16 a[34:35], v69 offset:33792
    ds_read_b64_tr_b16 a[36:37], v69 offset:36864
    ds_read_b64_tr_b16 a[38:39], v69 offset:37888
    ds_read_b64_tr_b16 a[40:41], v69 offset:40960
    ds_read_b64_tr_b16 a[42:43], v69 offset:41984
    ds_read_b64_tr_b16 a[44:45], v69 offset:45056
    ds_read_b64_tr_b16 a[46:47], v69 offset:46080
    s_waitcnt lgkmcnt(0)
    s_barrier
    s_add_u32 m0, s64, 0
    s_add_u32 s62, s65, 0
    buffer_load_dwordx4 v66, s[20:23], s62 offen lds
    s_add_u32 m0, s64, 4096
    s_add_u32 s62, s65, 128
    buffer_load_dwordx4 v66, s[20:23], s62 offen lds
    s_add_u32 m0, s64, 8192
    s_add_u32 s62, s65, 256
    buffer_load_dwordx4 v66, s[20:23], s62 offen lds
    s_add_u32 m0, s64, 12288
    s_add_u32 s62, s65, 384
    buffer_load_dwordx4 v66, s[20:23], s62 offen lds
    s_add_u32 m0, s64, 16384
    s_add_u32 s62, s65, 512
    buffer_load_dwordx4 v66, s[20:23], s62 offen lds
    s_add_u32 m0, s64, 20480
    s_add_u32 s62, s65, 640
    buffer_load_dwordx4 v66, s[20:23], s62 offen lds
    s_add_u32 m0, s64, 24576
    s_add_u32 s62, s65, 768
    buffer_load_dwordx4 v66, s[20:23], s62 offen lds
    s_add_u32 m0, s64, 28672
    s_add_u32 s62, s65, 896
    buffer_load_dwordx4 v66, s[20:23], s62 offen lds
    s_add_u32 m0, s64, 32768
    s_add_u32 s62, s65, 1024
    buffer_load_dwordx4 v66, s[20:23], s62 offen lds
    s_add_u32 s64, s64, 36864
    s_add_u32 s65, s65, 258048
    s_waitcnt vmcnt(29)
    s_barrier
    ds_read_b64_tr_b16 a[48:49], v69 offset:49152
    ds_read_b64_tr_b16 a[50:51], v69 offset:50176
    ds_read_b64_tr_b16 a[52:53], v69 offset:53248
    ds_read_b64_tr_b16 a[54:55], v69 offset:54272
    ds_read_b64_tr_b16 a[56:57], v69 offset:57344
    ds_read_b64_tr_b16 a[58:59], v69 offset:58368
    ds_read_b64_tr_b16 a[60:61], v69 offset:61440
    ds_read_b64_tr_b16 a[62:63], v69 offset:62464
    s_waitcnt lgkmcnt(0)
    s_barrier
    s_waitcnt vmcnt(25)
    s_barrier
    ds_read_b64_tr_b16 a[64:65], v70 offset:0
    ds_read_b64_tr_b16 a[66:67], v70 offset:1024
    ds_read_b64_tr_b16 a[68:69], v70 offset:4096
    ds_read_b64_tr_b16 a[70:71], v70 offset:5120
    ds_read_b64_tr_b16 a[72:73], v70 offset:8192
    ds_read_b64_tr_b16 a[74:75], v70 offset:9216
    ds_read_b64_tr_b16 a[76:77], v70 offset:12288
    ds_read_b64_tr_b16 a[78:79], v70 offset:13312
    s_waitcnt lgkmcnt(0)
    s_barrier
    s_add_u32 m0, s64, 0
    s_add_u32 s62, s65, 0
    buffer_load_dwordx4 v66, s[20:23], s62 offen lds
    s_add_u32 m0, s64, 4096
    s_add_u32 s62, s65, 128
    buffer_load_dwordx4 v66, s[20:23], s62 offen lds
    s_add_u32 m0, s64, 8192
    s_add_u32 s62, s65, 256
    buffer_load_dwordx4 v66, s[20:23], s62 offen lds
    s_add_u32 m0, s64, 12288
    s_add_u32 s62, s65, 384
    buffer_load_dwordx4 v66, s[20:23], s62 offen lds
    s_add_u32 m0, s64, 16384
    s_add_u32 s62, s65, 512
    buffer_load_dwordx4 v66, s[20:23], s62 offen lds
    s_add_u32 m0, s64, 20480
    s_add_u32 s62, s65, 640
    buffer_load_dwordx4 v66, s[20:23], s62 offen lds
    s_add_u32 m0, s64, 24576
    s_add_u32 s62, s65, 768
    buffer_load_dwordx4 v66, s[20:23], s62 offen lds
    s_add_u32 m0, s64, 28672
    s_add_u32 s62, s65, 896
    buffer_load_dwordx4 v66, s[20:23], s62 offen lds
    s_add_u32 m0, s64, 32768
    s_add_u32 s62, s65, 1024
    buffer_load_dwordx4 v66, s[20:23], s62 offen lds
    s_add_u32 s64, s64, 36864
    s_add_u32 s65, s65, 258048
    s_waitcnt vmcnt(30)
    s_barrier
    ds_read_b64_tr_b16 a[80:81], v70 offset:16384
    ds_read_b64_tr_b16 a[82:83], v70 offset:17408
    ds_read_b64_tr_b16 a[84:85], v70 offset:20480
    ds_read_b64_tr_b16 a[86:87], v70 offset:21504
    ds_read_b64_tr_b16 a[88:89], v70 offset:24576
    ds_read_b64_tr_b16 a[90:91], v70 offset:25600
    ds_read_b64_tr_b16 a[92:93], v70 offset:28672
    ds_read_b64_tr_b16 a[94:95], v70 offset:29696
    s_waitcnt lgkmcnt(0)
    s_barrier
    s_waitcnt vmcnt(26)
    s_barrier
    ds_read_b64_tr_b16 a[96:97], v70 offset:32768
    ds_read_b64_tr_b16 a[98:99], v70 offset:33792
    ds_read_b64_tr_b16 a[100:101], v70 offset:36864
    ds_read_b64_tr_b16 a[102:103], v70 offset:37888
    ds_read_b64_tr_b16 a[104:105], v70 offset:40960
    ds_read_b64_tr_b16 a[106:107], v70 offset:41984
    ds_read_b64_tr_b16 a[108:109], v70 offset:45056
    ds_read_b64_tr_b16 a[110:111], v70 offset:46080
    s_waitcnt lgkmcnt(0)
    s_barrier
    s_waitcnt vmcnt(22)
    s_barrier
    ds_read_b64_tr_b16 a[112:113], v70 offset:49152
    ds_read_b64_tr_b16 a[114:115], v70 offset:50176
    ds_read_b64_tr_b16 a[116:117], v70 offset:53248
    ds_read_b64_tr_b16 a[118:119], v70 offset:54272
    ds_read_b64_tr_b16 a[120:121], v70 offset:57344
    ds_read_b64_tr_b16 a[122:123], v70 offset:58368
    ds_read_b64_tr_b16 a[124:125], v70 offset:61440
    ds_read_b64_tr_b16 a[126:127], v70 offset:62464
    s_waitcnt lgkmcnt(0)
    s_barrier
    s_waitcnt vmcnt(18)
    s_barrier
    ds_read_b64_tr_b16 a[128:129], v71 offset:0
    ds_read_b64_tr_b16 a[130:131], v71 offset:1024
    ds_read_b64_tr_b16 a[132:133], v71 offset:4096
    ds_read_b64_tr_b16 a[134:135], v71 offset:5120
    ds_read_b64_tr_b16 a[136:137], v71 offset:8192
    ds_read_b64_tr_b16 a[138:139], v71 offset:9216
    ds_read_b64_tr_b16 a[140:141], v71 offset:12288
    ds_read_b64_tr_b16 a[142:143], v71 offset:13312
    s_waitcnt lgkmcnt(0)
    s_barrier
    s_waitcnt vmcnt(9)
    s_mov_b32 s66, 0
    s_mov_b32 s67, -1
    s_mov_b32 s88, 200000
    v_mov_b32 v76, 40
WG_1:
    buffer_load_dword v77, v76, s[48:51], 0 offen sc1
    s_sub_u32 s88, s88, 1
    s_cbranch_scc1 M_abort
    s_waitcnt vmcnt(0)
    v_cmp_le_u32 vcc, 32, v77
    s_cbranch_vccnz WG_1_ok
    s_sleep 8
    s_branch WG_1
WG_1_ok:
P_loop:
    s_barrier
    ds_read_b128 v[50:53], v62 offset:0
    ds_read_b128 v[54:57], v63 offset:0
    s_waitcnt lgkmcnt(1)
    v_mfma_f32_32x32x16_bf16 v[18:33], a[144:147], v[50:53], 0
    ds_read_b128 v[58:61], v64 offset:0
    v_mfma_f32_32x32x16_bf16 v[34:49], v[50:53], v[112:115], 0
    v_mfma_f32_32x32x16_bf16 v[2:17], a[0:3], v[50:53], 0
    s_waitcnt lgkmcnt(1)
    v_mfma_f32_32x32x16_bf16 v[18:33], a[148:151], v[54:57], v[18:33]
    ds_read_b128 v[50:53], v65 offset:0
    v_mfma_f32_32x32x16_bf16 v[34:49], v[54:57], v[116:119], v[34:49]
    s_add_u32 m0, s64, 0
    s_add_u32 s62, s65, 0
    buffer_load_dwordx4 v66, s[20:23], s62 offen lds
    v_mfma_f32_32x32x16_bf16 v[2:17], a[4:7], v[54:57], v[2:17]
    s_waitcnt lgkmcnt(1)
    v_mfma_f32_32x32x16_bf16 v[18:33], a[152:155], v[58:61], v[18:33]
    ds_read_b128 v[54:57], v62 offset:4096
    v_mfma_f32_32x32x16_bf16 v[34:49], v[58:61], v[120:123], v[34:49]
    s_add_u32 m0, s64, 4096
    s_add_u32 s62, s65, 128
    buffer_load_dwordx4 v66, s[20:23], s62 offen lds
    v_mfma_f32_32x32x16_bf16 v[2:17], a[8:11], v[58:61], v[2:17]
    s_waitcnt lgkmcnt(1)
    v_mfma_f32_32x32x16_bf16 v[18:33], a[156:159], v[50:53], v[18:33]
    ds_read_b128 v[58:61], v63 offset:4096
    v_mfma_f32_32x32x16_bf16 v[34:49], v[50:53], v[124:127], v[34:49]
    s_add_u32 m0, s64, 8192
    s_add_u32 s62, s65, 256
    buffer_load_dwordx4 v66, s[20:23], s62 offen lds
    v_mfma_f32_32x32x16_bf16 v[2:17], a[12:15], v[50:53], v[2:17]
    s_waitcnt lgkmcnt(1)
    v_mfma_f32_32x32x16_bf16 v[18:33], a[160:163], v[54:57], v[18:33]
    ds_read_b128 v[50:53], v64 offset:4096
    v_mfma_f32_32x32x16_bf16 v[34:49], v[54:57], v[128:131], v[34:49]
    s_add_u32 m0, s64, 12288
    s_add_u32 s62, s65, 384
    buffer_load_dwordx4 v66, s[20:23], s62 offen lds
    v_mfma_f32_32x32x16_bf16 v[2:17], a[16:19], v[54:57], v[2:17]
    s_waitcnt lgkmcnt(1)
    v_mfma_f32_32x32x16_bf16 v[18:33], a[164:167], v[58:61], v[18:33]
    ds_read_b128 v[54:57], v65 offset:4096
    v_mfma_f32_32x32x16_bf16 v[34:49], v[58:61], v[132:135], v[34:49]
    s_add_u32 m0, s64, 16384
    s_add_u32 s62, s65, 512
    buffer_load_dwordx4 v66, s[20:23], s62 offen lds
    v_mfma_f32_32x32x16_bf16 v[2:17], a[20:23], v[58:61], v[2:17]
    s_waitcnt lgkmcnt(1)
    v_mfma_f32_32x32x16_bf16 v[18:33], a[168:171], v[50:53], v[18:33]
    ds_read_b128 v[58:61], v62 offset:8192
    v_mfma_f32_32x32x16_bf16 v[34:49], v[50:53], v[136:139], v[34:49]
    s_add_u32 m0, s64, 20480
    s_add_u32 s62, s65, 640
    buffer_load_dwordx4 v66, s[20:23], s62 offen lds
    v_mfma_f32_32x32x16_bf16 v[2:17], a[24:27], v[50:53], v[2:17]
    s_waitcnt lgkmcnt(1)
    v_mfma_f32_32x32x16_bf16 v[18:33], a[172:175], v[54:57], v[18:33]
    ds_read_b128 v[50:53], v63 offset:8192
    v_mfma_f32_32x32x16_bf16 v[34:49], v[54:57], v[140:143], v[34:49]
    s_add_u32 m0, s64, 24576
    s_add_u32 s62, s65, 768
    buffer_load_dwordx4 v66, s[20:23], s62 offen lds
    v_mfma_f32_32x32x16_bf16 v[2:17], a[28:31], v[54:57], v[2:17]
    s_waitcnt lgkmcnt(1)
    v_mfma_f32_32x32x16_bf16 v[18:33], a[176:179], v[58:61], v[18:33]
    ds_read_b128 v[54:57], v64 offset:8192
    v_mfma_f32_32x32x16_bf16 v[34:49], v[58:61], v[144:147], v[34:49]
    s_add_u32 m0, s64, 28672
    s_add_u32 s62, s65, 896
    buffer_load_dwordx4 v66, s[20:23], s62 offen lds
    v_mfma_f32_32x32x16_bf16 v[2:17], a[32:35], v[58:61], v[2:17]
    s_waitcnt lgkmcnt(1)
    v_mfma_f32_32x32x16_bf16 v[18:33], a[180:183], v[50:53], v[18:33]
    ds_read_b128 v[58:61], v65 offset:8192
    v_mfma_f32_32x32x16_bf16 v[34:49], v[50:53], v[148:151], v[34:49]
    s_add_u32 m0, s64, 32768
    s_add_u32 s62, s65, 1024
    buffer_load_dwordx4 v66, s[20:23], s62 offen lds
    v_mfma_f32_32x32x16_bf16 v[2:17], a[36:39], v[50:53], v[2:17]
    s_waitcnt lgkmcnt(1)
    v_mfma_f32_32x32x16_bf16 v[18:33], a[184:187], v[54:57], v[18:33]
    ds_read_b128 v[50:53], v62 offset:12288
    v_mfma_f32_32x32x16_bf16 v[34:49], v[54:57], v[152:155], v[34:49]
    v_mfma_f32_32x32x16_bf16 v[2:17], a[40:43], v[54:57], v[2:17]
    s_waitcnt lgkmcnt(1)
    v_mfma_f32_32x32x16_bf16 v[18:33], a[188:191], v[58:61], v[18:33]
    ds_read_b128 v[54:57], v63 offset:12288
    v_mfma_f32_32x32x16_bf16 v[34:49], v[58:61], v[156:159], v[34:49]
    v_mfma_f32_32x32x16_bf16 v[2:17], a[44:47], v[58:61], v[2:17]
    s_waitcnt lgkmcnt(1)
    v_mfma_f32_32x32x16_bf16 v[18:33], a[192:195], v[50:53], v[18:33]
    ds_read_b128 v[58:61], v64 offset:12288
    v_mfma_f32_32x32x16_bf16 v[34:49], v[50:53], v[160:163], v[34:49]
    v_mfma_f32_32x32x16_bf16 v[2:17], a[48:51], v[50:53], v[2:17]
    s_waitcnt lgkmcnt(1)
    v_mfma_f32_32x32x16_bf16 v[18:33], a[196:199], v[54:57], v[18:33]
    ds_read_b128 v[50:53], v65 offset:12288
    v_mfma_f32_32x32x16_bf16 v[34:49], v[54:57], v[164:167], v[34:49]
    v_mfma_f32_32x32x16_bf16 v[2:17], a[52:55], v[54:57], v[2:17]
    s_waitcnt lgkmcnt(1)
    v_mfma_f32_32x32x16_bf16 v[18:33], a[200:203], v[58:61], v[18:33]
    ds_read_b128 v[54:57], v62 offset:16384
    v_mfma_f32_32x32x16_bf16 v[34:49], v[58:61], v[168:171], v[34:49]
    v_mfma_f32_32x32x16_bf16 v[2:17], a[56:59], v[58:61], v[2:17]
    s_waitcnt lgkmcnt(1)
    v_mfma_f32_32x32x16_bf16 v[18:33], a[204:207], v[50:53], v[18:33]
    ds_read_b128 v[58:61], v63 offset:16384
    v_mfma_f32_32x32x16_bf16 v[34:49], v[50:53], v[172:175], v[34:49]
    v_mfma_f32_32x32x16_bf16 v[2:17], a[60:63], v[50:53], v[2:17]
    s_waitcnt lgkmcnt(1)
    v_mfma_f32_32x32x16_bf16 v[18:33], a[208:211], v[54:57], v[18:33]
    ds_read_b128 v[50:53], v64 offset:16384
    v_mfma_f32_32x32x16_bf16 v[34:49], v[54:57], v[176:179], v[34:49]
    v_mfma_f32_32x32x16_bf16 v[2:17], a[64:67], v[54:57], v[2:17]
    s_waitcnt lgkmcnt(1)
    v_mfma_f32_32x32x16_bf16 v[18:33], a[212:215], v[58:61], v[18:33]
    ds_read_b128 v[54:57], v65 offset:16384
    v_mfma_f32_32x32x16_bf16 v[34:49], v[58:61], v[180:183], v[34:49]
    v_mfma_f32_32x32x16_bf16 v[2:17], a[68:71], v[58:61], v[2:17]
    s_waitcnt lgkmcnt(1)
    v_mfma_f32_32x32x16_bf16 v[18:33], a[216:219], v[50:53], v[18:33]
    ds_read_b128 v[58:61], v62 offset:20480
    v_mfma_f32_32x32x16_bf16 v[34:49], v[50:53], v[184:187], v[34:49]
    v_mfma_f32_32x32x16_bf16 v[2:17], a[72:75], v[50:53], v[2:17]
    s_waitcnt lgkmcnt(1)
    v_mfma_f32_32x32x16_bf16 v[18:33], a[220:223], v[54:57], v[18:33]
    ds_read_b128 v[50:53], v63 offset:20480
    v_mfma_f32_32x32x16_bf16 v[34:49], v[54:57], v[188:191], v[34:49]
    v_mfma_f32_32x32x16_bf16 v[2:17], a[76:79], v[54:57], v[2:17]
    s_waitcnt lgkmcnt(1)
    v_mfma_f32_32x32x16_bf16 v[18:33], a[224:227], v[58:61], v[18:33]
    ds_read_b128 v[54:57], v64 offset:20480
    v_mfma_f32_32x32x16_bf16 v[34:49], v[58:61], v[192:195], v[34:49]
    s_waitcnt vmcnt(9)
    s_cmp_lt_i32 s67, 0
    s_cbranch_scc1 P_nofl
    s_lshl_b32 s62, s77, 6
    s_add_u32 s62, s62, s67
    s_lshl_b32 s62, s62, 2
    s_add_u32 s62, s62, 86573056
    v_mov_b32 v74, s62
    s_mov_b64 exec, 1
    buffer_atomic_add v75, v74, s[52:55], 0 offen sc1
    s_mov_b64 exec, -1
P_nofl:
    v_mfma_f32_32x32x16_bf16 v[2:17], a[80:83], v[58:61], v[2:17]
    s_waitcnt lgkmcnt(1)
    v_mfma_f32_32x32x16_bf16 v[18:33], a[228:231], v[50:53], v[18:33]
    ds_read_b128 v[58:61], v65 offset:20480
    v_mfma_f32_32x32x16_bf16 v[34:49], v[50:53], v[196:199], v[34:49]
    v_mfma_f32_32x32x16_bf16 v[2:17], a[84:87], v[50:53], v[2:17]
    s_waitcnt lgkmcnt(1)
    v_mfma_f32_32x32x16_bf16 v[18:33], a[232:235], v[54:57], v[18:33]
    ds_read_b128 v[50:53], v62 offset:24576
    v_mfma_f32_32x32x16_bf16 v[34:49], v[54:57], v[200:203], v[34:49]
    v_mfma_f32_32x32x16_bf16 v[2:17], a[88:91], v[54:57], v[2:17]
    s_waitcnt lgkmcnt(1)
    v_mfma_f32_32x32x16_bf16 v[18:33], a[236:239], v[58:61], v[18:33]
    ds_read_b128 v[54:57], v63 offset:24576
    v_mfma_f32_32x32x16_bf16 v[34:49], v[58:61], v[204:207], v[34:49]
    v_mfma_f32_32x32x16_bf16 v[2:17], a[92:95], v[58:61], v[2:17]
    s_waitcnt lgkmcnt(1)
    v_mfma_f32_32x32x16_bf16 v[18:33], a[240:243], v[50:53], v[18:33]
    ds_read_b128 v[58:61], v64 offset:24576
    v_mfma_f32_32x32x16_bf16 v[34:49], v[50:53], v[208:211], v[34:49]
    v_mfma_f32_32x32x16_bf16 v[2:17], a[96:99], v[50:53], v[2:17]
    s_waitcnt lgkmcnt(1)
    v_mfma_f32_32x32x16_bf16 v[18:33], a[244:247], v[54:57], v[18:33]
    ds_read_b128 v[50:53], v65 offset:24576
    v_mfma_f32_32x32x16_bf16 v[34:49], v[54:57], v[212:215], v[34:49]
    v_mfma_f32_32x32x16_bf16 v[2:17], a[100:103], v[54:57], v[2:17]
    s_waitcnt lgkmcnt(1)
    v_mfma_f32_32x32x16_bf16 v[18:33], a[248:251], v[58:61], v[18:33]
    ds_read_b128 v[54:57], v62 offset:28672
    v_mfma_f32_32x32x16_bf16 v[34:49], v[58:61], v[216:219], v[34:49]
    v_mfma_f32_32x32x16_bf16 v[2:17], a[104:107], v[58:61], v[2:17]
    s_waitcnt lgkmcnt(1)
    v_mfma_f32_32x32x16_bf16 v[18:33], a[252:255], v[50:53], v[18:33]
    ds_read_b128 v[58:61], v63 offset:28672
    v_mfma_f32_32x32x16_bf16 v[34:49], v[50:53], v[220:223], v[34:49]
    v_mfma_f32_32x32x16_bf16 v[2:17], a[108:111], v[50:53], v[2:17]
    s_waitcnt lgkmcnt(1)
    v_mfma_f32_32x32x16_bf16 v[18:33], v[80:83], v[54:57], v[18:33]
    ds_read_b128 v[50:53], v64 offset:28672
    v_mfma_f32_32x32x16_bf16 v[34:49], v[54:57], v[224:227], v[34:49]
    v_mfma_f32_32x32x16_bf16 v[2:17], a[112:115], v[54:57], v[2:17]
    s_waitcnt lgkmcnt(1)
    v_mfma_f32_32x32x16_bf16 v[18:33], v[84:87], v[58:61], v[18:33]
    ds_read_b128 v[54:57], v65 offset:28672
    v_mfma_f32_32x32x16_bf16 v[34:49], v[58:61], v[228:231], v[34:49]
    v_mfma_f32_32x32x16_bf16 v[2:17], a[116:119], v[58:61], v[2:17]
    s_waitcnt lgkmcnt(1)
    v_mfma_f32_32x32x16_bf16 v[18:33], v[88:91], v[50:53], v[18:33]
    ds_read_b128 v[58:61], v62 offset:32768
    v_mfma_f32_32x32x16_bf16 v[34:49], v[50:53], v[232:235], v[34:49]
    v_mfma_f32_32x32x16_bf16 v[2:17], a[120:123], v[50:53], v[2:17]
    s_waitcnt lgkmcnt(1)
    v_mfma_f32_32x32x16_bf16 v[18:33], v[92:95], v[54:57], v[18:33]
    ds_read_b128 v[50:53], v63 offset:32768
    v_mfma_f32_32x32x16_bf16 v[34:49], v[54:57], v[236:239], v[34:49]
    v_mfma_f32_32x32x16_bf16 v[2:17], a[124:127], v[54:57], v[2:17]
    s_waitcnt lgkmcnt(1)
    v_mfma_f32_32x32x16_bf16 v[18:33], v[96:99], v[58:61], v[18:33]
    ds_read_b128 v[54:57], v64 offset:32768
    v_mfma_f32_32x32x16_bf16 v[34:49], v[58:61], v[240:243], v[34:49]
    v_mfma_f32_32x32x16_bf16 v[2:17], a[128:131], v[58:61], v[2:17]
    s_waitcnt lgkmcnt(1)
    v_mfma_f32_32x32x16_bf16 v[18:33], v[100:103], v[50:53], v[18:33]
    ds_read_b128 v[58:61], v65 offset:32768
    v_mfma_f32_32x32x16_bf16 v[34:49], v[50:53], v[244:247], v[34:49]
    v_mfma_f32_32x32x16_bf16 v[2:17], a[132:135], v[50:53], v[2:17]
    s_waitcnt lgkmcnt(1)
    v_mfma_f32_32x32x16_bf16 v[18:33], v[104:107], v[54:57], v[18:33]
    v_mfma_f32_32x32x16_bf16 v[34:49], v[54:57], v[248:251], v[34:49]
    v_mfma_f32_32x32x16_bf16 v[2:17], a[136:139], v[54:57], v[2:17]
    s_waitcnt lgkmcnt(0)
    v_mfma_f32_32x32x16_bf16 v[18:33], v[108:111], v[58:61], v[18:33]
    v_mfma_f32_32x32x16_bf16 v[34:49], v[58:61], v[252:255], v[34:49]
    v_mfma_f32_32x32x16_bf16 v[2:17], a[140:143], v[58:61], v[2:17]
    s_add_u32 s64, s64, 36864
    s_add_u32 s65, s65, 258048
    s_add_u32 s62, s61, 110592
    s_cmp_ge_u32 s64, s62
    s_cselect_b32 s64, s61, s64
    s_add_u32 s66, s66, 1
    s_cmp_eq_u32 s66, 3
    s_cselect_b32 s66, 0, s66
    s_mov_b32 s62, 36864
    s_cselect_b32 s62, 4294893568, s62
    v_add_u32 v62, s62, v62
    v_add_u32 v63, s62, v63
    v_add_u32 v64, s62, v64
    v_add_u32 v65, s62, v65
    s_lshl_b32 s62, s63, 5
    s_add_u32 s62, s62, s77
    s_lshl_b32 s62, s62, 13
    s_lshr_b32 s71, s62, 1
    s_add_u32 s71, s71, 52428800
    s_add_u32 s68, s62, 2097152
    s_add_u32 s69, s62, 18874368
    s_add_u32 s70, s62, 35651584
    v_cvt_pk_bf16_f32 v18, v18, v19
    v_cvt_pk_bf16_f32 v19, v20, v21
    v_cvt_pk_bf16_f32 v20, v22, v23
    v_cvt_pk_bf16_f32 v21, v24, v25
    v_cvt_pk_bf16_f32 v22, v26, v27
    v_cvt_pk_bf16_f32 v23, v28, v29
    v_cvt_pk_bf16_f32 v24, v30, v31
    v_cvt_pk_bf16_f32 v25, v32, v33
    buffer_store_dwordx4 v[18:21], v67, s[52:55], s68 offen sc1
    buffer_store_dwordx4 v[22:25], v67, s[52:55], s68 offen offset:1024 sc1
    v_cvt_pk_bf16_f32 v34, v34, v35
    v_cvt_pk_bf16_f32 v35, v36, v37
    v_cvt_pk_bf16_f32 v36, v38, v39
    v_cvt_pk_bf16_f32 v37, v40, v41
    v_cvt_pk_bf16_f32 v38, v42, v43
    v_cvt_pk_bf16_f32 v39, v44, v45
    v_cvt_pk_bf16_f32 v40, v46, v47
    v_cvt_pk_bf16_f32 v41, v48, v49
    buffer_store_dwordx4 v[34:37], v67, s[52:55], s69 offen sc1
    buffer_store_dwordx4 v[38:41], v67, s[52:55], s69 offen offset:1024 sc1
    s_nop 3
    v_cvt_pk_bf16_f32 v2, v2, v3
    v_cvt_pk_bf16_f32 v3, v4, v5
    v_cvt_pk_bf16_f32 v4, v6, v7
    v_cvt_pk_bf16_f32 v5, v8, v9
    v_cvt_pk_bf16_f32 v6, v10, v11
    v_cvt_pk_bf16_f32 v7, v12, v13
    v_cvt_pk_bf16_f32 v8, v14, v15
    v_cvt_pk_bf16_f32 v9, v16, v17
    buffer_store_dwordx4 v[2:5], v67, s[52:55], s70 offen sc1
    buffer_store_dwordx4 v[6:9], v67, s[52:55], s70 offen offset:1024 sc1
    s_cmp_lg_u32 s63, 63
    s_cbranch_scc1 P_narm
    v_mov_b32 v50, -1
    v_mov_b32 v51, -1
    v_mov_b32 v52, -1
    v_mov_b32 v53, -1
    buffer_store_dwordx4 v[50:53], v72, s[52:55], s71 offen sc1
P_narm:
    s_mov_b32 s67, s63
    s_add_u32 s63, s63, 7
    s_cmp_lt_u32 s63, 64
    s_cbranch_scc1 P_loop
    s_waitcnt vmcnt(0)
    s_lshl_b32 s62, s77, 6
    s_add_u32 s62, s62, s67
    s_lshl_b32 s62, s62, 2
    s_add_u32 s62, s62, 86573056
    v_mov_b32 v74, s62
    s_mov_b64 exec, 1
    buffer_atomic_add v75, v74, s[52:55], 0 offen sc1
    s_mov_b64 exec, -1
    s_barrier
    s_lshl_b32 s64, s76, 2
    s_add_u32 s64, s64, s56
    v_lshlrev_b32 v2, 4, v1
    v_and_b32 v3, 31, v1
    v_lshrrev_b32 v4, 5, v1
    v_lshlrev_b32 v4, 3, v4
    s_mov_b32 s66, 7456541
    s_mov_b32 s67, 987991609
    s_mov_b32 s65, s64
F0_m:
    s_cmp_ge_u32 s65, 1296
    s_cbranch_scc1 F0_mdone
    s_cmp_ge_u32 s65, 648
    s_cselect_b32 s68, 1, 0
    s_mul_i32 s60, s68, 648
    s_sub_u32 s60, s65, s60
    s_mul_hi_u32 s61, s60, 119304648
    s_mul_i32 s62, s61, 36
    s_sub_u32 s62, s60, s62
    s_lshl_b32 s61, s61, 5
    s_lshl_b32 s62, s62, 4
    v_add_u32 v5, s61, v3
    v_add_u32 v6, s62, v4
    s_lshl_b32 s63, s68, 20
    s_lshl_b32 s60, s60, 10
    s_add_u32 s63, s63, s60
    s_add_u32 s63, s63, 88080384
    s_cmp_eq_u32 s68, 0
    s_cselect_b64 s[70:71], -1, 0
    v_add_u32 v7, 0, v6
    v_cndmask_b32 v20, v5, v7, s[70:71]
    v_cndmask_b32 v21, v7, v5, s[70:71]
    v_lshrrev_b32 v22, 1, v21
    v_and_b32 v23, 1, v21
    v_cmp_eq_u32 vcc, 1, v21
    v_mul_u32_u24 v23, 144, v23
    v_mov_b32 v24, 288
    v_cndmask_b32 v22, v22, v24, vcc
    v_cndmask_b32 v23, v23, 0, vcc
    v_mad_u32_u24 v22, v20, v22, v23
    v_mul_hi_u32 v23, v22, s66
    v_mul_u32_u24 v23, 576, v23
    v_sub_u32 v22, v22, v23
    v_cvt_f32_u32 v22, v22
    v_mul_f32 v22, s67, v22
    v_cos_f32 v8, v22
    v_add_u32 v7, 1, v6
    v_cndmask_b32 v20, v5, v7, s[70:71]
    v_cndmask_b32 v21, v7, v5, s[70:71]
    v_lshrrev_b32 v22, 1, v21
    v_and_b32 v23, 1, v21
    v_cmp_eq_u32 vcc, 1, v21
    v_mul_u32_u24 v23, 144, v23
    v_mov_b32 v24, 288
    v_cndmask_b32 v22, v22, v24, vcc
    v_cndmask_b32 v23, v23, 0, vcc
    v_mad_u32_u24 v22, v20, v22, v23
    v_mul_hi_u32 v23, v22, s66
    v_mul_u32_u24 v23, 576, v23
    v_sub_u32 v22, v22, v23
    v_cvt_f32_u32 v22, v22
    v_mul_f32 v22, s67, v22
    v_cos_f32 v9, v22
    v_add_u32 v7, 2, v6
    v_cndmask_b32 v20, v5, v7, s[70:71]
    v_cndmask_b32 v21, v7, v5, s[70:71]
    v_lshrrev_b32 v22, 1, v21
    v_and_b32 v23, 1, v21
    v_cmp_eq_u32 vcc, 1, v21
    v_mul_u32_u24 v23, 144, v23
    v_mov_b32 v24, 288
    v_cndmask_b32 v22, v22, v24, vcc
    v_cndmask_b32 v23, v23, 0, vcc
    v_mad_u32_u24 v22, v20, v22, v23
    v_mul_hi_u32 v23, v22, s66
    v_mul_u32_u24 v23, 576, v23
    v_sub_u32 v22, v22, v23
    v_cvt_f32_u32 v22, v22
    v_mul_f32 v22, s67, v22
    v_cos_f32 v10, v22
    v_add_u32 v7, 3, v6
    v_cndmask_b32 v20, v5, v7, s[70:71]
    v_cndmask_b32 v21, v7, v5, s[70:71]
    v_lshrrev_b32 v22, 1, v21
    v_and_b32 v23, 1, v21
    v_cmp_eq_u32 vcc, 1, v21
    v_mul_u32_u24 v23, 144, v23
    v_mov_b32 v24, 288
    v_cndmask_b32 v22, v22, v24, vcc
    v_cndmask_b32 v23, v23, 0, vcc
    v_mad_u32_u24 v22, v20, v22, v23
    v_mul_hi_u32 v23, v22, s66
    v_mul_u32_u24 v23, 576, v23
    v_sub_u32 v22, v22, v23
    v_cvt_f32_u32 v22, v22
    v_mul_f32 v22, s67, v22
    v_cos_f32 v11, v22
    v_add_u32 v7, 4, v6
    v_cndmask_b32 v20, v5, v7, s[70:71]
    v_cndmask_b32 v21, v7, v5, s[70:71]
    v_lshrrev_b32 v22, 1, v21
    v_and_b32 v23, 1, v21
    v_cmp_eq_u32 vcc, 1, v21
    v_mul_u32_u24 v23, 144, v23
    v_mov_b32 v24, 288
    v_cndmask_b32 v22, v22, v24, vcc
    v_cndmask_b32 v23, v23, 0, vcc
    v_mad_u32_u24 v22, v20, v22, v23
    v_mul_hi_u32 v23, v22, s66
    v_mul_u32_u24 v23, 576, v23
    v_sub_u32 v22, v22, v23
    v_cvt_f32_u32 v22, v22
    v_mul_f32 v22, s67, v22
    v_cos_f32 v12, v22
    v_add_u32 v7, 5, v6
    v_cndmask_b32 v20, v5, v7, s[70:71]
    v_cndmask_b32 v21, v7, v5, s[70:71]
    v_lshrrev_b32 v22, 1, v21
    v_and_b32 v23, 1, v21
    v_cmp_eq_u32 vcc, 1, v21
    v_mul_u32_u24 v23, 144, v23
    v_mov_b32 v24, 288
    v_cndmask_b32 v22, v22, v24, vcc
    v_cndmask_b32 v23, v23, 0, vcc
    v_mad_u32_u24 v22, v20, v22, v23
    v_mul_hi_u32 v23, v22, s66
    v_mul_u32_u24 v23, 576, v23
    v_sub_u32 v22, v22, v23
    v_cvt_f32_u32 v22, v22
    v_mul_f32 v22, s67, v22
    v_cos_f32 v13, v22
    v_add_u32 v7, 6, v6
    v_cndmask_b32 v20, v5, v7, s[70:71]
    v_cndmask_b32 v21, v7, v5, s[70:71]
    v_lshrrev_b32 v22, 1, v21
    v_and_b32 v23, 1, v21
    v_cmp_eq_u32 vcc, 1, v21
    v_mul_u32_u24 v23, 144, v23
    v_mov_b32 v24, 288
    v_cndmask_b32 v22, v22, v24, vcc
    v_cndmask_b32 v23, v23, 0, vcc
    v_mad_u32_u24 v22, v20, v22, v23
    v_mul_hi_u32 v23, v22, s66
    v_mul_u32_u24 v23, 576, v23
    v_sub_u32 v22, v22, v23
    v_cvt_f32_u32 v22, v22
    v_mul_f32 v22, s67, v22
    v_cos_f32 v14, v22
    v_add_u32 v7, 7, v6
    v_cndmask_b32 v20, v5, v7, s[70:71]
    v_cndmask_b32 v21, v7, v5, s[70:71]
    v_lshrrev_b32 v22, 1, v21
    v_and_b32 v23, 1, v21
    v_cmp_eq_u32 vcc, 1, v21
    v_mul_u32_u24 v23, 144, v23
    v_mov_b32 v24, 288
    v_cndmask_b32 v22, v22, v24, vcc
    v_cndmask_b32 v23, v23, 0, vcc
    v_mad_u32_u24 v22, v20, v22, v23
    v_mul_hi_u32 v23, v22, s66
    v_mul_u32_u24 v23, 576, v23
    v_sub_u32 v22, v22, v23
    v_cvt_f32_u32 v22, v22
    v_mul_f32 v22, s67, v22
    v_cos_f32 v15, v22
    s_nop 0
    v_cvt_pk_bf16_f32 v16, v8, v9
    v_cvt_pk_bf16_f32 v17, v10, v11
    v_cvt_pk_bf16_f32 v18, v12, v13
    v_cvt_pk_bf16_f32 v19, v14, v15
    buffer_store_dwordx4 v[16:19], v2, s[52:55], s63 offen sc1
    s_add_u32 s65, s65, 896
    s_branch F0_m
F0_mdone:
    s_sub_u32 s65, s65, 1296
    s_cmp_ge_u32 s65, 22
    s_cbranch_scc1 F0_cdone
    s_cmp_lt_u32 s65, 6
    s_cbranch_scc0 F0_c64
    s_and_b32 s60, s65, 1
    s_lshl_b32 s60, s60, 4
    s_mov_b32 s61, 0
    s_lshr_b32 s62, s65, 1
    s_mov_b32 s63, 1023410176
    s_branch F0_cgo
F0_c64:
    s_sub_u32 s68, s65, 6
    s_and_b32 s60, s68, 3
    s_lshl_b32 s60, s60, 4
    s_bfe_u32 s61, s68, 0x10002
    s_lshl_b32 s61, s61, 5
    s_lshr_b32 s62, s68, 3
    s_mov_b32 s63, 1015021568
F0_cgo:
    s_cmp_eq_u32 s62, 1
    s_cselect_b32 s68, 3196059648, 0
    s_cmp_eq_u32 s62, 2
    s_cselect_b32 s68, 1048576000, s68
    v_add_u32 v5, s61, v3
    v_lshrrev_b32 v6, 1, v4
    v_add_u32 v6, s60, v6
    v_mov_b32 v24, s68
    v_add_u32 v7, 0, v6
    v_mul_u32_u24 v7, v7, v5
    v_and_b32 v7, 63, v7
    v_cvt_f32_u32 v7, v7
    v_fma_f32 v7, v7, s63, v24
    v_cos_f32 v8, v7
    v_add_u32 v7, 1, v6
    v_mul_u32_u24 v7, v7, v5
    v_and_b32 v7, 63, v7
    v_cvt_f32_u32 v7, v7
    v_fma_f32 v7, v7, s63, v24
    v_cos_f32 v9, v7
    v_add_u32 v7, 2, v6
    v_mul_u32_u24 v7, v7, v5
    v_and_b32 v7, 63, v7
    v_cvt_f32_u32 v7, v7
    v_fma_f32 v7, v7, s63, v24
    v_cos_f32 v10, v7
    v_add_u32 v7, 3, v6
    v_mul_u32_u24 v7, v7, v5
    v_and_b32 v7, 63, v7
    v_cvt_f32_u32 v7, v7
    v_fma_f32 v7, v7, s63, v24
    v_cos_f32 v11, v7
    v_add_u32 v7, 8, v6
    v_mul_u32_u24 v7, v7, v5
    v_and_b32 v7, 63, v7
    v_cvt_f32_u32 v7, v7
    v_fma_f32 v7, v7, s63, v24
    v_cos_f32 v12, v7
    v_add_u32 v7, 9, v6
    v_mul_u32_u24 v7, v7, v5
    v_and_b32 v7, 63, v7
    v_cvt_f32_u32 v7, v7
    v_fma_f32 v7, v7, s63, v24
    v_cos_f32 v13, v7
    v_add_u32 v7, 10, v6
    v_mul_u32_u24 v7, v7, v5
    v_and_b32 v7, 63, v7
    v_cvt_f32_u32 v7, v7
    v_fma_f32 v7, v7, s63, v24
    v_cos_f32 v14, v7
    v_add_u32 v7, 11, v6
    v_mul_u32_u24 v7, v7, v5
    v_and_b32 v7, 63, v7
    v_cvt_f32_u32 v7, v7
    v_fma_f32 v7, v7, s63, v24
    v_cos_f32 v15, v7
    s_nop 0
    v_cvt_pk_bf16_f32 v16, v8, v9
    v_cvt_pk_bf16_f32 v17, v10, v11
    v_cvt_pk_bf16_f32 v18, v12, v13
    v_cvt_pk_bf16_f32 v19, v14, v15
    s_lshl_b32 s63, s65, 10
    s_add_u32 s63, s63, 93061120
    buffer_store_dwordx4 v[16:19], v2, s[52:55], s63 offen sc1
F0_cdone:
    v_lshlrev_b32 v5, 1, v1
    v_lshlrev_b32 v6, 13, v1
    s_mov_b32 s65, s64
F0_w:
    s_cmp_ge_u32 s65, 2560
    s_cbranch_scc1 F0_wdone
    s_mul_hi_u32 s60, s65, 858993460
    s_mul_i32 s61, s60, 5
    s_sub_u32 s61, s65, s61
    s_lshr_b32 s62, s60, 5
    s_and_b32 s63, s60, 31
    s_lshl_b32 s62, s62, 7
    s_add_u32 s62, s62, s63
    s_mul_i32 s62, s62, 578
    s_lshl_b32 s63, s61, 7
    s_add_u32 s62, s62, s63
    s_lshl_b32 s63, s61, 19
    s_lshl_b32 s60, s60, 4
    s_add_u32 s63, s63, s60
    s_add_u32 s63, s63, 90177536
    buffer_load_ushort v8, v5, s[12:15], s62 offen
    buffer_load_ushort v12, v5, s[16:19], s62 offen
    s_add_u32 s62, s62, 18496
    buffer_load_ushort v9, v5, s[12:15], s62 offen
    buffer_load_ushort v13, v5, s[16:19], s62 offen
    s_add_u32 s62, s62, 18496
    buffer_load_ushort v10, v5, s[12:15], s62 offen
    buffer_load_ushort v14, v5, s[16:19], s62 offen
    s_add_u32 s62, s62, 18496
    buffer_load_ushort v11, v5, s[12:15], s62 offen
    buffer_load_ushort v15, v5, s[16:19], s62 offen
    s_waitcnt vmcnt(0)
    v_lshl_or_b32 v16, v12, 16, v8
    v_lshl_or_b32 v17, v13, 16, v9
    v_lshl_or_b32 v18, v14, 16, v10
    v_lshl_or_b32 v19, v15, 16, v11
    buffer_store_dwordx4 v[16:19], v6, s[52:55], s63 offen sc1
    s_add_u32 s65, s65, 896
    s_branch F0_w
F0_wdone:
    s_waitcnt vmcnt(0)
    s_barrier
    s_cmp_lg_u32 s56, 0
    s_cbranch_scc1 SG_2
    v_mov_b32 v76, 68
    v_mov_b32 v77, 1
    s_mov_b64 exec, 1
    buffer_atomic_add v77, v76, s[48:51], 0 offen sc1
    s_mov_b64 exec, -1
SG_2:
    s_cmp_ge_u32 s80, 12
    s_cbranch_scc1 M_noos
    v_lshrrev_b32 v164, 2, v1
    v_mul_u32_u24 v166, 1152, v164
    v_and_b32 v164, 3, v1
    v_lshl_add_u32 v166, v164, 4, v166
    s_lshl_b32 s60, s79, 6
    s_mul_i32 s61, s56, 1179648
    s_add_u32 s60, s60, s61
    s_lshl_b32 s63, s56, 15
    v_bfe_u32 v164, v1, 2, 2
    v_lshrrev_b32 v165, 5, v1
    v_lshl_add_u32 v164, v165, 2, v164
    v_lshlrev_b32 v167, 6, v164
    v_bfe_u32 v164, v1, 4, 1
    v_lshl_add_u32 v167, v164, 5, v167
    v_and_b32 v164, 3, v1
    v_lshl_add_u32 v167, v164, 3, v167
    v_add_u32 v167, s63, v167
    s_add_u32 m0, s63, 0
    s_add_u32 s62, s60, 0
    buffer_load_dwordx4 v166, s[40:43], s62 offen lds
    s_add_u32 m0, s63, 1024
    s_add_u32 s62, s60, 18432
    buffer_load_dwordx4 v166, s[40:43], s62 offen lds
    s_add_u32 m0, s63, 2048
    s_add_u32 s62, s60, 36864
    buffer_load_dwordx4 v166, s[40:43], s62 offen lds
    s_add_u32 m0, s63, 3072
    s_add_u32 s62, s60, 55296
    buffer_load_dwordx4 v166, s[40:43], s62 offen lds
    s_add_u32 m0, s63, 4096
    s_add_u32 s62, s60, 73728
    buffer_load_dwordx4 v166, s[40:43], s62 offen lds
    s_add_u32 m0, s63, 5120
    s_add_u32 s62, s60, 92160
    buffer_load_dwordx4 v166, s[40:43], s62 offen lds
    s_add_u32 m0, s63, 6144
    s_add_u32 s62, s60, 110592
    buffer_load_dwordx4 v166, s[40:43], s62 offen lds
    s_add_u32 m0, s63, 7168
    s_add_u32 s62, s60, 129024
    buffer_load_dwordx4 v166, s[40:43], s62 offen lds
    s_add_u32 m0, s63, 8192
    s_add_u32 s62, s60, 147456
    buffer_load_dwordx4 v166, s[40:43], s62 offen lds
    s_add_u32 m0, s63, 9216
    s_add_u32 s62, s60, 165888
    buffer_load_dwordx4 v166, s[40:43], s62 offen lds
    s_add_u32 m0, s63, 10240
    s_add_u32 s62, s60, 184320
    buffer_load_dwordx4 v166, s[40:43], s62 offen lds
    s_add_u32 m0, s63, 11264
    s_add_u32 s62, s60, 202752
    buffer_load_dwordx4 v166, s[40:43], s62 offen lds
    s_add_u32 m0, s63, 12288
    s_add_u32 s62, s60, 221184
    buffer_load_dwordx4 v166, s[40:43], s62 offen lds
    s_add_u32 m0, s63, 13312
    s_add_u32 s62, s60, 239616
    buffer_load_dwordx4 v166, s[40:43], s62 offen lds
    s_add_u32 m0, s63, 14336
    s_add_u32 s62, s60, 258048
    buffer_load_dwordx4 v166, s[40:43], s62 offen lds
    s_add_u32 m0, s63, 15360
    s_add_u32 s62, s60, 276480
    buffer_load_dwordx4 v166, s[40:43], s62 offen lds
    s_add_u32 m0, s63, 16384
    s_add_u32 s62, s60, 294912
    buffer_load_dwordx4 v166, s[40:43], s62 offen lds
    s_add_u32 m0, s63, 17408
    s_add_u32 s62, s60, 313344
    buffer_load_dwordx4 v166, s[40:43], s62 offen lds
    s_add_u32 m0, s63, 18432
    s_add_u32 s62, s60, 331776
    buffer_load_dwordx4 v166, s[40:43], s62 offen lds
    s_add_u32 m0, s63, 19456
    s_add_u32 s62, s60, 350208
    buffer_load_dwordx4 v166, s[40:43], s62 offen lds
    s_add_u32 m0, s63, 20480
    s_add_u32 s62, s60, 368640
    buffer_load_dwordx4 v166, s[40:43], s62 offen lds
    s_add_u32 m0, s63, 21504
    s_add_u32 s62, s60, 387072
    buffer_load_dwordx4 v166, s[40:43], s62 offen lds
    s_add_u32 m0, s63, 22528
    s_add_u32 s62, s60, 405504
    buffer_load_dwordx4 v166, s[40:43], s62 offen lds
    s_add_u32 m0, s63, 23552
    s_add_u32 s62, s60, 423936
    buffer_load_dwordx4 v166, s[40:43], s62 offen lds
    s_add_u32 m0, s63, 24576
    s_add_u32 s62, s60, 442368
    buffer_load_dwordx4 v166, s[40:43], s62 offen lds
    s_add_u32 m0, s63, 25600
    s_add_u32 s62, s60, 460800
    buffer_load_dwordx4 v166, s[40:43], s62 offen lds
    s_add_u32 m0, s63, 26624
    s_add_u32 s62, s60, 479232
    buffer_load_dwordx4 v166, s[40:43], s62 offen lds
    s_add_u32 m0, s63, 27648
    s_add_u32 s62, s60, 497664
    buffer_load_dwordx4 v166, s[40:43], s62 offen lds
    s_add_u32 m0, s63, 28672
    s_add_u32 s62, s60, 516096
    buffer_load_dwordx4 v166, s[40:43], s62 offen lds
    s_add_u32 m0, s63, 29696
    s_add_u32 s62, s60, 534528
    buffer_load_dwordx4 v166, s[40:43], s62 offen lds
    s_add_u32 m0, s63, 30720
    s_add_u32 s62, s60, 552960
    buffer_load_dwordx4 v166, s[40:43], s62 offen lds
    s_add_u32 m0, s63, 31744
    s_add_u32 s62, s60, 571392
    buffer_load_dwordx4 v166, s[40:43], s62 offen lds
    s_waitcnt vmcnt(24)
    ds_read_b64_tr_b16 a[0:1], v167 offset:0
    ds_read_b64_tr_b16 a[2:3], v167 offset:512
    ds_read_b64_tr_b16 a[4:5], v167 offset:1024
    ds_read_b64_tr_b16 a[6:7], v167 offset:1536
    ds_read_b64_tr_b16 a[8:9], v167 offset:2048
    ds_read_b64_tr_b16 a[10:11], v167 offset:2560
    ds_read_b64_tr_b16 a[12:13], v167 offset:3072
    ds_read_b64_tr_b16 a[14:15], v167 offset:3584
    ds_read_b64_tr_b16 a[16:17], v167 offset:4096
    ds_read_b64_tr_b16 a[18:19], v167 offset:4608
    ds_read_b64_tr_b16 a[20:21], v167 offset:5120
    ds_read_b64_tr_b16 a[22:23], v167 offset:5632
    ds_read_b64_tr_b16 a[24:25], v167 offset:6144
    ds_read_b64_tr_b16 a[26:27], v167 offset:6656
    ds_read_b64_tr_b16 a[28:29], v167 offset:7168
    ds_read_b64_tr_b16 a[30:31], v167 offset:7680
    s_waitcnt lgkmcnt(0)
    s_add_u32 m0, s63, 0
    s_add_u32 s62, s60, 589824
    buffer_load_dwordx4 v166, s[40:43], s62 offen lds
    s_add_u32 m0, s63, 1024
    s_add_u32 s62, s60, 608256
    buffer_load_dwordx4 v166, s[40:43], s62 offen lds
    s_add_u32 m0, s63, 2048
    s_add_u32 s62, s60, 626688
    buffer_load_dwordx4 v166, s[40:43], s62 offen lds
    s_add_u32 m0, s63, 3072
    s_add_u32 s62, s60, 645120
    buffer_load_dwordx4 v166, s[40:43], s62 offen lds
    s_add_u32 m0, s63, 4096
    s_add_u32 s62, s60, 663552
    buffer_load_dwordx4 v166, s[40:43], s62 offen lds
    s_add_u32 m0, s63, 5120
    s_add_u32 s62, s60, 681984
    buffer_load_dwordx4 v166, s[40:43], s62 offen lds
    s_add_u32 m0, s63, 6144
    s_add_u32 s62, s60, 700416
    buffer_load_dwordx4 v166, s[40:43], s62 offen lds
    s_add_u32 m0, s63, 7168
    s_add_u32 s62, s60, 718848
    buffer_load_dwordx4 v166, s[40:43], s62 offen lds
    s_waitcnt vmcnt(24)
    ds_read_b64_tr_b16 a[32:33], v167 offset:8192
    ds_read_b64_tr_b16 a[34:35], v167 offset:8704
    ds_read_b64_tr_b16 a[36:37], v167 offset:9216
    ds_read_b64_tr_b16 a[38:39], v167 offset:9728
    ds_read_b64_tr_b16 a[40:41], v167 offset:10240
    ds_read_b64_tr_b16 a[42:43], v167 offset:10752
    ds_read_b64_tr_b16 a[44:45], v167 offset:11264
    ds_read_b64_tr_b16 a[46:47], v167 offset:11776
    ds_read_b64_tr_b16 a[48:49], v167 offset:12288
    ds_read_b64_tr_b16 a[50:51], v167 offset:12800
    ds_read_b64_tr_b16 a[52:53], v167 offset:13312
    ds_read_b64_tr_b16 a[54:55], v167 offset:13824
    ds_read_b64_tr_b16 a[56:57], v167 offset:14336
    ds_read_b64_tr_b16 a[58:59], v167 offset:14848
    ds_read_b64_tr_b16 a[60:61], v167 offset:15360
    ds_read_b64_tr_b16 a[62:63], v167 offset:15872
    s_waitcnt lgkmcnt(0)
    s_add_u32 m0, s63, 8192
    s_add_u32 s62, s60, 737280
    buffer_load_dwordx4 v166, s[40:43], s62 offen lds
    s_add_u32 m0, s63, 9216
    s_add_u32 s62, s60, 755712
    buffer_load_dwordx4 v166, s[40:43], s62 offen lds
    s_add_u32 m0, s63, 10240
    s_add_u32 s62, s60, 774144
    buffer_load_dwordx4 v166, s[40:43], s62 offen lds
    s_add_u32 m0, s63, 11264
    s_add_u32 s62, s60, 792576
    buffer_load_dwordx4 v166, s[40:43], s62 offen lds
    s_add_u32 m0, s63, 12288
    s_add_u32 s62, s60, 811008
    buffer_load_dwordx4 v166, s[40:43], s62 offen lds
    s_add_u32 m0, s63, 13312
    s_add_u32 s62, s60, 829440
    buffer_load_dwordx4 v166, s[40:43], s62 offen lds
    s_add_u32 m0, s63, 14336
    s_add_u32 s62, s60, 847872
    buffer_load_dwordx4 v166, s[40:43], s62 offen lds
    s_add_u32 m0, s63, 15360
    s_add_u32 s62, s60, 866304
    buffer_load_dwordx4 v166, s[40:43], s62 offen lds
    s_waitcnt vmcnt(24)
    ds_read_b64_tr_b16 a[64:65], v167 offset:16384
    ds_read_b64_tr_b16 a[66:67], v167 offset:16896
    ds_read_b64_tr_b16 a[68:69], v167 offset:17408
    ds_read_b64_tr_b16 a[70:71], v167 offset:17920
    ds_read_b64_tr_b16 a[72:73], v167 offset:18432
    ds_read_b64_tr_b16 a[74:75], v167 offset:18944
    ds_read_b64_tr_b16 a[76:77], v167 offset:19456
    ds_read_b64_tr_b16 a[78:79], v167 offset:19968
    ds_read_b64_tr_b16 a[80:81], v167 offset:20480
    ds_read_b64_tr_b16 a[82:83], v167 offset:20992
    ds_read_b64_tr_b16 a[84:85], v167 offset:21504
    ds_read_b64_tr_b16 a[86:87], v167 offset:22016
    ds_read_b64_tr_b16 a[88:89], v167 offset:22528
    ds_read_b64_tr_b16 a[90:91], v167 offset:23040
    ds_read_b64_tr_b16 a[92:93], v167 offset:23552
    ds_read_b64_tr_b16 a[94:95], v167 offset:24064
    s_waitcnt lgkmcnt(0)
    s_add_u32 m0, s63, 16384
    s_add_u32 s62, s60, 884736
    buffer_load_dwordx4 v166, s[40:43], s62 offen lds
    s_add_u32 m0, s63, 17408
    s_add_u32 s62, s60, 903168
    buffer_load_dwordx4 v166, s[40:43], s62 offen lds
    s_add_u32 m0, s63, 18432
    s_add_u32 s62, s60, 921600
    buffer_load_dwordx4 v166, s[40:43], s62 offen lds
    s_add_u32 m0, s63, 19456
    s_add_u32 s62, s60, 940032
    buffer_load_dwordx4 v166, s[40:43], s62 offen lds
    s_add_u32 m0, s63, 20480
    s_add_u32 s62, s60, 958464
    buffer_load_dwordx4 v166, s[40:43], s62 offen lds
    s_add_u32 m0, s63, 21504
    s_add_u32 s62, s60, 976896
    buffer_load_dwordx4 v166, s[40:43], s62 offen lds
    s_add_u32 m0, s63, 22528
    s_add_u32 s62, s60, 995328
    buffer_load_dwordx4 v166, s[40:43], s62 offen lds
    s_add_u32 m0, s63, 23552
    s_add_u32 s62, s60, 1013760
    buffer_load_dwordx4 v166, s[40:43], s62 offen lds
    s_waitcnt vmcnt(24)
    ds_read_b64_tr_b16 a[96:97], v167 offset:24576
    ds_read_b64_tr_b16 a[98:99], v167 offset:25088
    ds_read_b64_tr_b16 a[100:101], v167 offset:25600
    ds_read_b64_tr_b16 a[102:103], v167 offset:26112
    ds_read_b64_tr_b16 a[104:105], v167 offset:26624
    ds_read_b64_tr_b16 a[106:107], v167 offset:27136
    ds_read_b64_tr_b16 a[108:109], v167 offset:27648
    ds_read_b64_tr_b16 a[110:111], v167 offset:28160
    ds_read_b64_tr_b16 a[112:113], v167 offset:28672
    ds_read_b64_tr_b16 a[114:115], v167 offset:29184
    ds_read_b64_tr_b16 a[116:117], v167 offset:29696
    ds_read_b64_tr_b16 a[118:119], v167 offset:30208
    ds_read_b64_tr_b16 a[120:121], v167 offset:30720
    ds_read_b64_tr_b16 a[122:123], v167 offset:31232
    ds_read_b64_tr_b16 a[124:125], v167 offset:31744
    ds_read_b64_tr_b16 a[126:127], v167 offset:32256
    s_waitcnt lgkmcnt(0)
    s_add_u32 m0, s63, 24576
    s_add_u32 s62, s60, 1032192
    buffer_load_dwordx4 v166, s[40:43], s62 offen lds
    s_add_u32 m0, s63, 25600
    s_add_u32 s62, s60, 1050624
    buffer_load_dwordx4 v166, s[40:43], s62 offen lds
    s_add_u32 m0, s63, 26624
    s_add_u32 s62, s60, 1069056
    buffer_load_dwordx4 v166, s[40:43], s62 offen lds
    s_add_u32 m0, s63, 27648
    s_add_u32 s62, s60, 1087488
    buffer_load_dwordx4 v166, s[40:43], s62 offen lds
    s_add_u32 m0, s63, 28672
    s_add_u32 s62, s60, 1105920
    buffer_load_dwordx4 v166, s[40:43], s62 offen lds
    s_add_u32 m0, s63, 29696
    s_add_u32 s62, s60, 1124352
    buffer_load_dwordx4 v166, s[40:43], s62 offen lds
    s_add_u32 m0, s63, 30720
    s_add_u32 s62, s60, 1142784
    buffer_load_dwordx4 v166, s[40:43], s62 offen lds
    s_add_u32 m0, s63, 31744
    s_add_u32 s62, s60, 1161216
    buffer_load_dwordx4 v166, s[40:43], s62 offen lds
    s_waitcnt vmcnt(24)
    ds_read_b64_tr_b16 a[128:129], v167 offset:0
    ds_read_b64_tr_b16 a[130:131], v167 offset:512
    ds_read_b64_tr_b16 a[132:133], v167 offset:1024
    ds_read_b64_tr_b16 a[134:135], v167 offset:1536
    ds_read_b64_tr_b16 a[136:137], v167 offset:2048
    ds_read_b64_tr_b16 a[138:139], v167 offset:2560
    ds_read_b64_tr_b16 a[140:141], v167 offset:3072
    ds_read_b64_tr_b16 a[142:143], v167 offset:3584
    ds_read_b64_tr_b16 a[144:145], v167 offset:4096
    ds_read_b64_tr_b16 a[146:147], v167 offset:4608
    ds_read_b64_tr_b16 a[148:149], v167 offset:5120
    ds_read_b64_tr_b16 a[150:151], v167 offset:5632
    ds_read_b64_tr_b16 a[152:153], v167 offset:6144
    ds_read_b64_tr_b16 a[154:155], v167 offset:6656
    ds_read_b64_tr_b16 a[156:157], v167 offset:7168
    ds_read_b64_tr_b16 a[158:159], v167 offset:7680
    s_waitcnt vmcnt(16)
    ds_read_b64_tr_b16 a[160:161], v167 offset:8192
    ds_read_b64_tr_b16 a[162:163], v167 offset:8704
    ds_read_b64_tr_b16 a[164:165], v167 offset:9216
    ds_read_b64_tr_b16 a[166:167], v167 offset:9728
    ds_read_b64_tr_b16 a[168:169], v167 offset:10240
    ds_read_b64_tr_b16 a[170:171], v167 offset:10752
    ds_read_b64_tr_b16 a[172:173], v167 offset:11264
    ds_read_b64_tr_b16 a[174:175], v167 offset:11776
    ds_read_b64_tr_b16 a[176:177], v167 offset:12288
    ds_read_b64_tr_b16 a[178:179], v167 offset:12800
    ds_read_b64_tr_b16 a[180:181], v167 offset:13312
    ds_read_b64_tr_b16 a[182:183], v167 offset:13824
    ds_read_b64_tr_b16 a[184:185], v167 offset:14336
    ds_read_b64_tr_b16 a[186:187], v167 offset:14848
    ds_read_b64_tr_b16 a[188:189], v167 offset:15360
    ds_read_b64_tr_b16 a[190:191], v167 offset:15872
    s_waitcnt vmcnt(8)
    ds_read_b64_tr_b16 a[192:193], v167 offset:16384
    ds_read_b64_tr_b16 a[194:195], v167 offset:16896
    ds_read_b64_tr_b16 a[196:197], v167 offset:17408
    ds_read_b64_tr_b16 a[198:199], v167 offset:17920
    ds_read_b64_tr_b16 a[200:201], v167 offset:18432
    ds_read_b64_tr_b16 a[202:203], v167 offset:18944
    ds_read_b64_tr_b16 a[204:205], v167 offset:19456
    ds_read_b64_tr_b16 a[206:207], v167 offset:19968
    ds_read_b64_tr_b16 a[208:209], v167 offset:20480
    ds_read_b64_tr_b16 a[210:211], v167 offset:20992
    ds_read_b64_tr_b16 a[212:213], v167 offset:21504
    ds_read_b64_tr_b16 a[214:215], v167 offset:22016
    ds_read_b64_tr_b16 a[216:217], v167 offset:22528
    ds_read_b64_tr_b16 a[218:219], v167 offset:23040
    ds_read_b64_tr_b16 a[220:221], v167 offset:23552
    ds_read_b64_tr_b16 a[222:223], v167 offset:24064
    s_waitcnt vmcnt(0)
    ds_read_b64_tr_b16 a[224:225], v167 offset:24576
    ds_read_b64_tr_b16 a[226:227], v167 offset:25088
    ds_read_b64_tr_b16 a[228:229], v167 offset:25600
    ds_read_b64_tr_b16 a[230:231], v167 offset:26112
    ds_read_b64_tr_b16 a[232:233], v167 offset:26624
    ds_read_b64_tr_b16 a[234:235], v167 offset:27136
    ds_read_b64_tr_b16 a[236:237], v167 offset:27648
    ds_read_b64_tr_b16 a[238:239], v167 offset:28160
    ds_read_b64_tr_b16 a[240:241], v167 offset:28672
    ds_read_b64_tr_b16 a[242:243], v167 offset:29184
    ds_read_b64_tr_b16 a[244:245], v167 offset:29696
    ds_read_b64_tr_b16 a[246:247], v167 offset:30208
    ds_read_b64_tr_b16 a[248:249], v167 offset:30720
    ds_read_b64_tr_b16 a[250:251], v167 offset:31232
    ds_read_b64_tr_b16 a[252:253], v167 offset:31744
    ds_read_b64_tr_b16 a[254:255], v167 offset:32256
    s_waitcnt lgkmcnt(0)
M_noos:
    s_barrier
    s_mov_b32 s88, 200000
    v_mov_b32 v250, 68
WG_3:
    buffer_load_dword v251, v250, s[48:51], 0 offen sc1
    s_sub_u32 s88, s88, 1
    s_cbranch_scc1 M_abort
    s_waitcnt vmcnt(0)
    v_cmp_le_u32 vcc, 224, v251
    s_cbranch_vccnz WG_3_ok
    s_sleep 8
    s_branch WG_3
WG_3_ok:
    s_cmp_ge_u32 s86, 44
    s_cbranch_scc1 M_nof1
    s_lshl_b32 s64, s85, 2
    s_add_u32 s64, s64, s56
    s_min_u32 s65, s64, 17
    s_mul_i32 s65, s65, 36864
    s_add_u32 s65, s65, 88080384
    v_lshlrev_b32 v44, 4, v1
    s_lshl_b32 s61, s56, 10
    v_lshrrev_b32 v42, 3, v1
    v_and_b32 v43, 6, v42
    s_lshr_b32 s60, s56, 1
    v_or_b32 v43, s60, v43
    v_and_b32 v40, 7, v1
    v_xor_b32 v40, v40, v43
    v_lshlrev_b32 v40, 4, v40
    s_lshl_b32 s60, s56, 3
    v_add_u32 v42, s60, v42
    s_mov_b32 s60, 73728
    v_mul_lo_u32 v42, v42, s60
    v_add_u32 v40, v40, v42
    v_and_b32 v42, 6, v1
    v_bfe_u32 v43, v1, 4, 1
    v_or_b32 v42, v42, v43
    v_lshrrev_b32 v43, 5, v1
    v_xor_b32 v42, v42, v43
    v_and_b32 v43, 31, v1
    v_lshlrev_b32 v43, 7, v43
    v_xor_b32 v36, 0, v42
    v_lshlrev_b32 v36, 4, v36
    v_add_u32 v36, v36, v43
    v_xor_b32 v37, 2, v42
    v_lshlrev_b32 v37, 4, v37
    v_add_u32 v37, v37, v43
    v_xor_b32 v38, 4, v42
    v_lshlrev_b32 v38, 4, v38
    v_add_u32 v38, v38, v43
    v_xor_b32 v39, 6, v42
    v_lshlrev_b32 v39, 4, v39
    v_add_u32 v39, v39, v43
    v_and_b32 v42, 31, v1
    v_lshlrev_b32 v41, 12, v42
    v_lshrrev_b32 v42, 5, v1
    v_lshl_add_u32 v41, v42, 9, v41
    s_mov_b32 s66, s86
    s_mov_b32 s67, s61
    s_barrier
    s_add_u32 m0, s67, 0
    s_mul_i32 s62, s66, 1152
    s_add_u32 s62, s62, 0
    buffer_load_dwordx4 v40, s[8:11], s62 offen lds
    s_add_u32 m0, s67, 4096
    s_mul_i32 s62, s66, 1152
    s_add_u32 s62, s62, 128
    buffer_load_dwordx4 v40, s[8:11], s62 offen lds
    s_add_u32 m0, s67, 8192
    s_mul_i32 s62, s66, 1152
    s_add_u32 s62, s62, 256
    buffer_load_dwordx4 v40, s[8:11], s62 offen lds
    s_add_u32 m0, s67, 12288
    s_mul_i32 s62, s66, 1152
    s_add_u32 s62, s62, 384
    buffer_load_dwordx4 v40, s[8:11], s62 offen lds
    s_add_u32 m0, s67, 16384
    s_mul_i32 s62, s66, 1152
    s_add_u32 s62, s62, 512
    buffer_load_dwordx4 v40, s[8:11], s62 offen lds
    s_add_u32 m0, s67, 20480
    s_mul_i32 s62, s66, 1152
    s_add_u32 s62, s62, 640
    buffer_load_dwordx4 v40, s[8:11], s62 offen lds
    s_add_u32 m0, s67, 24576
    s_mul_i32 s62, s66, 1152
    s_add_u32 s62, s62, 768
    buffer_load_dwordx4 v40, s[8:11], s62 offen lds
    s_add_u32 m0, s67, 28672
    s_mul_i32 s62, s66, 1152
    s_add_u32 s62, s62, 896
    buffer_load_dwordx4 v40, s[8:11], s62 offen lds
    s_add_u32 m0, s67, 32768
    s_mul_i32 s62, s66, 1152
    s_add_u32 s62, s62, 1024
    buffer_load_dwordx4 v40, s[8:11], s62 offen lds
    buffer_load_dwordx4 v[112:115], v44, s[52:55], s65 offen offset:0 sc1
    buffer_load_dwordx4 v[116:119], v44, s[52:55], s65 offen offset:1024 sc1
    buffer_load_dwordx4 v[120:123], v44, s[52:55], s65 offen offset:2048 sc1
    buffer_load_dwordx4 v[124:127], v44, s[52:55], s65 offen offset:3072 sc1
    s_add_u32 s65, s65, 4096
    buffer_load_dwordx4 v[128:131], v44, s[52:55], s65 offen offset:0 sc1
    buffer_load_dwordx4 v[132:135], v44, s[52:55], s65 offen offset:1024 sc1
    buffer_load_dwordx4 v[136:139], v44, s[52:55], s65 offen offset:2048 sc1
    buffer_load_dwordx4 v[140:143], v44, s[52:55], s65 offen offset:3072 sc1
    s_add_u32 s65, s65, 4096
    buffer_load_dwordx4 v[144:147], v44, s[52:55], s65 offen offset:0 sc1
    buffer_load_dwordx4 v[148:151], v44, s[52:55], s65 offen offset:1024 sc1
    buffer_load_dwordx4 v[152:155], v44, s[52:55], s65 offen offset:2048 sc1
    buffer_load_dwordx4 v[156:159], v44, s[52:55], s65 offen offset:3072 sc1
    s_add_u32 s65, s65, 4096
    buffer_load_dwordx4 v[160:163], v44, s[52:55], s65 offen offset:0 sc1
    buffer_load_dwordx4 v[164:167], v44, s[52:55], s65 offen offset:1024 sc1
    buffer_load_dwordx4 v[168:171], v44, s[52:55], s65 offen offset:2048 sc1
    buffer_load_dwordx4 v[172:175], v44, s[52:55], s65 offen offset:3072 sc1
    s_add_u32 s65, s65, 4096
    buffer_load_dwordx4 v[176:179], v44, s[52:55], s65 offen offset:0 sc1
    buffer_load_dwordx4 v[180:183], v44, s[52:55], s65 offen offset:1024 sc1
    buffer_load_dwordx4 v[184:187], v44, s[52:55], s65 offen offset:2048 sc1
    buffer_load_dwordx4 v[188:191], v44, s[52:55], s65 offen offset:3072 sc1
    s_add_u32 s65, s65, 4096
    buffer_load_dwordx4 v[192:195], v44, s[52:55], s65 offen offset:0 sc1
    buffer_load_dwordx4 v[196:199], v44, s[52:55], s65 offen offset:1024 sc1
    buffer_load_dwordx4 v[200:203], v44, s[52:55], s65 offen offset:2048 sc1
    buffer_load_dwordx4 v[204:207], v44, s[52:55], s65 offen offset:3072 sc1
    s_add_u32 s65, s65, 4096
    buffer_load_dwordx4 v[208:211], v44, s[52:55], s65 offen offset:0 sc1
    buffer_load_dwordx4 v[212:215], v44, s[52:55], s65 offen offset:1024 sc1
    buffer_load_dwordx4 v[216:219], v44, s[52:55], s65 offen offset:2048 sc1
    buffer_load_dwordx4 v[220:223], v44, s[52:55], s65 offen offset:3072 sc1
    s_add_u32 s65, s65, 4096
    buffer_load_dwordx4 v[224:227], v44, s[52:55], s65 offen offset:0 sc1
    buffer_load_dwordx4 v[228:231], v44, s[52:55], s65 offen offset:1024 sc1
    buffer_load_dwordx4 v[232:235], v44, s[52:55], s65 offen offset:2048 sc1
    buffer_load_dwordx4 v[236:239], v44, s[52:55], s65 offen offset:3072 sc1
    s_add_u32 s65, s65, 4096
    buffer_load_dwordx4 v[240:243], v44, s[52:55], s65 offen offset:0 sc1
    buffer_load_dwordx4 v[244:247], v44, s[52:55], s65 offen offset:1024 sc1
    buffer_load_dwordx4 v[248:251], v44, s[52:55], s65 offen offset:2048 sc1
    buffer_load_dwordx4 v[252:255], v44, s[52:55], s65 offen offset:3072 sc1
F1_loop:
    s_waitcnt vmcnt(0)
    s_barrier
    s_add_u32 s68, s66, 44
    s_xor_b32 s67, s67, 65536
    s_cmp_ge_u32 s68, 64
    s_cbranch_scc1 F1_nopf
    s_add_u32 m0, s67, 0
    s_mul_i32 s62, s68, 1152
    s_add_u32 s62, s62, 0
    buffer_load_dwordx4 v40, s[8:11], s62 offen lds
    s_add_u32 m0, s67, 4096
    s_mul_i32 s62, s68, 1152
    s_add_u32 s62, s62, 128
    buffer_load_dwordx4 v40, s[8:11], s62 offen lds
    s_add_u32 m0, s67, 8192
    s_mul_i32 s62, s68, 1152
    s_add_u32 s62, s62, 256
    buffer_load_dwordx4 v40, s[8:11], s62 offen lds
    s_add_u32 m0, s67, 12288
    s_mul_i32 s62, s68, 1152
    s_add_u32 s62, s62, 384
    buffer_load_dwordx4 v40, s[8:11], s62 offen lds
    s_add_u32 m0, s67, 16384
    s_mul_i32 s62, s68, 1152
    s_add_u32 s62, s62, 512
    buffer_load_dwordx4 v40, s[8:11], s62 offen lds
    s_add_u32 m0, s67, 20480
    s_mul_i32 s62, s68, 1152
    s_add_u32 s62, s62, 640
    buffer_load_dwordx4 v40, s[8:11], s62 offen lds
    s_add_u32 m0, s67, 24576
    s_mul_i32 s62, s68, 1152
    s_add_u32 s62, s62, 768
    buffer_load_dwordx4 v40, s[8:11], s62 offen lds
    s_add_u32 m0, s67, 28672
    s_mul_i32 s62, s68, 1152
    s_add_u32 s62, s62, 896
    buffer_load_dwordx4 v40, s[8:11], s62 offen lds
    s_add_u32 m0, s67, 32768
    s_mul_i32 s62, s68, 1152
    s_add_u32 s62, s62, 1024
    buffer_load_dwordx4 v40, s[8:11], s62 offen lds
F1_nopf:
    ds_read_b128 v[24:27], v36 offset:0
    ds_read_b128 v[28:31], v37 offset:0
    s_waitcnt lgkmcnt(1)
    v_mfma_f32_32x32x16_bf16 v[8:23], v[24:27], v[112:115], 0
    ds_read_b128 v[32:35], v38 offset:0
    s_waitcnt lgkmcnt(1)
    v_mfma_f32_32x32x16_bf16 v[8:23], v[28:31], v[116:119], v[8:23]
    ds_read_b128 v[24:27], v39 offset:0
    s_waitcnt lgkmcnt(1)
    v_mfma_f32_32x32x16_bf16 v[8:23], v[32:35], v[120:123], v[8:23]
    ds_read_b128 v[28:31], v36 offset:4096
    s_waitcnt lgkmcnt(1)
    v_mfma_f32_32x32x16_bf16 v[8:23], v[24:27], v[124:127], v[8:23]
    ds_read_b128 v[32:35], v37 offset:4096
    s_waitcnt lgkmcnt(1)
    v_mfma_f32_32x32x16_bf16 v[8:23], v[28:31], v[128:131], v[8:23]
    ds_read_b128 v[24:27], v38 offset:4096
    s_waitcnt lgkmcnt(1)
    v_mfma_f32_32x32x16_bf16 v[8:23], v[32:35], v[132:135], v[8:23]
    ds_read_b128 v[28:31], v39 offset:4096
    s_waitcnt lgkmcnt(1)
    v_mfma_f32_32x32x16_bf16 v[8:23], v[24:27], v[136:139], v[8:23]
    ds_read_b128 v[32:35], v36 offset:8192
    s_waitcnt lgkmcnt(1)
    v_mfma_f32_32x32x16_bf16 v[8:23], v[28:31], v[140:143], v[8:23]
    ds_read_b128 v[24:27], v37 offset:8192
    s_waitcnt lgkmcnt(1)
    v_mfma_f32_32x32x16_bf16 v[8:23], v[32:35], v[144:147], v[8:23]
    ds_read_b128 v[28:31], v38 offset:8192
    s_waitcnt lgkmcnt(1)
    v_mfma_f32_32x32x16_bf16 v[8:23], v[24:27], v[148:151], v[8:23]
    ds_read_b128 v[32:35], v39 offset:8192
    s_waitcnt lgkmcnt(1)
    v_mfma_f32_32x32x16_bf16 v[8:23], v[28:31], v[152:155], v[8:23]
    ds_read_b128 v[24:27], v36 offset:12288
    s_waitcnt lgkmcnt(1)
    v_mfma_f32_32x32x16_bf16 v[8:23], v[32:35], v[156:159], v[8:23]
    ds_read_b128 v[28:31], v37 offset:12288
    s_waitcnt lgkmcnt(1)
    v_mfma_f32_32x32x16_bf16 v[8:23], v[24:27], v[160:163], v[8:23]
    ds_read_b128 v[32:35], v38 offset:12288
    s_waitcnt lgkmcnt(1)
    v_mfma_f32_32x32x16_bf16 v[8:23], v[28:31], v[164:167], v[8:23]
    ds_read_b128 v[24:27], v39 offset:12288
    s_waitcnt lgkmcnt(1)
    v_mfma_f32_32x32x16_bf16 v[8:23], v[32:35], v[168:171], v[8:23]
    ds_read_b128 v[28:31], v36 offset:16384
    s_waitcnt lgkmcnt(1)
    v_mfma_f32_32x32x16_bf16 v[8:23], v[24:27], v[172:175], v[8:23]
    ds_read_b128 v[32:35], v37 offset:16384
    s_waitcnt lgkmcnt(1)
    v_mfma_f32_32x32x16_bf16 v[8:23], v[28:31], v[176:179], v[8:23]
    ds_read_b128 v[24:27], v38 offset:16384
    s_waitcnt lgkmcnt(1)
    v_mfma_f32_32x32x16_bf16 v[8:23], v[32:35], v[180:183], v[8:23]
    ds_read_b128 v[28:31], v39 offset:16384
    s_waitcnt lgkmcnt(1)
    v_mfma_f32_32x32x16_bf16 v[8:23], v[24:27], v[184:187], v[8:23]
    ds_read_b128 v[32:35], v36 offset:20480
    s_waitcnt lgkmcnt(1)
    v_mfma_f32_32x32x16_bf16 v[8:23], v[28:31], v[188:191], v[8:23]
    ds_read_b128 v[24:27], v37 offset:20480
    s_waitcnt lgkmcnt(1)
    v_mfma_f32_32x32x16_bf16 v[8:23], v[32:35], v[192:195], v[8:23]
    ds_read_b128 v[28:31], v38 offset:20480
    s_waitcnt lgkmcnt(1)
    v_mfma_f32_32x32x16_bf16 v[8:23], v[24:27], v[196:199], v[8:23]
    ds_read_b128 v[32:35], v39 offset:20480
    s_waitcnt lgkmcnt(1)
    v_mfma_f32_32x32x16_bf16 v[8:23], v[28:31], v[200:203], v[8:23]
    ds_read_b128 v[24:27], v36 offset:24576
    s_waitcnt lgkmcnt(1)
    v_mfma_f32_32x32x16_bf16 v[8:23], v[32:35], v[204:207], v[8:23]
    ds_read_b128 v[28:31], v37 offset:24576
    s_waitcnt lgkmcnt(1)
    v_mfma_f32_32x32x16_bf16 v[8:23], v[24:27], v[208:211], v[8:23]
    ds_read_b128 v[32:35], v38 offset:24576
    s_waitcnt lgkmcnt(1)
    v_mfma_f32_32x32x16_bf16 v[8:23], v[28:31], v[212:215], v[8:23]
    ds_read_b128 v[24:27], v39 offset:24576
    s_waitcnt lgkmcnt(1)
    v_mfma_f32_32x32x16_bf16 v[8:23], v[32:35], v[216:219], v[8:23]
    ds_read_b128 v[28:31], v36 offset:28672
    s_waitcnt lgkmcnt(1)
    v_mfma_f32_32x32x16_bf16 v[8:23], v[24:27], v[220:223], v[8:23]
    ds_read_b128 v[32:35], v37 offset:28672
    s_waitcnt lgkmcnt(1)
    v_mfma_f32_32x32x16_bf16 v[8:23], v[28:31], v[224:227], v[8:23]
    ds_read_b128 v[24:27], v38 offset:28672
    s_waitcnt lgkmcnt(1)
    v_mfma_f32_32x32x16_bf16 v[8:23], v[32:35], v[228:231], v[8:23]
    ds_read_b128 v[28:31], v39 offset:28672
    s_waitcnt lgkmcnt(1)
    v_mfma_f32_32x32x16_bf16 v[8:23], v[24:27], v[232:235], v[8:23]
    ds_read_b128 v[32:35], v36 offset:32768
    s_waitcnt lgkmcnt(1)
    v_mfma_f32_32x32x16_bf16 v[8:23], v[28:31], v[236:239], v[8:23]
    ds_read_b128 v[24:27], v37 offset:32768
    s_waitcnt lgkmcnt(1)
    v_mfma_f32_32x32x16_bf16 v[8:23], v[32:35], v[240:243], v[8:23]
    ds_read_b128 v[28:31], v38 offset:32768
    s_waitcnt lgkmcnt(1)
    v_mfma_f32_32x32x16_bf16 v[8:23], v[24:27], v[244:247], v[8:23]
    ds_read_b128 v[32:35], v39 offset:32768
    s_waitcnt lgkmcnt(1)
    v_mfma_f32_32x32x16_bf16 v[8:23], v[28:31], v[248:251], v[8:23]
    s_waitcnt lgkmcnt(0)
    v_mfma_f32_32x32x16_bf16 v[8:23], v[32:35], v[252:255], v[8:23]
    v_xor_b32 v36, 0x10000, v36
    v_xor_b32 v37, 0x10000, v37
    v_xor_b32 v38, 0x10000, v38
    v_xor_b32 v39, 0x10000, v39
    s_lshl_b32 s60, s64, 17
    s_lshr_b32 s62, s66, 5
    s_lshl_b32 s62, s62, 11
    s_add_u32 s60, s60, s62
    s_and_b32 s62, s66, 31
    s_lshl_b32 s62, s62, 4
    s_add_u32 s60, s60, s62
    s_add_u32 s60, s60, 93323264
    s_cmp_ge_u32 s64, 18
    s_cbranch_scc1 F1_nost
    v_cvt_pk_bf16_f32 v8, v8, v9
    v_cvt_pk_bf16_f32 v9, v10, v11
    v_cvt_pk_bf16_f32 v10, v12, v13
    v_cvt_pk_bf16_f32 v11, v14, v15
    v_cvt_pk_bf16_f32 v12, v16, v17
    v_cvt_pk_bf16_f32 v13, v18, v19
    v_cvt_pk_bf16_f32 v14, v20, v21
    v_cvt_pk_bf16_f32 v15, v22, v23
    buffer_store_dwordx4 v[8:11], v41, s[52:55], s60 offen sc1
    buffer_store_dwordx4 v[12:15], v41, s[52:55], s60 offen offset:1024 sc1
F1_nost:
    s_mov_b32 s66, s68
    s_cmp_lt_u32 s66, 64
    s_cbranch_scc1 F1_loop
M_nof1:
    s_waitcnt vmcnt(0)
    s_barrier
    s_cmp_lg_u32 s56, 0
    s_cbranch_scc1 SG_4
    v_mov_b32 v250, 72
    v_mov_b32 v251, 1
    s_mov_b64 exec, 1
    buffer_atomic_add v251, v250, s[48:51], 0 offen sc1
    s_mov_b64 exec, -1
SG_4:
    s_mov_b32 s88, 200000
    v_mov_b32 v250, 72
WG_5:
    buffer_load_dword v251, v250, s[48:51], 0 offen sc1
    s_sub_u32 s88, s88, 1
    s_cbranch_scc1 M_abort
    s_waitcnt vmcnt(0)
    v_cmp_le_u32 vcc, 224, v251
    s_cbranch_vccnz WG_5_ok
    s_sleep 8
    s_branch WG_5
WG_5_ok:
    s_cmp_gt_u32 s87, 288
    s_cbranch_scc1 M_nof2
    v_lshlrev_b32 v2, 4, v1
    s_mov_b32 s60, 93061120
    buffer_load_dwordx4 v[8:11], v2, s[52:55], s60 offen offset:0 sc1
    buffer_load_dwordx4 v[12:15], v2, s[52:55], s60 offen offset:1024 sc1
    buffer_load_dwordx4 v[16:19], v2, s[52:55], s60 offen offset:2048 sc1
    buffer_load_dwordx4 v[20:23], v2, s[52:55], s60 offen offset:3072 sc1
    s_add_u32 s60, s60, 4096
    buffer_load_dwordx4 v[24:27], v2, s[52:55], s60 offen offset:0 sc1
    buffer_load_dwordx4 v[28:31], v2, s[52:55], s60 offen offset:1024 sc1
    buffer_load_dwordx4 v[32:35], v2, s[52:55], s60 offen offset:2048 sc1
    buffer_load_dwordx4 v[36:39], v2, s[52:55], s60 offen offset:3072 sc1
    s_add_u32 s60, s60, 4096
    buffer_load_dwordx4 v[40:43], v2, s[52:55], s60 offen offset:0 sc1
    buffer_load_dwordx4 v[44:47], v2, s[52:55], s60 offen offset:1024 sc1
    buffer_load_dwordx4 v[48:51], v2, s[52:55], s60 offen offset:2048 sc1
    buffer_load_dwordx4 v[52:55], v2, s[52:55], s60 offen offset:3072 sc1
    s_add_u32 s60, s60, 4096
    buffer_load_dwordx4 v[56:59], v2, s[52:55], s60 offen offset:0 sc1
    buffer_load_dwordx4 v[60:63], v2, s[52:55], s60 offen offset:1024 sc1
    buffer_load_dwordx4 v[64:67], v2, s[52:55], s60 offen offset:2048 sc1
    buffer_load_dwordx4 v[68:71], v2, s[52:55], s60 offen offset:3072 sc1
    s_add_u32 s60, s60, 4096
    buffer_load_dwordx4 v[72:75], v2, s[52:55], s60 offen offset:0 sc1
    buffer_load_dwordx4 v[76:79], v2, s[52:55], s60 offen offset:1024 sc1
    buffer_load_dwordx4 v[80:83], v2, s[52:55], s60 offen offset:2048 sc1
    buffer_load_dwordx4 v[84:87], v2, s[52:55], s60 offen offset:3072 sc1
    s_add_u32 s60, s60, 4096
    buffer_load_dwordx4 v[88:91], v2, s[52:55], s60 offen offset:0 sc1
    buffer_load_dwordx4 v[92:95], v2, s[52:55], s60 offen offset:1024 sc1
    s_lshl_b32 s61, s87, 13
    s_cmp_eq_u32 s87, 288
    s_cselect_b32 s61, 4096, s61
    s_add_u32 s61, s61, 93323264
    s_add_u32 s62, s61, 4096
    s_cmp_eq_u32 s87, 288
    s_cselect_b32 s63, 1, 0
    s_cmp_eq_u32 s87, 0
    s_cselect_b32 s63, 1, s63
    buffer_load_dwordx4 v[96:99], v2, s[52:55], s61 offen offset:0 sc1
    buffer_load_dwordx4 v[100:103], v2, s[52:55], s61 offen offset:1024 sc1
    buffer_load_dwordx4 v[104:107], v2, s[52:55], s61 offen offset:2048 sc1
    buffer_load_dwordx4 v[108:111], v2, s[52:55], s61 offen offset:3072 sc1
    s_cmp_eq_u32 s63, 1
    s_cbranch_scc1 F2_zim
    buffer_load_dwordx4 v[112:115], v2, s[52:55], s62 offen offset:0 sc1
    buffer_load_dwordx4 v[116:119], v2, s[52:55], s62 offen offset:1024 sc1
    buffer_load_dwordx4 v[120:123], v2, s[52:55], s62 offen offset:2048 sc1
    buffer_load_dwordx4 v[124:127], v2, s[52:55], s62 offen offset:3072 sc1
    s_branch F2_zim2
F2_zim:
    v_mov_b32 v112, 0
    v_mov_b32 v113, 0
    v_mov_b32 v114, 0
    v_mov_b32 v115, 0
    v_mov_b32 v116, 0
    v_mov_b32 v117, 0
    v_mov_b32 v118, 0
    v_mov_b32 v119, 0
    v_mov_b32 v120, 0
    v_mov_b32 v121, 0
    v_mov_b32 v122, 0
    v_mov_b32 v123, 0
    v_mov_b32 v124, 0
    v_mov_b32 v125, 0
    v_mov_b32 v126, 0
    v_mov_b32 v127, 0
F2_zim2:
    v_and_b32 v240, 31, v1
    v_cvt_f32_u32 v3, v240
    v_mul_f32 v3, 973078528, v3
    v_lshrrev_b32 v241, 5, v1
    v_lshlrev_b32 v241, 2, v241
    v_cvt_f32_u32 v4, v241
    v_lshlrev_b32 v5, 7, v240
    v_lshl_add_u32 v5, v241, 2, v5
    s_mov_b32 s64, 904105529
    s_cmp_eq_u32 s63, 1
    s_cselect_b32 s64, 895716921, s64
    s_waitcnt vmcnt(0)
    v_mfma_f32_32x32x16_bf16 v[128:143], v[96:99], v[8:11], 0
    v_mfma_f32_32x32x16_bf16 v[128:143], v[100:103], v[12:15], v[128:143]
    v_mfma_f32_32x32x16_bf16 v[128:143], v[112:115], v[16:19], v[128:143]
    v_mfma_f32_32x32x16_bf16 v[128:143], v[116:119], v[20:23], v[128:143]
    v_mfma_f32_32x32x16_bf16 v[144:159], v[112:115], v[8:11], 0
    v_mfma_f32_32x32x16_bf16 v[144:159], v[116:119], v[12:15], v[144:159]
    v_mfma_f32_32x32x16_bf16 v[144:159], v[96:99], v[24:27], v[144:159]
    v_mfma_f32_32x32x16_bf16 v[144:159], v[100:103], v[28:31], v[144:159]
    v_mfma_f32_32x32x16_bf16 v[160:175], v[104:107], v[8:11], 0
    v_mfma_f32_32x32x16_bf16 v[160:175], v[108:111], v[12:15], v[160:175]
    v_mfma_f32_32x32x16_bf16 v[160:175], v[120:123], v[16:19], v[160:175]
    v_mfma_f32_32x32x16_bf16 v[160:175], v[124:127], v[20:23], v[160:175]
    v_mfma_f32_32x32x16_bf16 v[176:191], v[120:123], v[8:11], 0
    v_mfma_f32_32x32x16_bf16 v[176:191], v[124:127], v[12:15], v[176:191]
    v_mfma_f32_32x32x16_bf16 v[176:191], v[104:107], v[24:27], v[176:191]
    v_mfma_f32_32x32x16_bf16 v[176:191], v[108:111], v[28:31], v[176:191]
    s_lshl_b32 s61, s87, 13
    s_add_u32 s61, s61, 90177536
    buffer_load_dwordx4 v[96:99], v2, s[52:55], s61 offen offset:0 sc1
    buffer_load_dwordx4 v[100:103], v2, s[52:55], s61 offen offset:1024 sc1
    buffer_load_dwordx4 v[104:107], v2, s[52:55], s61 offen offset:2048 sc1
    buffer_load_dwordx4 v[108:111], v2, s[52:55], s61 offen offset:3072 sc1
    s_add_u32 s61, s61, 4096
    buffer_load_dwordx4 v[112:115], v2, s[52:55], s61 offen offset:0 sc1
    buffer_load_dwordx4 v[116:119], v2, s[52:55], s61 offen offset:1024 sc1
    buffer_load_dwordx4 v[120:123], v2, s[52:55], s61 offen offset:2048 sc1
    buffer_load_dwordx4 v[124:127], v2, s[52:55], s61 offen offset:3072 sc1
    s_nop 4
    v_add_f32 v240, 0, v4
    v_mul_f32 v240, v240, v3
    v_cos_f32 v241, v240
    v_sin_f32 v242, v240
    v_mul_f32 v243, v128, v241
    v_mul_f32 v241, v144, v241
    v_fma_f32 v243, v144, v242, v243
    v_fma_f32 v144, -v128, v242, v241
    v_mov_b32 v128, v243
    v_add_f32 v240, 1065353216, v4
    v_mul_f32 v240, v240, v3
    v_cos_f32 v241, v240
    v_sin_f32 v242, v240
    v_mul_f32 v243, v129, v241
    v_mul_f32 v241, v145, v241
    v_fma_f32 v243, v145, v242, v243
    v_fma_f32 v145, -v129, v242, v241
    v_mov_b32 v129, v243
    v_add_f32 v240, 1073741824, v4
    v_mul_f32 v240, v240, v3
    v_cos_f32 v241, v240
    v_sin_f32 v242, v240
    v_mul_f32 v243, v130, v241
    v_mul_f32 v241, v146, v241
    v_fma_f32 v243, v146, v242, v243
    v_fma_f32 v146, -v130, v242, v241
    v_mov_b32 v130, v243
    v_add_f32 v240, 1077936128, v4
    v_mul_f32 v240, v240, v3
    v_cos_f32 v241, v240
    v_sin_f32 v242, v240
    v_mul_f32 v243, v131, v241
    v_mul_f32 v241, v147, v241
    v_fma_f32 v243, v147, v242, v243
    v_fma_f32 v147, -v131, v242, v241
    v_mov_b32 v131, v243
    v_add_f32 v240, 1090519040, v4
    v_mul_f32 v240, v240, v3
    v_cos_f32 v241, v240
    v_sin_f32 v242, v240
    v_mul_f32 v243, v132, v241
    v_mul_f32 v241, v148, v241
    v_fma_f32 v243, v148, v242, v243
    v_fma_f32 v148, -v132, v242, v241
    v_mov_b32 v132, v243
    v_add_f32 v240, 1091567616, v4
    v_mul_f32 v240, v240, v3
    v_cos_f32 v241, v240
    v_sin_f32 v242, v240
    v_mul_f32 v243, v133, v241
    v_mul_f32 v241, v149, v241
    v_fma_f32 v243, v149, v242, v243
    v_fma_f32 v149, -v133, v242, v241
    v_mov_b32 v133, v243
    v_add_f32 v240, 1092616192, v4
    v_mul_f32 v240, v240, v3
    v_cos_f32 v241, v240
    v_sin_f32 v242, v240
    v_mul_f32 v243, v134, v241
    v_mul_f32 v241, v150, v241
    v_fma_f32 v243, v150, v242, v243
    v_fma_f32 v150, -v134, v242, v241
    v_mov_b32 v134, v243
    v_add_f32 v240, 1093664768, v4
    v_mul_f32 v240, v240, v3
    v_cos_f32 v241, v240
    v_sin_f32 v242, v240
    v_mul_f32 v243, v135, v241
    v_mul_f32 v241, v151, v241
    v_fma_f32 v243, v151, v242, v243
    v_fma_f32 v151, -v135, v242, v241
    v_mov_b32 v135, v243
    v_add_f32 v240, 1098907648, v4
    v_mul_f32 v240, v240, v3
    v_cos_f32 v241, v240
    v_sin_f32 v242, v240
    v_mul_f32 v243, v136, v241
    v_mul_f32 v241, v152, v241
    v_fma_f32 v243, v152, v242, v243
    v_fma_f32 v152, -v136, v242, v241
    v_mov_b32 v136, v243
    v_add_f32 v240, 1099431936, v4
    v_mul_f32 v240, v240, v3
    v_cos_f32 v241, v240
    v_sin_f32 v242, v240
    v_mul_f32 v243, v137, v241
    v_mul_f32 v241, v153, v241
    v_fma_f32 v243, v153, v242, v243
    v_fma_f32 v153, -v137, v242, v241
    v_mov_b32 v137, v243
    v_add_f32 v240, 1099956224, v4
    v_mul_f32 v240, v240, v3
    v_cos_f32 v241, v240
    v_sin_f32 v242, v240
    v_mul_f32 v243, v138, v241
    v_mul_f32 v241, v154, v241
    v_fma_f32 v243, v154, v242, v243
    v_fma_f32 v154, -v138, v242, v241
    v_mov_b32 v138, v243
    v_add_f32 v240, 1100480512, v4
    v_mul_f32 v240, v240, v3
    v_cos_f32 v241, v240
    v_sin_f32 v242, v240
    v_mul_f32 v243, v139, v241
    v_mul_f32 v241, v155, v241
    v_fma_f32 v243, v155, v242, v243
    v_fma_f32 v155, -v139, v242, v241
    v_mov_b32 v139, v243
    v_add_f32 v240, 1103101952, v4
    v_mul_f32 v240, v240, v3
    v_cos_f32 v241, v240
    v_sin_f32 v242, v240
    v_mul_f32 v243, v140, v241
    v_mul_f32 v241, v156, v241
    v_fma_f32 v243, v156, v242, v243
    v_fma_f32 v156, -v140, v242, v241
    v_mov_b32 v140, v243
    v_add_f32 v240, 1103626240, v4
    v_mul_f32 v240, v240, v3
    v_cos_f32 v241, v240
    v_sin_f32 v242, v240
    v_mul_f32 v243, v141, v241
    v_mul_f32 v241, v157, v241
    v_fma_f32 v243, v157, v242, v243
    v_fma_f32 v157, -v141, v242, v241
    v_mov_b32 v141, v243
    v_add_f32 v240, 1104150528, v4
    v_mul_f32 v240, v240, v3
    v_cos_f32 v241, v240
    v_sin_f32 v242, v240
    v_mul_f32 v243, v142, v241
    v_mul_f32 v241, v158, v241
    v_fma_f32 v243, v158, v242, v243
    v_fma_f32 v158, -v142, v242, v241
    v_mov_b32 v142, v243
    v_add_f32 v240, 1104674816, v4
    v_mul_f32 v240, v240, v3
    v_cos_f32 v241, v240
    v_sin_f32 v242, v240
    v_mul_f32 v243, v143, v241
    v_mul_f32 v241, v159, v241
    v_fma_f32 v243, v159, v242, v243
    v_fma_f32 v159, -v143, v242, v241
    v_mov_b32 v143, v243
    v_cvt_pk_bf16_f32 v192, v128, v129
    v_cvt_pk_bf16_f32 v208, v144, v145
    v_xor_b32 v224, 0x80008000, v192
    v_cvt_pk_bf16_f32 v193, v130, v131
    v_cvt_pk_bf16_f32 v209, v146, v147
    v_xor_b32 v225, 0x80008000, v193
    v_cvt_pk_bf16_f32 v194, v132, v133
    v_cvt_pk_bf16_f32 v210, v148, v149
    v_xor_b32 v226, 0x80008000, v194
    v_cvt_pk_bf16_f32 v195, v134, v135
    v_cvt_pk_bf16_f32 v211, v150, v151
    v_xor_b32 v227, 0x80008000, v195
    v_cvt_pk_bf16_f32 v196, v136, v137
    v_cvt_pk_bf16_f32 v212, v152, v153
    v_xor_b32 v228, 0x80008000, v196
    v_cvt_pk_bf16_f32 v197, v138, v139
    v_cvt_pk_bf16_f32 v213, v154, v155
    v_xor_b32 v229, 0x80008000, v197
    v_cvt_pk_bf16_f32 v198, v140, v141
    v_cvt_pk_bf16_f32 v214, v156, v157
    v_xor_b32 v230, 0x80008000, v198
    v_cvt_pk_bf16_f32 v199, v142, v143
    v_cvt_pk_bf16_f32 v215, v158, v159
    v_xor_b32 v231, 0x80008000, v199
    v_add_f32 v240, 1107296256, v4
    v_mul_f32 v240, v240, v3
    v_cos_f32 v241, v240
    v_sin_f32 v242, v240
    v_mul_f32 v243, v160, v241
    v_mul_f32 v241, v176, v241
    v_fma_f32 v243, v176, v242, v243
    v_fma_f32 v176, -v160, v242, v241
    v_mov_b32 v160, v243
    v_add_f32 v240, 1107558400, v4
    v_mul_f32 v240, v240, v3
    v_cos_f32 v241, v240
    v_sin_f32 v242, v240
    v_mul_f32 v243, v161, v241
    v_mul_f32 v241, v177, v241
    v_fma_f32 v243, v177, v242, v243
    v_fma_f32 v177, -v161, v242, v241
    v_mov_b32 v161, v243
    v_add_f32 v240, 1107820544, v4
    v_mul_f32 v240, v240, v3
    v_cos_f32 v241, v240
    v_sin_f32 v242, v240
    v_mul_f32 v243, v162, v241
    v_mul_f32 v241, v178, v241
    v_fma_f32 v243, v178, v242, v243
    v_fma_f32 v178, -v162, v242, v241
    v_mov_b32 v162, v243
    v_add_f32 v240, 1108082688, v4
    v_mul_f32 v240, v240, v3
    v_cos_f32 v241, v240
    v_sin_f32 v242, v240
    v_mul_f32 v243, v163, v241
    v_mul_f32 v241, v179, v241
    v_fma_f32 v243, v179, v242, v243
    v_fma_f32 v179, -v163, v242, v241
    v_mov_b32 v163, v243
    v_add_f32 v240, 1109393408, v4
    v_mul_f32 v240, v240, v3
    v_cos_f32 v241, v240
    v_sin_f32 v242, v240
    v_mul_f32 v243, v164, v241
    v_mul_f32 v241, v180, v241
    v_fma_f32 v243, v180, v242, v243
    v_fma_f32 v180, -v164, v242, v241
    v_mov_b32 v164, v243
    v_add_f32 v240, 1109655552, v4
    v_mul_f32 v240, v240, v3
    v_cos_f32 v241, v240
    v_sin_f32 v242, v240
    v_mul_f32 v243, v165, v241
    v_mul_f32 v241, v181, v241
    v_fma_f32 v243, v181, v242, v243
    v_fma_f32 v181, -v165, v242, v241
    v_mov_b32 v165, v243
    v_add_f32 v240, 1109917696, v4
    v_mul_f32 v240, v240, v3
    v_cos_f32 v241, v240
    v_sin_f32 v242, v240
    v_mul_f32 v243, v166, v241
    v_mul_f32 v241, v182, v241
    v_fma_f32 v243, v182, v242, v243
    v_fma_f32 v182, -v166, v242, v241
    v_mov_b32 v166, v243
    v_add_f32 v240, 1110179840, v4
    v_mul_f32 v240, v240, v3
    v_cos_f32 v241, v240
    v_sin_f32 v242, v240
    v_mul_f32 v243, v167, v241
    v_mul_f32 v241, v183, v241
    v_fma_f32 v243, v183, v242, v243
    v_fma_f32 v183, -v167, v242, v241
    v_mov_b32 v167, v243
    v_add_f32 v240, 1111490560, v4
    v_mul_f32 v240, v240, v3
    v_cos_f32 v241, v240
    v_sin_f32 v242, v240
    v_mul_f32 v243, v168, v241
    v_mul_f32 v241, v184, v241
    v_fma_f32 v243, v184, v242, v243
    v_fma_f32 v184, -v168, v242, v241
    v_mov_b32 v168, v243
    v_add_f32 v240, 1111752704, v4
    v_mul_f32 v240, v240, v3
    v_cos_f32 v241, v240
    v_sin_f32 v242, v240
    v_mul_f32 v243, v169, v241
    v_mul_f32 v241, v185, v241
    v_fma_f32 v243, v185, v242, v243
    v_fma_f32 v185, -v169, v242, v241
    v_mov_b32 v169, v243
    v_add_f32 v240, 1112014848, v4
    v_mul_f32 v240, v240, v3
    v_cos_f32 v241, v240
    v_sin_f32 v242, v240
    v_mul_f32 v243, v170, v241
    v_mul_f32 v241, v186, v241
    v_fma_f32 v243, v186, v242, v243
    v_fma_f32 v186, -v170, v242, v241
    v_mov_b32 v170, v243
    v_add_f32 v240, 1112276992, v4
    v_mul_f32 v240, v240, v3
    v_cos_f32 v241, v240
    v_sin_f32 v242, v240
    v_mul_f32 v243, v171, v241
    v_mul_f32 v241, v187, v241
    v_fma_f32 v243, v187, v242, v243
    v_fma_f32 v187, -v171, v242, v241
    v_mov_b32 v171, v243
    v_add_f32 v240, 1113587712, v4
    v_mul_f32 v240, v240, v3
    v_cos_f32 v241, v240
    v_sin_f32 v242, v240
    v_mul_f32 v243, v172, v241
    v_mul_f32 v241, v188, v241
    v_fma_f32 v243, v188, v242, v243
    v_fma_f32 v188, -v172, v242, v241
    v_mov_b32 v172, v243
    v_add_f32 v240, 1113849856, v4
    v_mul_f32 v240, v240, v3
    v_cos_f32 v241, v240
    v_sin_f32 v242, v240
    v_mul_f32 v243, v173, v241
    v_mul_f32 v241, v189, v241
    v_fma_f32 v243, v189, v242, v243
    v_fma_f32 v189, -v173, v242, v241
    v_mov_b32 v173, v243
    v_add_f32 v240, 1114112000, v4
    v_mul_f32 v240, v240, v3
    v_cos_f32 v241, v240
    v_sin_f32 v242, v240
    v_mul_f32 v243, v174, v241
    v_mul_f32 v241, v190, v241
    v_fma_f32 v243, v190, v242, v243
    v_fma_f32 v190, -v174, v242, v241
    v_mov_b32 v174, v243
    v_add_f32 v240, 1114374144, v4
    v_mul_f32 v240, v240, v3
    v_cos_f32 v241, v240
    v_sin_f32 v242, v240
    v_mul_f32 v243, v175, v241
    v_mul_f32 v241, v191, v241
    v_fma_f32 v243, v191, v242, v243
    v_fma_f32 v191, -v175, v242, v241
    v_mov_b32 v175, v243
    v_cvt_pk_bf16_f32 v200, v160, v161
    v_cvt_pk_bf16_f32 v216, v176, v177
    v_xor_b32 v232, 0x80008000, v200
    v_cvt_pk_bf16_f32 v201, v162, v163
    v_cvt_pk_bf16_f32 v217, v178, v179
    v_xor_b32 v233, 0x80008000, v201
    v_cvt_pk_bf16_f32 v202, v164, v165
    v_cvt_pk_bf16_f32 v218, v180, v181
    v_xor_b32 v234, 0x80008000, v202
    v_cvt_pk_bf16_f32 v203, v166, v167
    v_cvt_pk_bf16_f32 v219, v182, v183
    v_xor_b32 v235, 0x80008000, v203
    v_cvt_pk_bf16_f32 v204, v168, v169
    v_cvt_pk_bf16_f32 v220, v184, v185
    v_xor_b32 v236, 0x80008000, v204
    v_cvt_pk_bf16_f32 v205, v170, v171
    v_cvt_pk_bf16_f32 v221, v186, v187
    v_xor_b32 v237, 0x80008000, v205
    v_cvt_pk_bf16_f32 v206, v172, v173
    v_cvt_pk_bf16_f32 v222, v188, v189
    v_xor_b32 v238, 0x80008000, v206
    v_cvt_pk_bf16_f32 v207, v174, v175
    v_cvt_pk_bf16_f32 v223, v190, v191
    v_xor_b32 v239, 0x80008000, v207
    s_nop 1
    v_mfma_f32_32x32x16_bf16 v[128:143], v[32:35], v[192:195], 0
    v_mfma_f32_32x32x16_bf16 v[128:143], v[36:39], v[196:199], v[128:143]
    v_mfma_f32_32x32x16_bf16 v[128:143], v[40:43], v[200:203], v[128:143]
    v_mfma_f32_32x32x16_bf16 v[128:143], v[44:47], v[204:207], v[128:143]
    v_mfma_f32_32x32x16_bf16 v[128:143], v[64:67], v[208:211], v[128:143]
    v_mfma_f32_32x32x16_bf16 v[128:143], v[68:71], v[212:215], v[128:143]
    v_mfma_f32_32x32x16_bf16 v[128:143], v[72:75], v[216:219], v[128:143]
    v_mfma_f32_32x32x16_bf16 v[128:143], v[76:79], v[220:223], v[128:143]
    v_mfma_f32_32x32x16_bf16 v[144:159], v[32:35], v[208:211], 0
    v_mfma_f32_32x32x16_bf16 v[144:159], v[36:39], v[212:215], v[144:159]
    v_mfma_f32_32x32x16_bf16 v[144:159], v[40:43], v[216:219], v[144:159]
    v_mfma_f32_32x32x16_bf16 v[144:159], v[44:47], v[220:223], v[144:159]
    v_mfma_f32_32x32x16_bf16 v[144:159], v[64:67], v[224:227], v[144:159]
    v_mfma_f32_32x32x16_bf16 v[144:159], v[68:71], v[228:231], v[144:159]
    v_mfma_f32_32x32x16_bf16 v[144:159], v[72:75], v[232:235], v[144:159]
    v_mfma_f32_32x32x16_bf16 v[144:159], v[76:79], v[236:239], v[144:159]
    v_mfma_f32_32x32x16_bf16 v[160:175], v[48:51], v[192:195], 0
    v_mfma_f32_32x32x16_bf16 v[160:175], v[52:55], v[196:199], v[160:175]
    v_mfma_f32_32x32x16_bf16 v[160:175], v[56:59], v[200:203], v[160:175]
    v_mfma_f32_32x32x16_bf16 v[160:175], v[60:63], v[204:207], v[160:175]
    v_mfma_f32_32x32x16_bf16 v[160:175], v[80:83], v[208:211], v[160:175]
    v_mfma_f32_32x32x16_bf16 v[160:175], v[84:87], v[212:215], v[160:175]
    v_mfma_f32_32x32x16_bf16 v[160:175], v[88:91], v[216:219], v[160:175]
    v_mfma_f32_32x32x16_bf16 v[160:175], v[92:95], v[220:223], v[160:175]
    v_mfma_f32_32x32x16_bf16 v[176:191], v[48:51], v[208:211], 0
    v_mfma_f32_32x32x16_bf16 v[176:191], v[52:55], v[212:215], v[176:191]
    v_mfma_f32_32x32x16_bf16 v[176:191], v[56:59], v[216:219], v[176:191]
    v_mfma_f32_32x32x16_bf16 v[176:191], v[60:63], v[220:223], v[176:191]
    v_mfma_f32_32x32x16_bf16 v[176:191], v[80:83], v[224:227], v[176:191]
    v_mfma_f32_32x32x16_bf16 v[176:191], v[84:87], v[228:231], v[176:191]
    v_mfma_f32_32x32x16_bf16 v[176:191], v[88:91], v[232:235], v[176:191]
    v_mfma_f32_32x32x16_bf16 v[176:191], v[92:95], v[236:239], v[176:191]
    s_waitcnt vmcnt(0)
    s_nop 10
    v_lshlrev_b32 v241, 16, v96
    v_and_b32 v242, 0xffff0000, v96
    v_mul_f32 v241, s64, v241
    v_mul_f32 v242, s64, v242
    v_mul_f32 v243, v128, v241
    v_mul_f32 v241, v144, v241
    v_fma_f32 v243, -v144, v242, v243
    v_fma_f32 v144, v128, v242, v241
    v_mov_b32 v128, v243
    v_lshlrev_b32 v241, 16, v97
    v_and_b32 v242, 0xffff0000, v97
    v_mul_f32 v241, s64, v241
    v_mul_f32 v242, s64, v242
    v_mul_f32 v243, v129, v241
    v_mul_f32 v241, v145, v241
    v_fma_f32 v243, -v145, v242, v243
    v_fma_f32 v145, v129, v242, v241
    v_mov_b32 v129, v243
    v_lshlrev_b32 v241, 16, v98
    v_and_b32 v242, 0xffff0000, v98
    v_mul_f32 v241, s64, v241
    v_mul_f32 v242, s64, v242
    v_mul_f32 v243, v130, v241
    v_mul_f32 v241, v146, v241
    v_fma_f32 v243, -v146, v242, v243
    v_fma_f32 v146, v130, v242, v241
    v_mov_b32 v130, v243
    v_lshlrev_b32 v241, 16, v99
    v_and_b32 v242, 0xffff0000, v99
    v_mul_f32 v241, s64, v241
    v_mul_f32 v242, s64, v242
    v_mul_f32 v243, v131, v241
    v_mul_f32 v241, v147, v241
    v_fma_f32 v243, -v147, v242, v243
    v_fma_f32 v147, v131, v242, v241
    v_mov_b32 v131, v243
    v_lshlrev_b32 v241, 16, v100
    v_and_b32 v242, 0xffff0000, v100
    v_mul_f32 v241, s64, v241
    v_mul_f32 v242, s64, v242
    v_mul_f32 v243, v132, v241
    v_mul_f32 v241, v148, v241
    v_fma_f32 v243, -v148, v242, v243
    v_fma_f32 v148, v132, v242, v241
    v_mov_b32 v132, v243
    v_lshlrev_b32 v241, 16, v101
    v_and_b32 v242, 0xffff0000, v101
    v_mul_f32 v241, s64, v241
    v_mul_f32 v242, s64, v242
    v_mul_f32 v243, v133, v241
    v_mul_f32 v241, v149, v241
    v_fma_f32 v243, -v149, v242, v243
    v_fma_f32 v149, v133, v242, v241
    v_mov_b32 v133, v243
    v_lshlrev_b32 v241, 16, v102
    v_and_b32 v242, 0xffff0000, v102
    v_mul_f32 v241, s64, v241
    v_mul_f32 v242, s64, v242
    v_mul_f32 v243, v134, v241
    v_mul_f32 v241, v150, v241
    v_fma_f32 v243, -v150, v242, v243
    v_fma_f32 v150, v134, v242, v241
    v_mov_b32 v134, v243
    v_lshlrev_b32 v241, 16, v103
    v_and_b32 v242, 0xffff0000, v103
    v_mul_f32 v241, s64, v241
    v_mul_f32 v242, s64, v242
    v_mul_f32 v243, v135, v241
    v_mul_f32 v241, v151, v241
    v_fma_f32 v243, -v151, v242, v243
    v_fma_f32 v151, v135, v242, v241
    v_mov_b32 v135, v243
    v_lshlrev_b32 v241, 16, v104
    v_and_b32 v242, 0xffff0000, v104
    v_mul_f32 v241, s64, v241
    v_mul_f32 v242, s64, v242
    v_mul_f32 v243, v136, v241
    v_mul_f32 v241, v152, v241
    v_fma_f32 v243, -v152, v242, v243
    v_fma_f32 v152, v136, v242, v241
    v_mov_b32 v136, v243
    v_lshlrev_b32 v241, 16, v105
    v_and_b32 v242, 0xffff0000, v105
    v_mul_f32 v241, s64, v241
    v_mul_f32 v242, s64, v242
    v_mul_f32 v243, v137, v241
    v_mul_f32 v241, v153, v241
    v_fma_f32 v243, -v153, v242, v243
    v_fma_f32 v153, v137, v242, v241
    v_mov_b32 v137, v243
    v_lshlrev_b32 v241, 16, v106
    v_and_b32 v242, 0xffff0000, v106
    v_mul_f32 v241, s64, v241
    v_mul_f32 v242, s64, v242
    v_mul_f32 v243, v138, v241
    v_mul_f32 v241, v154, v241
    v_fma_f32 v243, -v154, v242, v243
    v_fma_f32 v154, v138, v242, v241
    v_mov_b32 v138, v243
    v_lshlrev_b32 v241, 16, v107
    v_and_b32 v242, 0xffff0000, v107
    v_mul_f32 v241, s64, v241
    v_mul_f32 v242, s64, v242
    v_mul_f32 v243, v139, v241
    v_mul_f32 v241, v155, v241
    v_fma_f32 v243, -v155, v242, v243
    v_fma_f32 v155, v139, v242, v241
    v_mov_b32 v139, v243
    v_lshlrev_b32 v241, 16, v108
    v_and_b32 v242, 0xffff0000, v108
    v_mul_f32 v241, s64, v241
    v_mul_f32 v242, s64, v242
    v_mul_f32 v243, v140, v241
    v_mul_f32 v241, v156, v241
    v_fma_f32 v243, -v156, v242, v243
    v_fma_f32 v156, v140, v242, v241
    v_mov_b32 v140, v243
    v_lshlrev_b32 v241, 16, v109
    v_and_b32 v242, 0xffff0000, v109
    v_mul_f32 v241, s64, v241
    v_mul_f32 v242, s64, v242
    v_mul_f32 v243, v141, v241
    v_mul_f32 v241, v157, v241
    v_fma_f32 v243, -v157, v242, v243
    v_fma_f32 v157, v141, v242, v241
    v_mov_b32 v141, v243
    v_lshlrev_b32 v241, 16, v110
    v_and_b32 v242, 0xffff0000, v110
    v_mul_f32 v241, s64, v241
    v_mul_f32 v242, s64, v242
    v_mul_f32 v243, v142, v241
    v_mul_f32 v241, v158, v241
    v_fma_f32 v243, -v158, v242, v243
    v_fma_f32 v158, v142, v242, v241
    v_mov_b32 v142, v243
    v_lshlrev_b32 v241, 16, v111
    v_and_b32 v242, 0xffff0000, v111
    v_mul_f32 v241, s64, v241
    v_mul_f32 v242, s64, v242
    v_mul_f32 v243, v143, v241
    v_mul_f32 v241, v159, v241
    v_fma_f32 v243, -v159, v242, v243
    v_fma_f32 v159, v143, v242, v241
    v_mov_b32 v143, v243
    v_cvt_pk_bf16_f32 v192, v128, v129
    v_cvt_pk_bf16_f32 v208, v144, v145
    v_xor_b32 v224, 0x80008000, v208
    v_cvt_pk_bf16_f32 v193, v130, v131
    v_cvt_pk_bf16_f32 v209, v146, v147
    v_xor_b32 v225, 0x80008000, v209
    v_cvt_pk_bf16_f32 v194, v132, v133
    v_cvt_pk_bf16_f32 v210, v148, v149
    v_xor_b32 v226, 0x80008000, v210
    v_cvt_pk_bf16_f32 v195, v134, v135
    v_cvt_pk_bf16_f32 v211, v150, v151
    v_xor_b32 v227, 0x80008000, v211
    v_cvt_pk_bf16_f32 v196, v136, v137
    v_cvt_pk_bf16_f32 v212, v152, v153
    v_xor_b32 v228, 0x80008000, v212
    v_cvt_pk_bf16_f32 v197, v138, v139
    v_cvt_pk_bf16_f32 v213, v154, v155
    v_xor_b32 v229, 0x80008000, v213
    v_cvt_pk_bf16_f32 v198, v140, v141
    v_cvt_pk_bf16_f32 v214, v156, v157
    v_xor_b32 v230, 0x80008000, v214
    v_cvt_pk_bf16_f32 v199, v142, v143
    v_cvt_pk_bf16_f32 v215, v158, v159
    v_xor_b32 v231, 0x80008000, v215
    v_lshlrev_b32 v241, 16, v112
    v_and_b32 v242, 0xffff0000, v112
    v_mul_f32 v241, s64, v241
    v_mul_f32 v242, s64, v242
    v_mul_f32 v243, v160, v241
    v_mul_f32 v241, v176, v241
    v_fma_f32 v243, -v176, v242, v243
    v_fma_f32 v176, v160, v242, v241
    v_mov_b32 v160, v243
    v_lshlrev_b32 v241, 16, v113
    v_and_b32 v242, 0xffff0000, v113
    v_mul_f32 v241, s64, v241
    v_mul_f32 v242, s64, v242
    v_mul_f32 v243, v161, v241
    v_mul_f32 v241, v177, v241
    v_fma_f32 v243, -v177, v242, v243
    v_fma_f32 v177, v161, v242, v241
    v_mov_b32 v161, v243
    v_lshlrev_b32 v241, 16, v114
    v_and_b32 v242, 0xffff0000, v114
    v_mul_f32 v241, s64, v241
    v_mul_f32 v242, s64, v242
    v_mul_f32 v243, v162, v241
    v_mul_f32 v241, v178, v241
    v_fma_f32 v243, -v178, v242, v243
    v_fma_f32 v178, v162, v242, v241
    v_mov_b32 v162, v243
    v_lshlrev_b32 v241, 16, v115
    v_and_b32 v242, 0xffff0000, v115
    v_mul_f32 v241, s64, v241
    v_mul_f32 v242, s64, v242
    v_mul_f32 v243, v163, v241
    v_mul_f32 v241, v179, v241
    v_fma_f32 v243, -v179, v242, v243
    v_fma_f32 v179, v163, v242, v241
    v_mov_b32 v163, v243
    v_lshlrev_b32 v241, 16, v116
    v_and_b32 v242, 0xffff0000, v116
    v_mul_f32 v241, s64, v241
    v_mul_f32 v242, s64, v242
    v_mul_f32 v243, v164, v241
    v_mul_f32 v241, v180, v241
    v_fma_f32 v243, -v180, v242, v243
    v_fma_f32 v180, v164, v242, v241
    v_mov_b32 v164, v243
    v_lshlrev_b32 v241, 16, v117
    v_and_b32 v242, 0xffff0000, v117
    v_mul_f32 v241, s64, v241
    v_mul_f32 v242, s64, v242
    v_mul_f32 v243, v165, v241
    v_mul_f32 v241, v181, v241
    v_fma_f32 v243, -v181, v242, v243
    v_fma_f32 v181, v165, v242, v241
    v_mov_b32 v165, v243
    v_lshlrev_b32 v241, 16, v118
    v_and_b32 v242, 0xffff0000, v118
    v_mul_f32 v241, s64, v241
    v_mul_f32 v242, s64, v242
    v_mul_f32 v243, v166, v241
    v_mul_f32 v241, v182, v241
    v_fma_f32 v243, -v182, v242, v243
    v_fma_f32 v182, v166, v242, v241
    v_mov_b32 v166, v243
    v_lshlrev_b32 v241, 16, v119
    v_and_b32 v242, 0xffff0000, v119
    v_mul_f32 v241, s64, v241
    v_mul_f32 v242, s64, v242
    v_mul_f32 v243, v167, v241
    v_mul_f32 v241, v183, v241
    v_fma_f32 v243, -v183, v242, v243
    v_fma_f32 v183, v167, v242, v241
    v_mov_b32 v167, v243
    v_lshlrev_b32 v241, 16, v120
    v_and_b32 v242, 0xffff0000, v120
    v_mul_f32 v241, s64, v241
    v_mul_f32 v242, s64, v242
    v_mul_f32 v243, v168, v241
    v_mul_f32 v241, v184, v241
    v_fma_f32 v243, -v184, v242, v243
    v_fma_f32 v184, v168, v242, v241
    v_mov_b32 v168, v243
    v_lshlrev_b32 v241, 16, v121
    v_and_b32 v242, 0xffff0000, v121
    v_mul_f32 v241, s64, v241
    v_mul_f32 v242, s64, v242
    v_mul_f32 v243, v169, v241
    v_mul_f32 v241, v185, v241
    v_fma_f32 v243, -v185, v242, v243
    v_fma_f32 v185, v169, v242, v241
    v_mov_b32 v169, v243
    v_lshlrev_b32 v241, 16, v122
    v_and_b32 v242, 0xffff0000, v122
    v_mul_f32 v241, s64, v241
    v_mul_f32 v242, s64, v242
    v_mul_f32 v243, v170, v241
    v_mul_f32 v241, v186, v241
    v_fma_f32 v243, -v186, v242, v243
    v_fma_f32 v186, v170, v242, v241
    v_mov_b32 v170, v243
    v_lshlrev_b32 v241, 16, v123
    v_and_b32 v242, 0xffff0000, v123
    v_mul_f32 v241, s64, v241
    v_mul_f32 v242, s64, v242
    v_mul_f32 v243, v171, v241
    v_mul_f32 v241, v187, v241
    v_fma_f32 v243, -v187, v242, v243
    v_fma_f32 v187, v171, v242, v241
    v_mov_b32 v171, v243
    v_lshlrev_b32 v241, 16, v124
    v_and_b32 v242, 0xffff0000, v124
    v_mul_f32 v241, s64, v241
    v_mul_f32 v242, s64, v242
    v_mul_f32 v243, v172, v241
    v_mul_f32 v241, v188, v241
    v_fma_f32 v243, -v188, v242, v243
    v_fma_f32 v188, v172, v242, v241
    v_mov_b32 v172, v243
    v_lshlrev_b32 v241, 16, v125
    v_and_b32 v242, 0xffff0000, v125
    v_mul_f32 v241, s64, v241
    v_mul_f32 v242, s64, v242
    v_mul_f32 v243, v173, v241
    v_mul_f32 v241, v189, v241
    v_fma_f32 v243, -v189, v242, v243
    v_fma_f32 v189, v173, v242, v241
    v_mov_b32 v173, v243
    v_lshlrev_b32 v241, 16, v126
    v_and_b32 v242, 0xffff0000, v126
    v_mul_f32 v241, s64, v241
    v_mul_f32 v242, s64, v242
    v_mul_f32 v243, v174, v241
    v_mul_f32 v241, v190, v241
    v_fma_f32 v243, -v190, v242, v243
    v_fma_f32 v190, v174, v242, v241
    v_mov_b32 v174, v243
    v_lshlrev_b32 v241, 16, v127
    v_and_b32 v242, 0xffff0000, v127
    v_mul_f32 v241, s64, v241
    v_mul_f32 v242, s64, v242
    v_mul_f32 v243, v175, v241
    v_mul_f32 v241, v191, v241
    v_fma_f32 v243, -v191, v242, v243
    v_fma_f32 v191, v175, v242, v241
    v_mov_b32 v175, v243
    v_cvt_pk_bf16_f32 v200, v160, v161
    v_cvt_pk_bf16_f32 v216, v176, v177
    v_xor_b32 v232, 0x80008000, v216
    v_cvt_pk_bf16_f32 v201, v162, v163
    v_cvt_pk_bf16_f32 v217, v178, v179
    v_xor_b32 v233, 0x80008000, v217
    v_cvt_pk_bf16_f32 v202, v164, v165
    v_cvt_pk_bf16_f32 v218, v180, v181
    v_xor_b32 v234, 0x80008000, v218
    v_cvt_pk_bf16_f32 v203, v166, v167
    v_cvt_pk_bf16_f32 v219, v182, v183
    v_xor_b32 v235, 0x80008000, v219
    v_cvt_pk_bf16_f32 v204, v168, v169
    v_cvt_pk_bf16_f32 v220, v184, v185
    v_xor_b32 v236, 0x80008000, v220
    v_cvt_pk_bf16_f32 v205, v170, v171
    v_cvt_pk_bf16_f32 v221, v186, v187
    v_xor_b32 v237, 0x80008000, v221
    v_cvt_pk_bf16_f32 v206, v172, v173
    v_cvt_pk_bf16_f32 v222, v188, v189
    v_xor_b32 v238, 0x80008000, v222
    v_cvt_pk_bf16_f32 v207, v174, v175
    v_cvt_pk_bf16_f32 v223, v190, v191
    v_xor_b32 v239, 0x80008000, v223
    s_nop 1
    v_mfma_f32_32x32x16_bf16 v[128:143], v[192:195], v[32:35], 0
    v_mfma_f32_32x32x16_bf16 v[128:143], v[196:199], v[36:39], v[128:143]
    v_mfma_f32_32x32x16_bf16 v[128:143], v[200:203], v[40:43], v[128:143]
    v_mfma_f32_32x32x16_bf16 v[128:143], v[204:207], v[44:47], v[128:143]
    v_mfma_f32_32x32x16_bf16 v[128:143], v[224:227], v[64:67], v[128:143]
    v_mfma_f32_32x32x16_bf16 v[128:143], v[228:231], v[68:71], v[128:143]
    v_mfma_f32_32x32x16_bf16 v[128:143], v[232:235], v[72:75], v[128:143]
    v_mfma_f32_32x32x16_bf16 v[128:143], v[236:239], v[76:79], v[128:143]
    v_mfma_f32_32x32x16_bf16 v[144:159], v[208:211], v[32:35], 0
    v_mfma_f32_32x32x16_bf16 v[144:159], v[212:215], v[36:39], v[144:159]
    v_mfma_f32_32x32x16_bf16 v[144:159], v[216:219], v[40:43], v[144:159]
    v_mfma_f32_32x32x16_bf16 v[144:159], v[220:223], v[44:47], v[144:159]
    v_mfma_f32_32x32x16_bf16 v[144:159], v[192:195], v[64:67], v[144:159]
    v_mfma_f32_32x32x16_bf16 v[144:159], v[196:199], v[68:71], v[144:159]
    v_mfma_f32_32x32x16_bf16 v[144:159], v[200:203], v[72:75], v[144:159]
    v_mfma_f32_32x32x16_bf16 v[144:159], v[204:207], v[76:79], v[144:159]
    v_mfma_f32_32x32x16_bf16 v[160:175], v[192:195], v[48:51], 0
    v_mfma_f32_32x32x16_bf16 v[160:175], v[196:199], v[52:55], v[160:175]
    v_mfma_f32_32x32x16_bf16 v[160:175], v[200:203], v[56:59], v[160:175]
    v_mfma_f32_32x32x16_bf16 v[160:175], v[204:207], v[60:63], v[160:175]
    v_mfma_f32_32x32x16_bf16 v[160:175], v[224:227], v[80:83], v[160:175]
    v_mfma_f32_32x32x16_bf16 v[160:175], v[228:231], v[84:87], v[160:175]
    v_mfma_f32_32x32x16_bf16 v[160:175], v[232:235], v[88:91], v[160:175]
    v_mfma_f32_32x32x16_bf16 v[160:175], v[236:239], v[92:95], v[160:175]
    v_mfma_f32_32x32x16_bf16 v[176:191], v[208:211], v[48:51], 0
    v_mfma_f32_32x32x16_bf16 v[176:191], v[212:215], v[52:55], v[176:191]
    v_mfma_f32_32x32x16_bf16 v[176:191], v[216:219], v[56:59], v[176:191]
    v_mfma_f32_32x32x16_bf16 v[176:191], v[220:223], v[60:63], v[176:191]
    v_mfma_f32_32x32x16_bf16 v[176:191], v[192:195], v[80:83], v[176:191]
    v_mfma_f32_32x32x16_bf16 v[176:191], v[196:199], v[84:87], v[176:191]
    v_mfma_f32_32x32x16_bf16 v[176:191], v[200:203], v[88:91], v[176:191]
    v_mfma_f32_32x32x16_bf16 v[176:191], v[204:207], v[92:95], v[176:191]
    s_nop 7
    s_nop 3
    v_add_f32 v240, 0, v4
    v_mul_f32 v240, v240, v3
    v_cos_f32 v241, v240
    v_sin_f32 v242, v240
    v_mul_f32 v243, v128, v241
    v_mul_f32 v241, v144, v241
    v_fma_f32 v243, -v144, v242, v243
    v_fma_f32 v144, v128, v242, v241
    v_mov_b32 v128, v243
    v_add_f32 v240, 1065353216, v4
    v_mul_f32 v240, v240, v3
    v_cos_f32 v241, v240
    v_sin_f32 v242, v240
    v_mul_f32 v243, v129, v241
    v_mul_f32 v241, v145, v241
    v_fma_f32 v243, -v145, v242, v243
    v_fma_f32 v145, v129, v242, v241
    v_mov_b32 v129, v243
    v_add_f32 v240, 1073741824, v4
    v_mul_f32 v240, v240, v3
    v_cos_f32 v241, v240
    v_sin_f32 v242, v240
    v_mul_f32 v243, v130, v241
    v_mul_f32 v241, v146, v241
    v_fma_f32 v243, -v146, v242, v243
    v_fma_f32 v146, v130, v242, v241
    v_mov_b32 v130, v243
    v_add_f32 v240, 1077936128, v4
    v_mul_f32 v240, v240, v3
    v_cos_f32 v241, v240
    v_sin_f32 v242, v240
    v_mul_f32 v243, v131, v241
    v_mul_f32 v241, v147, v241
    v_fma_f32 v243, -v147, v242, v243
    v_fma_f32 v147, v131, v242, v241
    v_mov_b32 v131, v243
    v_add_f32 v240, 1090519040, v4
    v_mul_f32 v240, v240, v3
    v_cos_f32 v241, v240
    v_sin_f32 v242, v240
    v_mul_f32 v243, v132, v241
    v_mul_f32 v241, v148, v241
    v_fma_f32 v243, -v148, v242, v243
    v_fma_f32 v148, v132, v242, v241
    v_mov_b32 v132, v243
    v_add_f32 v240, 1091567616, v4
    v_mul_f32 v240, v240, v3
    v_cos_f32 v241, v240
    v_sin_f32 v242, v240
    v_mul_f32 v243, v133, v241
    v_mul_f32 v241, v149, v241
    v_fma_f32 v243, -v149, v242, v243
    v_fma_f32 v149, v133, v242, v241
    v_mov_b32 v133, v243
    v_add_f32 v240, 1092616192, v4
    v_mul_f32 v240, v240, v3
    v_cos_f32 v241, v240
    v_sin_f32 v242, v240
    v_mul_f32 v243, v134, v241
    v_mul_f32 v241, v150, v241
    v_fma_f32 v243, -v150, v242, v243
    v_fma_f32 v150, v134, v242, v241
    v_mov_b32 v134, v243
    v_add_f32 v240, 1093664768, v4
    v_mul_f32 v240, v240, v3
    v_cos_f32 v241, v240
    v_sin_f32 v242, v240
    v_mul_f32 v243, v135, v241
    v_mul_f32 v241, v151, v241
    v_fma_f32 v243, -v151, v242, v243
    v_fma_f32 v151, v135, v242, v241
    v_mov_b32 v135, v243
    v_add_f32 v240, 1098907648, v4
    v_mul_f32 v240, v240, v3
    v_cos_f32 v241, v240
    v_sin_f32 v242, v240
    v_mul_f32 v243, v136, v241
    v_mul_f32 v241, v152, v241
    v_fma_f32 v243, -v152, v242, v243
    v_fma_f32 v152, v136, v242, v241
    v_mov_b32 v136, v243
    v_add_f32 v240, 1099431936, v4
    v_mul_f32 v240, v240, v3
    v_cos_f32 v241, v240
    v_sin_f32 v242, v240
    v_mul_f32 v243, v137, v241
    v_mul_f32 v241, v153, v241
    v_fma_f32 v243, -v153, v242, v243
    v_fma_f32 v153, v137, v242, v241
    v_mov_b32 v137, v243
    v_add_f32 v240, 1099956224, v4
    v_mul_f32 v240, v240, v3
    v_cos_f32 v241, v240
    v_sin_f32 v242, v240
    v_mul_f32 v243, v138, v241
    v_mul_f32 v241, v154, v241
    v_fma_f32 v243, -v154, v242, v243
    v_fma_f32 v154, v138, v242, v241
    v_mov_b32 v138, v243
    v_add_f32 v240, 1100480512, v4
    v_mul_f32 v240, v240, v3
    v_cos_f32 v241, v240
    v_sin_f32 v242, v240
    v_mul_f32 v243, v139, v241
    v_mul_f32 v241, v155, v241
    v_fma_f32 v243, -v155, v242, v243
    v_fma_f32 v155, v139, v242, v241
    v_mov_b32 v139, v243
    v_add_f32 v240, 1103101952, v4
    v_mul_f32 v240, v240, v3
    v_cos_f32 v241, v240
    v_sin_f32 v242, v240
    v_mul_f32 v243, v140, v241
    v_mul_f32 v241, v156, v241
    v_fma_f32 v243, -v156, v242, v243
    v_fma_f32 v156, v140, v242, v241
    v_mov_b32 v140, v243
    v_add_f32 v240, 1103626240, v4
    v_mul_f32 v240, v240, v3
    v_cos_f32 v241, v240
    v_sin_f32 v242, v240
    v_mul_f32 v243, v141, v241
    v_mul_f32 v241, v157, v241
    v_fma_f32 v243, -v157, v242, v243
    v_fma_f32 v157, v141, v242, v241
    v_mov_b32 v141, v243
    v_add_f32 v240, 1104150528, v4
    v_mul_f32 v240, v240, v3
    v_cos_f32 v241, v240
    v_sin_f32 v242, v240
    v_mul_f32 v243, v142, v241
    v_mul_f32 v241, v158, v241
    v_fma_f32 v243, -v158, v242, v243
    v_fma_f32 v158, v142, v242, v241
    v_mov_b32 v142, v243
    v_add_f32 v240, 1104674816, v4
    v_mul_f32 v240, v240, v3
    v_cos_f32 v241, v240
    v_sin_f32 v242, v240
    v_mul_f32 v243, v143, v241
    v_mul_f32 v241, v159, v241
    v_fma_f32 v243, -v159, v242, v243
    v_fma_f32 v159, v143, v242, v241
    v_mov_b32 v143, v243
    v_cvt_pk_bf16_f32 v192, v128, v129
    v_cvt_pk_bf16_f32 v208, v144, v145
    v_cvt_pk_bf16_f32 v193, v130, v131
    v_cvt_pk_bf16_f32 v209, v146, v147
    v_cvt_pk_bf16_f32 v194, v132, v133
    v_cvt_pk_bf16_f32 v210, v148, v149
    v_cvt_pk_bf16_f32 v195, v134, v135
    v_cvt_pk_bf16_f32 v211, v150, v151
    v_cvt_pk_bf16_f32 v196, v136, v137
    v_cvt_pk_bf16_f32 v212, v152, v153
    v_cvt_pk_bf16_f32 v197, v138, v139
    v_cvt_pk_bf16_f32 v213, v154, v155
    v_cvt_pk_bf16_f32 v198, v140, v141
    v_cvt_pk_bf16_f32 v214, v156, v157
    v_cvt_pk_bf16_f32 v199, v142, v143
    v_cvt_pk_bf16_f32 v215, v158, v159
    v_add_f32 v3, 1015021568, v3
    v_add_f32 v240, 0, v4
    v_mul_f32 v240, v240, v3
    v_cos_f32 v241, v240
    v_sin_f32 v242, v240
    v_mul_f32 v243, v160, v241
    v_mul_f32 v241, v176, v241
    v_fma_f32 v243, -v176, v242, v243
    v_fma_f32 v176, v160, v242, v241
    v_mov_b32 v160, v243
    v_add_f32 v240, 1065353216, v4
    v_mul_f32 v240, v240, v3
    v_cos_f32 v241, v240
    v_sin_f32 v242, v240
    v_mul_f32 v243, v161, v241
    v_mul_f32 v241, v177, v241
    v_fma_f32 v243, -v177, v242, v243
    v_fma_f32 v177, v161, v242, v241
    v_mov_b32 v161, v243
    v_add_f32 v240, 1073741824, v4
    v_mul_f32 v240, v240, v3
    v_cos_f32 v241, v240
    v_sin_f32 v242, v240
    v_mul_f32 v243, v162, v241
    v_mul_f32 v241, v178, v241
    v_fma_f32 v243, -v178, v242, v243
    v_fma_f32 v178, v162, v242, v241
    v_mov_b32 v162, v243
    v_add_f32 v240, 1077936128, v4
    v_mul_f32 v240, v240, v3
    v_cos_f32 v241, v240
    v_sin_f32 v242, v240
    v_mul_f32 v243, v163, v241
    v_mul_f32 v241, v179, v241
    v_fma_f32 v243, -v179, v242, v243
    v_fma_f32 v179, v163, v242, v241
    v_mov_b32 v163, v243
    v_add_f32 v240, 1090519040, v4
    v_mul_f32 v240, v240, v3
    v_cos_f32 v241, v240
    v_sin_f32 v242, v240
    v_mul_f32 v243, v164, v241
    v_mul_f32 v241, v180, v241
    v_fma_f32 v243, -v180, v242, v243
    v_fma_f32 v180, v164, v242, v241
    v_mov_b32 v164, v243
    v_add_f32 v240, 1091567616, v4
    v_mul_f32 v240, v240, v3
    v_cos_f32 v241, v240
    v_sin_f32 v242, v240
    v_mul_f32 v243, v165, v241
    v_mul_f32 v241, v181, v241
    v_fma_f32 v243, -v181, v242, v243
    v_fma_f32 v181, v165, v242, v241
    v_mov_b32 v165, v243
    v_add_f32 v240, 1092616192, v4
    v_mul_f32 v240, v240, v3
    v_cos_f32 v241, v240
    v_sin_f32 v242, v240
    v_mul_f32 v243, v166, v241
    v_mul_f32 v241, v182, v241
    v_fma_f32 v243, -v182, v242, v243
    v_fma_f32 v182, v166, v242, v241
    v_mov_b32 v166, v243
    v_add_f32 v240, 1093664768, v4
    v_mul_f32 v240, v240, v3
    v_cos_f32 v241, v240
    v_sin_f32 v242, v240
    v_mul_f32 v243, v167, v241
    v_mul_f32 v241, v183, v241
    v_fma_f32 v243, -v183, v242, v243
    v_fma_f32 v183, v167, v242, v241
    v_mov_b32 v167, v243
    v_add_f32 v240, 1098907648, v4
    v_mul_f32 v240, v240, v3
    v_cos_f32 v241, v240
    v_sin_f32 v242, v240
    v_mul_f32 v243, v168, v241
    v_mul_f32 v241, v184, v241
    v_fma_f32 v243, -v184, v242, v243
    v_fma_f32 v184, v168, v242, v241
    v_mov_b32 v168, v243
    v_add_f32 v240, 1099431936, v4
    v_mul_f32 v240, v240, v3
    v_cos_f32 v241, v240
    v_sin_f32 v242, v240
    v_mul_f32 v243, v169, v241
    v_mul_f32 v241, v185, v241
    v_fma_f32 v243, -v185, v242, v243
    v_fma_f32 v185, v169, v242, v241
    v_mov_b32 v169, v243
    v_add_f32 v240, 1099956224, v4
    v_mul_f32 v240, v240, v3
    v_cos_f32 v241, v240
    v_sin_f32 v242, v240
    v_mul_f32 v243, v170, v241
    v_mul_f32 v241, v186, v241
    v_fma_f32 v243, -v186, v242, v243
    v_fma_f32 v186, v170, v242, v241
    v_mov_b32 v170, v243
    v_add_f32 v240, 1100480512, v4
    v_mul_f32 v240, v240, v3
    v_cos_f32 v241, v240
    v_sin_f32 v242, v240
    v_mul_f32 v243, v171, v241
    v_mul_f32 v241, v187, v241
    v_fma_f32 v243, -v187, v242, v243
    v_fma_f32 v187, v171, v242, v241
    v_mov_b32 v171, v243
    v_add_f32 v240, 1103101952, v4
    v_mul_f32 v240, v240, v3
    v_cos_f32 v241, v240
    v_sin_f32 v242, v240
    v_mul_f32 v243, v172, v241
    v_mul_f32 v241, v188, v241
    v_fma_f32 v243, -v188, v242, v243
    v_fma_f32 v188, v172, v242, v241
    v_mov_b32 v172, v243
    v_add_f32 v240, 1103626240, v4
    v_mul_f32 v240, v240, v3
    v_cos_f32 v241, v240
    v_sin_f32 v242, v240
    v_mul_f32 v243, v173, v241
    v_mul_f32 v241, v189, v241
    v_fma_f32 v243, -v189, v242, v243
    v_fma_f32 v189, v173, v242, v241
    v_mov_b32 v173, v243
    v_add_f32 v240, 1104150528, v4
    v_mul_f32 v240, v240, v3
    v_cos_f32 v241, v240
    v_sin_f32 v242, v240
    v_mul_f32 v243, v174, v241
    v_mul_f32 v241, v190, v241
    v_fma_f32 v243, -v190, v242, v243
    v_fma_f32 v190, v174, v242, v241
    v_mov_b32 v174, v243
    v_add_f32 v240, 1104674816, v4
    v_mul_f32 v240, v240, v3
    v_cos_f32 v241, v240
    v_sin_f32 v242, v240
    v_mul_f32 v243, v175, v241
    v_mul_f32 v241, v191, v241
    v_fma_f32 v243, -v191, v242, v243
    v_fma_f32 v191, v175, v242, v241
    v_mov_b32 v175, v243
    v_cvt_pk_bf16_f32 v200, v160, v161
    v_cvt_pk_bf16_f32 v216, v176, v177
    v_cvt_pk_bf16_f32 v201, v162, v163
    v_cvt_pk_bf16_f32 v217, v178, v179
    v_cvt_pk_bf16_f32 v202, v164, v165
    v_cvt_pk_bf16_f32 v218, v180, v181
    v_cvt_pk_bf16_f32 v203, v166, v167
    v_cvt_pk_bf16_f32 v219, v182, v183
    v_cvt_pk_bf16_f32 v204, v168, v169
    v_cvt_pk_bf16_f32 v220, v184, v185
    v_cvt_pk_bf16_f32 v205, v170, v171
    v_cvt_pk_bf16_f32 v221, v186, v187
    v_cvt_pk_bf16_f32 v206, v172, v173
    v_cvt_pk_bf16_f32 v222, v188, v189
    v_cvt_pk_bf16_f32 v207, v174, v175
    v_cvt_pk_bf16_f32 v223, v190, v191
    s_nop 1
    v_mfma_f32_32x32x16_bf16 v[128:143], v[192:195], v[8:11], 0
    v_mfma_f32_32x32x16_bf16 v[128:143], v[196:199], v[12:15], v[128:143]
    v_mfma_f32_32x32x16_bf16 v[128:143], v[208:211], v[24:27], v[128:143]
    v_mfma_f32_32x32x16_bf16 v[128:143], v[212:215], v[28:31], v[128:143]
    v_mfma_f32_32x32x16_bf16 v[144:159], v[208:211], v[8:11], 0
    v_mfma_f32_32x32x16_bf16 v[144:159], v[212:215], v[12:15], v[144:159]
    v_mfma_f32_32x32x16_bf16 v[144:159], v[192:195], v[16:19], v[144:159]
    v_mfma_f32_32x32x16_bf16 v[144:159], v[196:199], v[20:23], v[144:159]
    v_mfma_f32_32x32x16_bf16 v[160:175], v[200:203], v[8:11], 0
    v_mfma_f32_32x32x16_bf16 v[160:175], v[204:207], v[12:15], v[160:175]
    v_mfma_f32_32x32x16_bf16 v[160:175], v[216:219], v[24:27], v[160:175]
    v_mfma_f32_32x32x16_bf16 v[160:175], v[220:223], v[28:31], v[160:175]
    v_mfma_f32_32x32x16_bf16 v[176:191], v[216:219], v[8:11], 0
    v_mfma_f32_32x32x16_bf16 v[176:191], v[220:223], v[12:15], v[176:191]
    v_mfma_f32_32x32x16_bf16 v[176:191], v[200:203], v[16:19], v[176:191]
    v_mfma_f32_32x32x16_bf16 v[176:191], v[204:207], v[20:23], v[176:191]
    s_lshl_b32 s61, s87, 13
    s_cmp_eq_u32 s87, 288
    s_cselect_b32 s61, 4096, s61
    s_add_u32 s61, s61, 96468992
    s_add_u32 s62, s61, 4096
    v_cvt_pk_bf16_f32 v128, v128, v129
    v_cvt_pk_bf16_f32 v129, v130, v131
    v_cvt_pk_bf16_f32 v130, v132, v133
    v_cvt_pk_bf16_f32 v131, v134, v135
    v_cvt_pk_bf16_f32 v132, v136, v137
    v_cvt_pk_bf16_f32 v133, v138, v139
    v_cvt_pk_bf16_f32 v134, v140, v141
    v_cvt_pk_bf16_f32 v135, v142, v143
    s_nop 1
    v_permlane32_swap_b32 v128, v130
    v_permlane32_swap_b32 v129, v131
    buffer_store_dwordx4 v[128:131], v5, s[52:55], s61 offen offset:0 sc1
    v_permlane32_swap_b32 v132, v134
    v_permlane32_swap_b32 v133, v135
    buffer_store_dwordx4 v[132:135], v5, s[52:55], s61 offen offset:32 sc1
    v_cvt_pk_bf16_f32 v160, v160, v161
    v_cvt_pk_bf16_f32 v161, v162, v163
    v_cvt_pk_bf16_f32 v162, v164, v165
    v_cvt_pk_bf16_f32 v163, v166, v167
    v_cvt_pk_bf16_f32 v164, v168, v169
    v_cvt_pk_bf16_f32 v165, v170, v171
    v_cvt_pk_bf16_f32 v166, v172, v173
    v_cvt_pk_bf16_f32 v167, v174, v175
    s_nop 1
    v_permlane32_swap_b32 v160, v162
    v_permlane32_swap_b32 v161, v163
    buffer_store_dwordx4 v[160:163], v5, s[52:55], s61 offen offset:64 sc1
    v_permlane32_swap_b32 v164, v166
    v_permlane32_swap_b32 v165, v167
    buffer_store_dwordx4 v[164:167], v5, s[52:55], s61 offen offset:96 sc1
    s_cmp_eq_u32 s63, 1
    s_cbranch_scc1 F2_end
    v_cvt_pk_bf16_f32 v144, v144, v145
    v_cvt_pk_bf16_f32 v145, v146, v147
    v_cvt_pk_bf16_f32 v146, v148, v149
    v_cvt_pk_bf16_f32 v147, v150, v151
    v_cvt_pk_bf16_f32 v148, v152, v153
    v_cvt_pk_bf16_f32 v149, v154, v155
    v_cvt_pk_bf16_f32 v150, v156, v157
    v_cvt_pk_bf16_f32 v151, v158, v159
    s_nop 1
    v_permlane32_swap_b32 v144, v146
    v_permlane32_swap_b32 v145, v147
    buffer_store_dwordx4 v[144:147], v5, s[52:55], s62 offen offset:0 sc1
    v_permlane32_swap_b32 v148, v150
    v_permlane32_swap_b32 v149, v151
    buffer_store_dwordx4 v[148:151], v5, s[52:55], s62 offen offset:32 sc1
    v_cvt_pk_bf16_f32 v176, v176, v177
    v_cvt_pk_bf16_f32 v177, v178, v179
    v_cvt_pk_bf16_f32 v178, v180, v181
    v_cvt_pk_bf16_f32 v179, v182, v183
    v_cvt_pk_bf16_f32 v180, v184, v185
    v_cvt_pk_bf16_f32 v181, v186, v187
    v_cvt_pk_bf16_f32 v182, v188, v189
    v_cvt_pk_bf16_f32 v183, v190, v191
    s_nop 1
    v_permlane32_swap_b32 v176, v178
    v_permlane32_swap_b32 v177, v179
    buffer_store_dwordx4 v[176:179], v5, s[52:55], s62 offen offset:64 sc1
    v_permlane32_swap_b32 v180, v182
    v_permlane32_swap_b32 v181, v183
    buffer_store_dwordx4 v[180:183], v5, s[52:55], s62 offen offset:96 sc1
F2_end:
M_nof2:
    s_waitcnt vmcnt(0)
    s_barrier
    s_cmp_lg_u32 s56, 0
    s_cbranch_scc1 SG_6
    v_mov_b32 v250, 76
    v_mov_b32 v251, 1
    s_mov_b64 exec, 1
    buffer_atomic_add v251, v250, s[48:51], 0 offen sc1
    s_mov_b64 exec, -1
SG_6:
    s_mov_b32 s88, 200000
    v_mov_b32 v250, 76
WG_7:
    buffer_load_dword v251, v250, s[48:51], 0 offen sc1
    s_sub_u32 s88, s88, 1
    s_cbranch_scc1 M_abort
    s_waitcnt vmcnt(0)
    v_cmp_le_u32 vcc, 224, v251
    s_cbranch_vccnz WG_7_ok
    s_sleep 8
    s_branch WG_7
WG_7_ok:
    s_cmp_ge_u32 s86, 44
    s_cbranch_scc1 M_nof3
    s_lshl_b32 s64, s85, 2
    s_add_u32 s64, s64, s56
    s_min_u32 s65, s64, 17
    s_mul_i32 s65, s65, 36864
    s_add_u32 s65, s65, 89128960
    v_lshlrev_b32 v44, 4, v1
    s_lshl_b32 s61, s56, 10
    v_lshrrev_b32 v42, 2, v1
    s_lshl_b32 s60, s56, 4
    v_add_u32 v42, s60, v42
    v_lshlrev_b32 v40, 12, v42
    v_and_b32 v42, 3, v1
    v_lshl_add_u32 v40, v42, 4, v40
    v_bfe_u32 v42, v1, 2, 2
    v_lshrrev_b32 v43, 5, v1
    v_lshl_add_u32 v42, v43, 3, v42
    v_lshlrev_b32 v36, 6, v42
    v_bfe_u32 v42, v1, 4, 1
    v_lshl_add_u32 v36, v42, 5, v36
    v_and_b32 v42, 3, v1
    v_lshl_add_u32 v36, v42, 3, v36
    v_and_b32 v42, 31, v1
    v_mul_u32_u24 v41, 2304, v42
    v_lshl_add_u32 v41, v43, 4, v41
    s_mov_b32 s66, s86
    s_mov_b32 s67, s61
    s_barrier
    s_add_u32 m0, s67, 0
    s_lshl_b32 s62, s66, 6
    s_add_u32 s62, s62, 96468992
    buffer_load_dwordx4 v40, s[52:55], s62 offen sc1 lds
    s_add_u32 m0, s67, 4096
    s_lshl_b32 s62, s66, 6
    s_add_u32 s62, s62, 96731136
    buffer_load_dwordx4 v40, s[52:55], s62 offen sc1 lds
    s_add_u32 m0, s67, 8192
    s_lshl_b32 s62, s66, 6
    s_add_u32 s62, s62, 96993280
    buffer_load_dwordx4 v40, s[52:55], s62 offen sc1 lds
    s_add_u32 m0, s67, 12288
    s_lshl_b32 s62, s66, 6
    s_add_u32 s62, s62, 97255424
    buffer_load_dwordx4 v40, s[52:55], s62 offen sc1 lds
    s_add_u32 m0, s67, 16384
    s_lshl_b32 s62, s66, 6
    s_add_u32 s62, s62, 97517568
    buffer_load_dwordx4 v40, s[52:55], s62 offen sc1 lds
    s_add_u32 m0, s67, 20480
    s_lshl_b32 s62, s66, 6
    s_add_u32 s62, s62, 97779712
    buffer_load_dwordx4 v40, s[52:55], s62 offen sc1 lds
    s_add_u32 m0, s67, 24576
    s_lshl_b32 s62, s66, 6
    s_add_u32 s62, s62, 98041856
    buffer_load_dwordx4 v40, s[52:55], s62 offen sc1 lds
    s_add_u32 m0, s67, 28672
    s_lshl_b32 s62, s66, 6
    s_add_u32 s62, s62, 98304000
    buffer_load_dwordx4 v40, s[52:55], s62 offen sc1 lds
    s_add_u32 m0, s67, 32768
    s_lshl_b32 s62, s66, 6
    s_add_u32 s62, s62, 98566144
    buffer_load_dwordx4 v40, s[52:55], s62 offen sc1 lds
    buffer_load_dwordx4 v[112:115], v44, s[52:55], s65 offen offset:0 sc1
    buffer_load_dwordx4 v[116:119], v44, s[52:55], s65 offen offset:1024 sc1
    buffer_load_dwordx4 v[120:123], v44, s[52:55], s65 offen offset:2048 sc1
    buffer_load_dwordx4 v[124:127], v44, s[52:55], s65 offen offset:3072 sc1
    s_add_u32 s65, s65, 4096
    buffer_load_dwordx4 v[128:131], v44, s[52:55], s65 offen offset:0 sc1
    buffer_load_dwordx4 v[132:135], v44, s[52:55], s65 offen offset:1024 sc1
    buffer_load_dwordx4 v[136:139], v44, s[52:55], s65 offen offset:2048 sc1
    buffer_load_dwordx4 v[140:143], v44, s[52:55], s65 offen offset:3072 sc1
    s_add_u32 s65, s65, 4096
    buffer_load_dwordx4 v[144:147], v44, s[52:55], s65 offen offset:0 sc1
    buffer_load_dwordx4 v[148:151], v44, s[52:55], s65 offen offset:1024 sc1
    buffer_load_dwordx4 v[152:155], v44, s[52:55], s65 offen offset:2048 sc1
    buffer_load_dwordx4 v[156:159], v44, s[52:55], s65 offen offset:3072 sc1
    s_add_u32 s65, s65, 4096
    buffer_load_dwordx4 v[160:163], v44, s[52:55], s65 offen offset:0 sc1
    buffer_load_dwordx4 v[164:167], v44, s[52:55], s65 offen offset:1024 sc1
    buffer_load_dwordx4 v[168:171], v44, s[52:55], s65 offen offset:2048 sc1
    buffer_load_dwordx4 v[172:175], v44, s[52:55], s65 offen offset:3072 sc1
    s_add_u32 s65, s65, 4096
    buffer_load_dwordx4 v[176:179], v44, s[52:55], s65 offen offset:0 sc1
    buffer_load_dwordx4 v[180:183], v44, s[52:55], s65 offen offset:1024 sc1
    buffer_load_dwordx4 v[184:187], v44, s[52:55], s65 offen offset:2048 sc1
    buffer_load_dwordx4 v[188:191], v44, s[52:55], s65 offen offset:3072 sc1
    s_add_u32 s65, s65, 4096
    buffer_load_dwordx4 v[192:195], v44, s[52:55], s65 offen offset:0 sc1
    buffer_load_dwordx4 v[196:199], v44, s[52:55], s65 offen offset:1024 sc1
    buffer_load_dwordx4 v[200:203], v44, s[52:55], s65 offen offset:2048 sc1
    buffer_load_dwordx4 v[204:207], v44, s[52:55], s65 offen offset:3072 sc1
    s_add_u32 s65, s65, 4096
    buffer_load_dwordx4 v[208:211], v44, s[52:55], s65 offen offset:0 sc1
    buffer_load_dwordx4 v[212:215], v44, s[52:55], s65 offen offset:1024 sc1
    buffer_load_dwordx4 v[216:219], v44, s[52:55], s65 offen offset:2048 sc1
    buffer_load_dwordx4 v[220:223], v44, s[52:55], s65 offen offset:3072 sc1
    s_add_u32 s65, s65, 4096
    buffer_load_dwordx4 v[224:227], v44, s[52:55], s65 offen offset:0 sc1
    buffer_load_dwordx4 v[228:231], v44, s[52:55], s65 offen offset:1024 sc1
    buffer_load_dwordx4 v[232:235], v44, s[52:55], s65 offen offset:2048 sc1
    buffer_load_dwordx4 v[236:239], v44, s[52:55], s65 offen offset:3072 sc1
    s_add_u32 s65, s65, 4096
    buffer_load_dwordx4 v[240:243], v44, s[52:55], s65 offen offset:0 sc1
    buffer_load_dwordx4 v[244:247], v44, s[52:55], s65 offen offset:1024 sc1
    buffer_load_dwordx4 v[248:251], v44, s[52:55], s65 offen offset:2048 sc1
    buffer_load_dwordx4 v[252:255], v44, s[52:55], s65 offen offset:3072 sc1
F3_loop:
    s_waitcnt vmcnt(0)
    s_barrier
    s_add_u32 s68, s66, 44
    s_xor_b32 s67, s67, 65536
    s_cmp_ge_u32 s68, 64
    s_cbranch_scc1 F3_nopf
    s_add_u32 m0, s67, 0
    s_lshl_b32 s62, s68, 6
    s_add_u32 s62, s62, 96468992
    buffer_load_dwordx4 v40, s[52:55], s62 offen sc1 lds
    s_add_u32 m0, s67, 4096
    s_lshl_b32 s62, s68, 6
    s_add_u32 s62, s62, 96731136
    buffer_load_dwordx4 v40, s[52:55], s62 offen sc1 lds
    s_add_u32 m0, s67, 8192
    s_lshl_b32 s62, s68, 6
    s_add_u32 s62, s62, 96993280
    buffer_load_dwordx4 v40, s[52:55], s62 offen sc1 lds
    s_add_u32 m0, s67, 12288
    s_lshl_b32 s62, s68, 6
    s_add_u32 s62, s62, 97255424
    buffer_load_dwordx4 v40, s[52:55], s62 offen sc1 lds
    s_add_u32 m0, s67, 16384
    s_lshl_b32 s62, s68, 6
    s_add_u32 s62, s62, 97517568
    buffer_load_dwordx4 v40, s[52:55], s62 offen sc1 lds
    s_add_u32 m0, s67, 20480
    s_lshl_b32 s62, s68, 6
    s_add_u32 s62, s62, 97779712
    buffer_load_dwordx4 v40, s[52:55], s62 offen sc1 lds
    s_add_u32 m0, s67, 24576
    s_lshl_b32 s62, s68, 6
    s_add_u32 s62, s62, 98041856
    buffer_load_dwordx4 v40, s[52:55], s62 offen sc1 lds
    s_add_u32 m0, s67, 28672
    s_lshl_b32 s62, s68, 6
    s_add_u32 s62, s62, 98304000
    buffer_load_dwordx4 v40, s[52:55], s62 offen sc1 lds
    s_add_u32 m0, s67, 32768
    s_lshl_b32 s62, s68, 6
    s_add_u32 s62, s62, 98566144
    buffer_load_dwordx4 v40, s[52:55], s62 offen sc1 lds
F3_nopf:
    ds_read_b64_tr_b16 v[24:25], v36 offset:0
    ds_read_b64_tr_b16 v[26:27], v36 offset:256
    ds_read_b64_tr_b16 v[28:29], v36 offset:1024
    ds_read_b64_tr_b16 v[30:31], v36 offset:1280
    s_waitcnt lgkmcnt(2)
    v_mfma_f32_32x32x16_bf16 v[8:23], v[112:115], v[24:27], 0
    ds_read_b64_tr_b16 v[32:33], v36 offset:2048
    ds_read_b64_tr_b16 v[34:35], v36 offset:2304
    s_waitcnt lgkmcnt(2)
    v_mfma_f32_32x32x16_bf16 v[8:23], v[116:119], v[28:31], v[8:23]
    ds_read_b64_tr_b16 v[24:25], v36 offset:3072
    ds_read_b64_tr_b16 v[26:27], v36 offset:3328
    s_waitcnt lgkmcnt(2)
    v_mfma_f32_32x32x16_bf16 v[8:23], v[120:123], v[32:35], v[8:23]
    ds_read_b64_tr_b16 v[28:29], v36 offset:4096
    ds_read_b64_tr_b16 v[30:31], v36 offset:4352
    s_waitcnt lgkmcnt(2)
    v_mfma_f32_32x32x16_bf16 v[8:23], v[124:127], v[24:27], v[8:23]
    ds_read_b64_tr_b16 v[32:33], v36 offset:5120
    ds_read_b64_tr_b16 v[34:35], v36 offset:5376
    s_waitcnt lgkmcnt(2)
    v_mfma_f32_32x32x16_bf16 v[8:23], v[128:131], v[28:31], v[8:23]
    ds_read_b64_tr_b16 v[24:25], v36 offset:6144
    ds_read_b64_tr_b16 v[26:27], v36 offset:6400
    s_waitcnt lgkmcnt(2)
    v_mfma_f32_32x32x16_bf16 v[8:23], v[132:135], v[32:35], v[8:23]
    ds_read_b64_tr_b16 v[28:29], v36 offset:7168
    ds_read_b64_tr_b16 v[30:31], v36 offset:7424
    s_waitcnt lgkmcnt(2)
    v_mfma_f32_32x32x16_bf16 v[8:23], v[136:139], v[24:27], v[8:23]
    ds_read_b64_tr_b16 v[32:33], v36 offset:8192
    ds_read_b64_tr_b16 v[34:35], v36 offset:8448
    s_waitcnt lgkmcnt(2)
    v_mfma_f32_32x32x16_bf16 v[8:23], v[140:143], v[28:31], v[8:23]
    ds_read_b64_tr_b16 v[24:25], v36 offset:9216
    ds_read_b64_tr_b16 v[26:27], v36 offset:9472
    s_waitcnt lgkmcnt(2)
    v_mfma_f32_32x32x16_bf16 v[8:23], v[144:147], v[32:35], v[8:23]
    ds_read_b64_tr_b16 v[28:29], v36 offset:10240
    ds_read_b64_tr_b16 v[30:31], v36 offset:10496
    s_waitcnt lgkmcnt(2)
    v_mfma_f32_32x32x16_bf16 v[8:23], v[148:151], v[24:27], v[8:23]
    ds_read_b64_tr_b16 v[32:33], v36 offset:11264
    ds_read_b64_tr_b16 v[34:35], v36 offset:11520
    s_waitcnt lgkmcnt(2)
    v_mfma_f32_32x32x16_bf16 v[8:23], v[152:155], v[28:31], v[8:23]
    ds_read_b64_tr_b16 v[24:25], v36 offset:12288
    ds_read_b64_tr_b16 v[26:27], v36 offset:12544
    s_waitcnt lgkmcnt(2)
    v_mfma_f32_32x32x16_bf16 v[8:23], v[156:159], v[32:35], v[8:23]
    ds_read_b64_tr_b16 v[28:29], v36 offset:13312
    ds_read_b64_tr_b16 v[30:31], v36 offset:13568
    s_waitcnt lgkmcnt(2)
    v_mfma_f32_32x32x16_bf16 v[8:23], v[160:163], v[24:27], v[8:23]
    ds_read_b64_tr_b16 v[32:33], v36 offset:14336
    ds_read_b64_tr_b16 v[34:35], v36 offset:14592
    s_waitcnt lgkmcnt(2)
    v_mfma_f32_32x32x16_bf16 v[8:23], v[164:167], v[28:31], v[8:23]
    ds_read_b64_tr_b16 v[24:25], v36 offset:15360
    ds_read_b64_tr_b16 v[26:27], v36 offset:15616
    s_waitcnt lgkmcnt(2)
    v_mfma_f32_32x32x16_bf16 v[8:23], v[168:171], v[32:35], v[8:23]
    ds_read_b64_tr_b16 v[28:29], v36 offset:16384
    ds_read_b64_tr_b16 v[30:31], v36 offset:16640
    s_waitcnt lgkmcnt(2)
    v_mfma_f32_32x32x16_bf16 v[8:23], v[172:175], v[24:27], v[8:23]
    ds_read_b64_tr_b16 v[32:33], v36 offset:17408
    ds_read_b64_tr_b16 v[34:35], v36 offset:17664
    s_waitcnt lgkmcnt(2)
    v_mfma_f32_32x32x16_bf16 v[8:23], v[176:179], v[28:31], v[8:23]
    ds_read_b64_tr_b16 v[24:25], v36 offset:18432
    ds_read_b64_tr_b16 v[26:27], v36 offset:18688
    s_waitcnt lgkmcnt(2)
    v_mfma_f32_32x32x16_bf16 v[8:23], v[180:183], v[32:35], v[8:23]
    ds_read_b64_tr_b16 v[28:29], v36 offset:19456
    ds_read_b64_tr_b16 v[30:31], v36 offset:19712
    s_waitcnt lgkmcnt(2)
    v_mfma_f32_32x32x16_bf16 v[8:23], v[184:187], v[24:27], v[8:23]
    ds_read_b64_tr_b16 v[32:33], v36 offset:20480
    ds_read_b64_tr_b16 v[34:35], v36 offset:20736
    s_waitcnt lgkmcnt(2)
    v_mfma_f32_32x32x16_bf16 v[8:23], v[188:191], v[28:31], v[8:23]
    ds_read_b64_tr_b16 v[24:25], v36 offset:21504
    ds_read_b64_tr_b16 v[26:27], v36 offset:21760
    s_waitcnt lgkmcnt(2)
    v_mfma_f32_32x32x16_bf16 v[8:23], v[192:195], v[32:35], v[8:23]
    ds_read_b64_tr_b16 v[28:29], v36 offset:22528
    ds_read_b64_tr_b16 v[30:31], v36 offset:22784
    s_waitcnt lgkmcnt(2)
    v_mfma_f32_32x32x16_bf16 v[8:23], v[196:199], v[24:27], v[8:23]
    ds_read_b64_tr_b16 v[32:33], v36 offset:23552
    ds_read_b64_tr_b16 v[34:35], v36 offset:23808
    s_waitcnt lgkmcnt(2)
    v_mfma_f32_32x32x16_bf16 v[8:23], v[200:203], v[28:31], v[8:23]
    ds_read_b64_tr_b16 v[24:25], v36 offset:24576
    ds_read_b64_tr_b16 v[26:27], v36 offset:24832
    s_waitcnt lgkmcnt(2)
    v_mfma_f32_32x32x16_bf16 v[8:23], v[204:207], v[32:35], v[8:23]
    ds_read_b64_tr_b16 v[28:29], v36 offset:25600
    ds_read_b64_tr_b16 v[30:31], v36 offset:25856
    s_waitcnt lgkmcnt(2)
    v_mfma_f32_32x32x16_bf16 v[8:23], v[208:211], v[24:27], v[8:23]
    ds_read_b64_tr_b16 v[32:33], v36 offset:26624
    ds_read_b64_tr_b16 v[34:35], v36 offset:26880
    s_waitcnt lgkmcnt(2)
    v_mfma_f32_32x32x16_bf16 v[8:23], v[212:215], v[28:31], v[8:23]
    ds_read_b64_tr_b16 v[24:25], v36 offset:27648
    ds_read_b64_tr_b16 v[26:27], v36 offset:27904
    s_waitcnt lgkmcnt(2)
    v_mfma_f32_32x32x16_bf16 v[8:23], v[216:219], v[32:35], v[8:23]
    ds_read_b64_tr_b16 v[28:29], v36 offset:28672
    ds_read_b64_tr_b16 v[30:31], v36 offset:28928
    s_waitcnt lgkmcnt(2)
    v_mfma_f32_32x32x16_bf16 v[8:23], v[220:223], v[24:27], v[8:23]
    ds_read_b64_tr_b16 v[32:33], v36 offset:29696
    ds_read_b64_tr_b16 v[34:35], v36 offset:29952
    s_waitcnt lgkmcnt(2)
    v_mfma_f32_32x32x16_bf16 v[8:23], v[224:227], v[28:31], v[8:23]
    ds_read_b64_tr_b16 v[24:25], v36 offset:30720
    ds_read_b64_tr_b16 v[26:27], v36 offset:30976
    s_waitcnt lgkmcnt(2)
    v_mfma_f32_32x32x16_bf16 v[8:23], v[228:231], v[32:35], v[8:23]
    ds_read_b64_tr_b16 v[28:29], v36 offset:31744
    ds_read_b64_tr_b16 v[30:31], v36 offset:32000
    s_waitcnt lgkmcnt(2)
    v_mfma_f32_32x32x16_bf16 v[8:23], v[232:235], v[24:27], v[8:23]
    ds_read_b64_tr_b16 v[32:33], v36 offset:32768
    ds_read_b64_tr_b16 v[34:35], v36 offset:33024
    s_waitcnt lgkmcnt(2)
    v_mfma_f32_32x32x16_bf16 v[8:23], v[236:239], v[28:31], v[8:23]
    ds_read_b64_tr_b16 v[24:25], v36 offset:33792
    ds_read_b64_tr_b16 v[26:27], v36 offset:34048
    s_waitcnt lgkmcnt(2)
    v_mfma_f32_32x32x16_bf16 v[8:23], v[240:243], v[32:35], v[8:23]
    ds_read_b64_tr_b16 v[28:29], v36 offset:34816
    ds_read_b64_tr_b16 v[30:31], v36 offset:35072
    s_waitcnt lgkmcnt(2)
    v_mfma_f32_32x32x16_bf16 v[8:23], v[244:247], v[24:27], v[8:23]
    ds_read_b64_tr_b16 v[32:33], v36 offset:35840
    ds_read_b64_tr_b16 v[34:35], v36 offset:36096
    s_waitcnt lgkmcnt(2)
    v_mfma_f32_32x32x16_bf16 v[8:23], v[248:251], v[28:31], v[8:23]
    s_waitcnt lgkmcnt(0)
    v_mfma_f32_32x32x16_bf16 v[8:23], v[252:255], v[32:35], v[8:23]
    v_xor_b32 v36, 0x10000, v36
    s_mul_i32 s60, s66, 73728
    s_lshl_b32 s62, s64, 6
    s_add_u32 s60, s60, s62
    s_nop 7
    s_cmp_ge_u32 s64, 18
    s_cbranch_scc1 F3_nost
    v_cvt_pk_bf16_f32 v8, v8, v9
    v_cvt_pk_bf16_f32 v9, v10, v11
    v_cvt_pk_bf16_f32 v10, v12, v13
    v_cvt_pk_bf16_f32 v11, v14, v15
    v_cvt_pk_bf16_f32 v12, v16, v17
    v_cvt_pk_bf16_f32 v13, v18, v19
    v_cvt_pk_bf16_f32 v14, v20, v21
    v_cvt_pk_bf16_f32 v15, v22, v23
    s_nop 1
    v_permlane32_swap_b32 v8, v10
    v_permlane32_swap_b32 v9, v11
    buffer_store_dwordx4 v[8:11], v41, s[44:47], s60 offen offset:0
    v_permlane32_swap_b32 v12, v14
    v_permlane32_swap_b32 v13, v15
    buffer_store_dwordx4 v[12:15], v41, s[44:47], s60 offen offset:32
F3_nost:
    s_mov_b32 s66, s68
    s_cmp_lt_u32 s66, 64
    s_cbranch_scc1 F3_loop
M_nof3:
    s_waitcnt vmcnt(0)
    s_barrier
    v_lshlrev_b32 v2, 4, v1
    v_bfe_u32 v3, v1, 2, 2
    v_lshrrev_b32 v6, 5, v1
    v_lshl_add_u32 v3, v6, 2, v3
    v_lshlrev_b32 v3, 4, v3
    v_and_b32 v7, 1, v1
    v_lshl_add_u32 v3, v7, 3, v3
    s_lshl_b32 s60, s56, 11
    v_add_u32 v3, s60, v3
    v_and_b32 v4, 31, v1
    v_lshlrev_b32 v4, 4, v4
    v_lshl_add_u32 v4, v6, 3, v4
    s_lshl_b32 s60, s56, 9
    v_add_u32 v4, s60, v4
    s_lshl_b32 s60, s56, 11
    v_add_u32 v5, s60, v2
    v_lshlrev_b32 v163, 4, v1
    s_lshl_b32 s60, s56, 12
    s_add_u32 s60, s60, 131072
    v_add_u32 v160, s60, v163
    s_lshl_b32 s60, s56, 10
    s_add_u32 s60, s60, 131072
    v_add_u32 v161, s60, v163
    s_lshl_b32 s60, s56, 16
    v_add_u32 v163, s60, v163
    v_and_b32 v164, 31, v1
    v_mul_u32_u24 v162, 2304, v164
    v_lshrrev_b32 v164, 5, v1
    v_lshl_add_u32 v162, v164, 3, v162
    s_lshl_b32 s60, s79, 6
    s_lshl_b32 s61, s56, 4
    s_add_u32 s60, s60, s61
    s_add_u32 s60, s60, 1152
    v_add_u32 v162, s60, v162
    s_mov_b32 s81, s78
    s_cmp_lt_u32 s80, 12
    s_cselect_b32 s82, s80, 64
    s_mov_b32 s83, 0
    s_mov_b32 s59, 0
    s_mov_b32 s90, 0
    s_mov_b32 s91, 0
    s_mov_b32 s92, 0
    s_mov_b32 s93, 0
    s_mov_b32 s92, 0
M_evx:
    s_cmp_ge_u32 s81, 64
    s_cbranch_scc1 M_ev
    s_lshl_b32 s84, s81, 5
    s_add_u32 s84, s84, s77
    s_mov_b32 s89, s84
    s_lshl_b32 s60, s89, 13
    s_add_u32 s61, s60, 35651584
    s_add_u32 s62, s60, 2097152
    s_add_u32 s63, s60, 18874368
    buffer_load_dwordx4 v[184:187], v2, s[52:55], s61 offen offset:0 sc1
    buffer_load_dwordx4 v[8:11], v2, s[52:55], s62 offen offset:0 sc1
    buffer_load_dwordx4 v[188:191], v2, s[52:55], s61 offen offset:1024 sc1
    buffer_load_dwordx4 v[12:15], v2, s[52:55], s62 offen offset:1024 sc1
    buffer_load_dwordx4 v[192:195], v2, s[52:55], s61 offen offset:2048 sc1
    buffer_load_dwordx4 v[16:19], v2, s[52:55], s62 offen offset:2048 sc1
    buffer_load_dwordx4 v[196:199], v2, s[52:55], s61 offen offset:3072 sc1
    buffer_load_dwordx4 v[20:23], v2, s[52:55], s62 offen offset:3072 sc1
    s_add_u32 s61, s61, 4096
    s_add_u32 s62, s62, 4096
    buffer_load_dwordx4 v[200:203], v2, s[52:55], s61 offen offset:0 sc1
    buffer_load_dwordx4 v[24:27], v2, s[52:55], s62 offen offset:0 sc1
    buffer_load_dwordx4 v[204:207], v2, s[52:55], s61 offen offset:1024 sc1
    buffer_load_dwordx4 v[28:31], v2, s[52:55], s62 offen offset:1024 sc1
    buffer_load_dwordx4 v[208:211], v2, s[52:55], s61 offen offset:2048 sc1
    buffer_load_dwordx4 v[32:35], v2, s[52:55], s62 offen offset:2048 sc1
    buffer_load_dwordx4 v[212:215], v2, s[52:55], s61 offen offset:3072 sc1
    buffer_load_dwordx4 v[36:39], v2, s[52:55], s62 offen offset:3072 sc1
    buffer_load_dwordx4 v[216:219], v5, s[52:55], s63 offen offset:0 sc1
    buffer_load_dwordx4 v[220:223], v5, s[52:55], s63 offen offset:1024 sc1
    s_waitcnt vmcnt(16)
    v_mfma_f32_32x32x16_bf16 v[224:239], v[8:11], v[184:187], 0
    s_waitcnt vmcnt(14)
    v_mfma_f32_32x32x16_bf16 v[224:239], v[12:15], v[188:191], v[224:239]
    s_waitcnt vmcnt(12)
    v_mfma_f32_32x32x16_bf16 v[224:239], v[16:19], v[192:195], v[224:239]
    s_waitcnt vmcnt(10)
    v_mfma_f32_32x32x16_bf16 v[224:239], v[20:23], v[196:199], v[224:239]
    s_waitcnt vmcnt(8)
    v_mfma_f32_32x32x16_bf16 v[224:239], v[24:27], v[200:203], v[224:239]
    s_waitcnt vmcnt(6)
    v_mfma_f32_32x32x16_bf16 v[224:239], v[28:31], v[204:207], v[224:239]
    s_waitcnt vmcnt(4)
    v_mfma_f32_32x32x16_bf16 v[224:239], v[32:35], v[208:211], v[224:239]
    s_waitcnt vmcnt(2)
    v_mfma_f32_32x32x16_bf16 v[224:239], v[36:39], v[212:215], v[224:239]
    v_mov_b32 v40, 3492320863
    s_nop 8
    s_mov_b32 s60, 4294967295
    s_mov_b32 s61, 4294967280
    v_cndmask_b32 v224, v40, v224, s[60:61]
    s_mov_b32 s60, 4294967294
    s_mov_b32 s61, 4294967264
    v_cndmask_b32 v225, v40, v225, s[60:61]
    s_mov_b32 s60, 4294967292
    s_mov_b32 s61, 4294967232
    v_cndmask_b32 v226, v40, v226, s[60:61]
    s_mov_b32 s60, 4294967288
    s_mov_b32 s61, 4294967168
    v_cndmask_b32 v227, v40, v227, s[60:61]
    s_mov_b32 s60, 4294967040
    s_mov_b32 s61, 4294963200
    v_cndmask_b32 v228, v40, v228, s[60:61]
    s_mov_b32 s60, 4294966784
    s_mov_b32 s61, 4294959104
    v_cndmask_b32 v229, v40, v229, s[60:61]
    s_mov_b32 s60, 4294966272
    s_mov_b32 s61, 4294950912
    v_cndmask_b32 v230, v40, v230, s[60:61]
    s_mov_b32 s60, 4294965248
    s_mov_b32 s61, 4294934528
    v_cndmask_b32 v231, v40, v231, s[60:61]
    s_mov_b32 s60, 4294901760
    s_mov_b32 s61, 4293918720
    v_cndmask_b32 v232, v40, v232, s[60:61]
    s_mov_b32 s60, 4294836224
    s_mov_b32 s61, 4292870144
    v_cndmask_b32 v233, v40, v233, s[60:61]
    s_mov_b32 s60, 4294705152
    s_mov_b32 s61, 4290772992
    v_cndmask_b32 v234, v40, v234, s[60:61]
    s_mov_b32 s60, 4294443008
    s_mov_b32 s61, 4286578688
    v_cndmask_b32 v235, v40, v235, s[60:61]
    s_mov_b32 s60, 4278190080
    s_mov_b32 s61, 4026531840
    v_cndmask_b32 v236, v40, v236, s[60:61]
    s_mov_b32 s60, 4261412864
    s_mov_b32 s61, 3758096384
    v_cndmask_b32 v237, v40, v237, s[60:61]
    s_mov_b32 s60, 4227858432
    s_mov_b32 s61, 3221225472
    v_cndmask_b32 v238, v40, v238, s[60:61]
    s_mov_b32 s60, 4160749568
    s_mov_b32 s61, 2147483648
    v_cndmask_b32 v239, v40, v239, s[60:61]
    v_max3_f32 v240, v224, v225, v226
    v_max3_f32 v240, v240, v227, v228
    v_max3_f32 v240, v240, v229, v230
    v_max3_f32 v240, v240, v231, v232
    v_max3_f32 v240, v240, v233, v234
    v_max3_f32 v240, v240, v235, v236
    v_max3_f32 v240, v240, v237, v238
    v_max_f32 v240, v240, v239
    s_waitcnt vmcnt(0)
    s_memrealtime s[60:61]
    s_mov_b32 s95, 0
    s_waitcnt lgkmcnt(0)
    s_mov_b32 s94, s60
M_ev:
    s_min_u32 s60, s81, s82
    s_cmp_ge_u32 s60, 64
    s_cbranch_scc1 M_fin
    s_cmp_lg_u32 s56, 0
    s_cbranch_scc1 M_evb
    s_lshl_b32 s64, s77, 7
    s_add_u32 s64, s64, 86589440
    s_min_u32 s65, s82, 63
    s_lshl_b32 s65, s65, 12
    s_add_u32 s65, s65, 86638592
    v_mov_b32 v250, s64
    v_and_b32 v251, 31, v1
    v_lshlrev_b32 v251, 7, v251
    v_add_u32 v251, s65, v251
    s_mov_b32 s88, 200000
M_evp:
    s_mov_b32 s62, 3
    s_sub_u32 s88, s88, 1
    s_cbranch_scc1 M_evd
    s_cmp_ge_u32 s81, 64
    s_cbranch_scc1 M_evo
    s_memrealtime s[60:61]
    s_waitcnt lgkmcnt(0)
    s_sub_u32 s61, s60, s94
    s_cmp_lt_i32 s61, 0
    s_cbranch_scc1 M_evi
    buffer_load_dword v252, v250, s[52:55], 0 offen sc1
    s_waitcnt vmcnt(0)
    v_readfirstlane_b32 s61, v252
    s_mov_b32 s62, 1
    s_cmp_gt_u32 s61, s81
    s_cbranch_scc1 M_evd
    s_cmp_eq_u32 s61, 63
    s_cbranch_scc1 M_evd
    s_sub_u32 s61, s81, s61
    s_cmp_ge_u32 s81, 62
    s_cselect_b32 s63, 2, 1
    s_cselect_b32 s64, 1, 0
    s_cmp_le_u32 s61, s63
    s_cselect_b32 s95, 1, 0
    s_cselect_b32 s62, s64, s63
    s_min_u32 s62, s62, s61
    s_sub_u32 s61, s61, s62
    s_mul_i32 s61, s61, 170
    s_max_u32 s61, s61, 30
    s_add_u32 s94, s60, s61
M_evi:
    s_cmp_eq_u32 s95, 1
    s_cbranch_scc1 M_evs
M_evo:
    s_cmp_ge_u32 s82, 64
    s_cbranch_scc1 M_evs
    buffer_load_dword v253, v251, s[52:55], 0 offen sc1
    s_mov_b32 s62, 2
    s_waitcnt vmcnt(0)
    v_cmp_eq_u32 vcc, 0, v253
    s_cbranch_vccz M_evd
M_evs:
    s_sleep 4
    s_branch M_evp
M_evd:
    v_mov_b32 v252, s62
    v_mov_b32 v253, 16384
    ds_write_b32 v253, v252
    s_waitcnt lgkmcnt(0)
M_evb:
    s_barrier
    v_mov_b32 v253, 16384
    ds_read_b32 v252, v253
    s_waitcnt lgkmcnt(0)
    v_readfirstlane_b32 s62, v252
    s_barrier
    s_cmp_eq_u32 s62, 3
    s_cbranch_scc1 M_abort
    s_cmp_eq_u32 s62, 2
    s_cbranch_scc1 M_evO
    s_lshl_b32 s60, s89, 12
    s_add_u32 s61, s60, 52428800
    s_add_u32 s62, s60, 52430848
    v_mov_b32 v42, 0
    v_mov_b32 v43, 0
    v_mov_b32 v70, 0
    v_mov_b32 v71, 0
    s_mov_b32 s63, 200000
X_poll:
    buffer_load_dwordx4 v[72:75], v2, s[52:55], s61 offen sc1
    buffer_load_dwordx4 v[76:79], v2, s[52:55], s61 offen offset:1024 sc1
    buffer_load_dwordx2 v[40:41], v4, s[52:55], s62 offen sc1
    s_cmp_lt_u32 s84, 2016
    s_waitcnt vmcnt(0)
    s_cbranch_scc1 X_have
    v_max3_u32 v88, v72, v73, v74
    v_max3_u32 v88, v88, v75, v76
    v_max3_u32 v88, v88, v77, v78
    v_max3_u32 v88, v88, v79, v40
    v_max_u32 v88, v88, v41
    v_cmp_eq_u32 vcc, -1, v88
    s_cbranch_vccz X_have
    s_sub_u32 s63, s63, 1
    s_cbranch_scc1 X_have
    s_sleep 5
    s_branch X_poll
X_have:
    ds_write_b128 v5, v[72:75]
    ds_write_b128 v5, v[76:79] offset:1024
    ds_read_b64_tr_b16 v[8:9], v3 offset:0
    ds_read_b64_tr_b16 v[10:11], v3 offset:128
    ds_read_b64_tr_b16 v[12:13], v3 offset:256
    ds_read_b64_tr_b16 v[14:15], v3 offset:384
    ds_read_b64_tr_b16 v[16:17], v3 offset:512
    ds_read_b64_tr_b16 v[18:19], v3 offset:640
    ds_read_b64_tr_b16 v[20:21], v3 offset:768
    ds_read_b64_tr_b16 v[22:23], v3 offset:896
    ds_read_b64_tr_b16 v[24:25], v3 offset:1024
    ds_read_b64_tr_b16 v[26:27], v3 offset:1152
    ds_read_b64_tr_b16 v[28:29], v3 offset:1280
    ds_read_b64_tr_b16 v[30:31], v3 offset:1408
    s_waitcnt lgkmcnt(8)
    ds_read_b64_tr_b16 v[32:33], v3 offset:1536
    ds_read_b64_tr_b16 v[34:35], v3 offset:1664
    ds_read_b64_tr_b16 v[36:37], v3 offset:1792
    ds_read_b64_tr_b16 v[38:39], v3 offset:1920
    s_waitcnt lgkmcnt(8)
    v_mfma_f32_32x32x16_bf16 v[44:59], v[8:11], v[184:187], 0
    s_waitcnt lgkmcnt(8)
    v_mfma_f32_32x32x16_bf16 v[44:59], v[12:15], v[188:191], v[44:59]
    s_waitcnt lgkmcnt(8)
    v_mfma_f32_32x32x16_bf16 v[44:59], v[16:19], v[192:195], v[44:59]
    s_waitcnt lgkmcnt(8)
    v_mfma_f32_32x32x16_bf16 v[44:59], v[20:23], v[196:199], v[44:59]
    s_waitcnt lgkmcnt(6)
    v_mfma_f32_32x32x16_bf16 v[44:59], v[24:27], v[200:203], v[44:59]
    s_waitcnt lgkmcnt(4)
    v_mfma_f32_32x32x16_bf16 v[44:59], v[28:31], v[204:207], v[44:59]
    s_waitcnt lgkmcnt(2)
    v_mfma_f32_32x32x16_bf16 v[44:59], v[32:35], v[208:211], v[44:59]
    s_waitcnt lgkmcnt(0)
    v_mfma_f32_32x32x16_bf16 v[44:59], v[36:39], v[212:215], v[44:59]
    s_mov_b32 s60, 1040356334
    s_nop 10
    v_max3_f32 v240, v240, v44, v45
    v_max3_f32 v240, v240, v46, v47
    v_mov_b32 v88, v240
    s_nop 1
    v_permlane32_swap_b32 v240, v88
    v_max_f32 v240, v240, v88
    v_mul_f32 v240, s60, v240
    v_fma_f32 v224, v224, s60, -v240
    v_fma_f32 v225, v225, s60, -v240
    v_fma_f32 v226, v226, s60, -v240
    v_fma_f32 v227, v227, s60, -v240
    v_fma_f32 v228, v228, s60, -v240
    v_fma_f32 v229, v229, s60, -v240
    v_fma_f32 v230, v230, s60, -v240
    v_fma_f32 v231, v231, s60, -v240
    v_fma_f32 v232, v232, s60, -v240
    v_fma_f32 v233, v233, s60, -v240
    v_fma_f32 v234, v234, s60, -v240
    v_fma_f32 v235, v235, s60, -v240
    v_fma_f32 v236, v236, s60, -v240
    v_fma_f32 v237, v237, s60, -v240
    v_fma_f32 v238, v238, s60, -v240
    v_fma_f32 v239, v239, s60, -v240
    v_fma_f32 v44, v44, s60, -v240
    v_fma_f32 v45, v45, s60, -v240
    v_fma_f32 v46, v46, s60, -v240
    v_fma_f32 v47, v47, s60, -v240
    v_exp_f32 v224, v224
    v_exp_f32 v225, v225
    v_exp_f32 v226, v226
    v_exp_f32 v227, v227
    v_exp_f32 v228, v228
    v_exp_f32 v229, v229
    v_exp_f32 v230, v230
    v_exp_f32 v231, v231
    v_exp_f32 v232, v232
    v_exp_f32 v233, v233
    v_exp_f32 v234, v234
    v_exp_f32 v235, v235
    v_exp_f32 v236, v236
    v_exp_f32 v237, v237
    v_exp_f32 v238, v238
    v_exp_f32 v239, v239
    v_exp_f32 v44, v44
    v_exp_f32 v45, v45
    v_exp_f32 v46, v46
    v_exp_f32 v47, v47
    s_nop 0
    v_add_f32 v240, v224, v225
    v_add_f32 v240, v240, v226
    v_add_f32 v240, v240, v227
    v_add_f32 v240, v240, v228
    v_add_f32 v240, v240, v229
    v_add_f32 v240, v240, v230
    v_add_f32 v240, v240, v231
    v_add_f32 v240, v240, v232
    v_add_f32 v240, v240, v233
    v_add_f32 v240, v240, v234
    v_add_f32 v240, v240, v235
    v_add_f32 v240, v240, v236
    v_add_f32 v240, v240, v237
    v_add_f32 v240, v240, v238
    v_add_f32 v240, v240, v239
    v_add_f32 v240, v240, v44
    v_add_f32 v240, v240, v45
    v_add_f32 v240, v240, v46
    v_add_f32 v240, v240, v47
    v_mov_b32 v88, v240
    s_nop 1
    v_permlane32_swap_b32 v240, v88
    v_add_f32 v240, v240, v88
    v_rcp_f32 v240, v240
    s_nop 0
    v_mul_f32 v224, v224, v240
    v_mul_f32 v225, v225, v240
    v_mul_f32 v226, v226, v240
    v_mul_f32 v227, v227, v240
    v_mul_f32 v228, v228, v240
    v_mul_f32 v229, v229, v240
    v_mul_f32 v230, v230, v240
    v_mul_f32 v231, v231, v240
    v_mul_f32 v232, v232, v240
    v_mul_f32 v233, v233, v240
    v_mul_f32 v234, v234, v240
    v_mul_f32 v235, v235, v240
    v_mul_f32 v236, v236, v240
    v_mul_f32 v237, v237, v240
    v_mul_f32 v238, v238, v240
    v_mul_f32 v239, v239, v240
    v_mul_f32 v44, v44, v240
    v_mul_f32 v45, v45, v240
    v_mul_f32 v46, v46, v240
    v_mul_f32 v47, v47, v240
    v_cvt_pk_bf16_f32 v60, v224, v225
    v_cvt_pk_bf16_f32 v61, v226, v227
    v_cvt_pk_bf16_f32 v62, v228, v229
    v_cvt_pk_bf16_f32 v63, v230, v231
    v_cvt_pk_bf16_f32 v64, v232, v233
    v_cvt_pk_bf16_f32 v65, v234, v235
    v_cvt_pk_bf16_f32 v66, v236, v237
    v_cvt_pk_bf16_f32 v67, v238, v239
    v_cvt_pk_bf16_f32 v68, v44, v45
    v_cvt_pk_bf16_f32 v69, v46, v47
    s_waitcnt vmcnt(0)
    s_nop 0
    v_mfma_f32_32x32x16_bf16 v[72:87], v[216:219], v[60:63], 0
    v_mfma_f32_32x32x16_bf16 v[72:87], v[220:223], v[64:67], v[72:87]
    v_mfma_f32_32x32x16_bf16 v[72:87], v[40:43], v[68:71], v[72:87]
    s_lshl_b32 s60, s84, 13
    s_add_u32 s60, s60, 69206016
    s_nop 10
    v_cvt_pk_bf16_f32 v72, v72, v73
    v_cvt_pk_bf16_f32 v73, v74, v75
    v_cvt_pk_bf16_f32 v74, v76, v77
    v_cvt_pk_bf16_f32 v75, v78, v79
    v_cvt_pk_bf16_f32 v76, v80, v81
    v_cvt_pk_bf16_f32 v77, v82, v83
    v_cvt_pk_bf16_f32 v78, v84, v85
    v_cvt_pk_bf16_f32 v79, v86, v87
    buffer_store_dwordx4 v[72:75], v5, s[52:55], s60 offen sc1
    buffer_store_dwordx4 v[76:79], v5, s[52:55], s60 offen offset:1024 sc1
    s_lshl_b32 s60, s84, 7
    s_add_u32 s60, s60, 86638592
    v_mov_b32 v251, 1
    s_waitcnt vmcnt(0)
    s_barrier
    s_cmp_lg_u32 s56, 0
    s_cbranch_scc1 M_xf
    s_mov_b64 exec, 1
    buffer_store_dword v251, off, s[52:55], s60 sc1
    s_mov_b64 exec, -1
M_xf:
    s_add_u32 s81, s81, 7
    s_branch M_evx
M_evO:
    s_cmp_lt_u32 s82, 62
    s_cbranch_scc1 M_evO2
    s_lshl_b32 s60, s82, 18
    s_add_u32 s60, s60, 69206016
    v_lshrrev_b32 v142, 3, v1
    v_lshlrev_b32 v140, 9, v142
    v_and_b32 v142, 7, v1
    v_lshl_add_u32 v140, v142, 4, v140
    s_lshl_b32 s61, s59, 7
    s_lshl_b32 s62, s56, 16
    s_add_u32 s61, s61, s62
    s_add_u32 s60, s60, s61
    s_lshl_b32 s62, s56, 14
    s_add_u32 s62, s62, 32768
    s_add_u32 m0, s62, 0
    s_nop 0
    buffer_load_dwordx4 v140, s[52:55], s60 offen sc1 lds
    s_add_u32 s60, s60, 4096
    s_add_u32 m0, s62, 1024
    s_nop 0
    buffer_load_dwordx4 v140, s[52:55], s60 offen sc1 lds
    s_add_u32 s60, s60, 4096
    s_add_u32 m0, s62, 2048
    s_nop 0
    buffer_load_dwordx4 v140, s[52:55], s60 offen sc1 lds
    s_add_u32 s60, s60, 4096
    s_add_u32 m0, s62, 3072
    s_nop 0
    buffer_load_dwordx4 v140, s[52:55], s60 offen sc1 lds
    s_add_u32 s60, s60, 4096
    s_add_u32 m0, s62, 4096
    s_nop 0
    buffer_load_dwordx4 v140, s[52:55], s60 offen sc1 lds
    s_add_u32 s60, s60, 4096
    s_add_u32 m0, s62, 5120
    s_nop 0
    buffer_load_dwordx4 v140, s[52:55], s60 offen sc1 lds
    s_add_u32 s60, s60, 4096
    s_add_u32 m0, s62, 6144
    s_nop 0
    buffer_load_dwordx4 v140, s[52:55], s60 offen sc1 lds
    s_add_u32 s60, s60, 4096
    s_add_u32 m0, s62, 7168
    s_nop 0
    buffer_load_dwordx4 v140, s[52:55], s60 offen sc1 lds
    s_add_u32 s60, s60, 4096
    s_add_u32 m0, s62, 8192
    s_nop 0
    buffer_load_dwordx4 v140, s[52:55], s60 offen sc1 lds
    s_add_u32 s60, s60, 4096
    s_add_u32 m0, s62, 9216
    s_nop 0
    buffer_load_dwordx4 v140, s[52:55], s60 offen sc1 lds
    s_add_u32 s60, s60, 4096
    s_add_u32 m0, s62, 10240
    s_nop 0
    buffer_load_dwordx4 v140, s[52:55], s60 offen sc1 lds
    s_add_u32 s60, s60, 4096
    s_add_u32 m0, s62, 11264
    s_nop 0
    buffer_load_dwordx4 v140, s[52:55], s60 offen sc1 lds
    s_add_u32 s60, s60, 4096
    s_add_u32 m0, s62, 12288
    s_nop 0
    buffer_load_dwordx4 v140, s[52:55], s60 offen sc1 lds
    s_add_u32 s60, s60, 4096
    s_add_u32 m0, s62, 13312
    s_nop 0
    buffer_load_dwordx4 v140, s[52:55], s60 offen sc1 lds
    s_add_u32 s60, s60, 4096
    s_add_u32 m0, s62, 14336
    s_nop 0
    buffer_load_dwordx4 v140, s[52:55], s60 offen sc1 lds
    s_add_u32 s60, s60, 4096
    s_add_u32 m0, s62, 15360
    s_nop 0
    buffer_load_dwordx4 v140, s[52:55], s60 offen sc1 lds
    s_add_u32 s60, s60, 4096
    v_lshrrev_b32 v141, 5, v1
    v_lshlrev_b32 v141, 7, v141
    v_lshl_add_u32 v141, v142, 4, v141
    v_add_u32 v141, s62, v141
    s_mul_i32 s61, s59, 18432
    v_add_u32 v162, s61, v162
    v_bfe_u32 v142, v1, 3, 2
    v_cmp_eq_u32 vcc, 0, v142
    v_mov_b32 v142, 0x40000000
    s_nop 0
    v_cndmask_b32 v162, v142, v162, vcc
    s_waitcnt vmcnt(15)
    ds_read_b128 v[8:11], v141 offset:0
    ds_read_b128 v[12:15], v141 offset:256
    ds_read_b128 v[16:19], v141 offset:512
    ds_read_b128 v[20:23], v141 offset:768
    s_waitcnt vmcnt(14)
    ds_read_b128 v[24:27], v141 offset:1024
    ds_read_b128 v[28:31], v141 offset:1280
    ds_read_b128 v[32:35], v141 offset:1536
    ds_read_b128 v[36:39], v141 offset:1792
    s_waitcnt lgkmcnt(7)
    v_mfma_f32_32x32x16_bf16 v[168:183], a[0:3], v[8:11], 0
    s_waitcnt vmcnt(13)
    ds_read_b128 v[8:11], v141 offset:2048
    s_waitcnt lgkmcnt(7)
    v_mfma_f32_32x32x16_bf16 v[168:183], a[4:7], v[12:15], v[168:183]
    ds_read_b128 v[12:15], v141 offset:2304
    s_waitcnt lgkmcnt(7)
    v_mfma_f32_32x32x16_bf16 v[168:183], a[8:11], v[16:19], v[168:183]
    ds_read_b128 v[16:19], v141 offset:2560
    s_waitcnt lgkmcnt(7)
    v_mfma_f32_32x32x16_bf16 v[168:183], a[12:15], v[20:23], v[168:183]
    ds_read_b128 v[20:23], v141 offset:2816
    s_waitcnt lgkmcnt(7)
    v_mfma_f32_32x32x16_bf16 v[168:183], a[16:19], v[24:27], v[168:183]
    s_waitcnt vmcnt(12)
    ds_read_b128 v[24:27], v141 offset:3072
    s_waitcnt lgkmcnt(7)
    v_mfma_f32_32x32x16_bf16 v[168:183], a[20:23], v[28:31], v[168:183]
    ds_read_b128 v[28:31], v141 offset:3328
    s_waitcnt lgkmcnt(7)
    v_mfma_f32_32x32x16_bf16 v[168:183], a[24:27], v[32:35], v[168:183]
    ds_read_b128 v[32:35], v141 offset:3584
    s_waitcnt lgkmcnt(7)
    v_mfma_f32_32x32x16_bf16 v[168:183], a[28:31], v[36:39], v[168:183]
    ds_read_b128 v[36:39], v141 offset:3840
    s_waitcnt lgkmcnt(7)
    v_mfma_f32_32x32x16_bf16 v[168:183], a[32:35], v[8:11], v[168:183]
    s_waitcnt vmcnt(11)
    ds_read_b128 v[8:11], v141 offset:4096
    s_waitcnt lgkmcnt(7)
    v_mfma_f32_32x32x16_bf16 v[168:183], a[36:39], v[12:15], v[168:183]
    ds_read_b128 v[12:15], v141 offset:4352
    s_waitcnt lgkmcnt(7)
    v_mfma_f32_32x32x16_bf16 v[168:183], a[40:43], v[16:19], v[168:183]
    ds_read_b128 v[16:19], v141 offset:4608
    s_waitcnt lgkmcnt(7)
    v_mfma_f32_32x32x16_bf16 v[168:183], a[44:47], v[20:23], v[168:183]
    ds_read_b128 v[20:23], v141 offset:4864
    s_waitcnt lgkmcnt(7)
    v_mfma_f32_32x32x16_bf16 v[168:183], a[48:51], v[24:27], v[168:183]
    s_waitcnt vmcnt(10)
    ds_read_b128 v[24:27], v141 offset:5120
    s_waitcnt lgkmcnt(7)
    v_mfma_f32_32x32x16_bf16 v[168:183], a[52:55], v[28:31], v[168:183]
    ds_read_b128 v[28:31], v141 offset:5376
    s_waitcnt lgkmcnt(7)
    v_mfma_f32_32x32x16_bf16 v[168:183], a[56:59], v[32:35], v[168:183]
    ds_read_b128 v[32:35], v141 offset:5632
    s_waitcnt lgkmcnt(7)
    v_mfma_f32_32x32x16_bf16 v[168:183], a[60:63], v[36:39], v[168:183]
    ds_read_b128 v[36:39], v141 offset:5888
    s_waitcnt lgkmcnt(7)
    v_mfma_f32_32x32x16_bf16 v[168:183], a[64:67], v[8:11], v[168:183]
    s_waitcnt vmcnt(9)
    ds_read_b128 v[8:11], v141 offset:6144
    s_waitcnt lgkmcnt(7)
    v_mfma_f32_32x32x16_bf16 v[168:183], a[68:71], v[12:15], v[168:183]
    ds_read_b128 v[12:15], v141 offset:6400
    s_waitcnt lgkmcnt(7)
    v_mfma_f32_32x32x16_bf16 v[168:183], a[72:75], v[16:19], v[168:183]
    ds_read_b128 v[16:19], v141 offset:6656
    s_waitcnt lgkmcnt(7)
    v_mfma_f32_32x32x16_bf16 v[168:183], a[76:79], v[20:23], v[168:183]
    ds_read_b128 v[20:23], v141 offset:6912
    s_waitcnt lgkmcnt(7)
    v_mfma_f32_32x32x16_bf16 v[168:183], a[80:83], v[24:27], v[168:183]
    s_waitcnt vmcnt(8)
    ds_read_b128 v[24:27], v141 offset:7168
    s_waitcnt lgkmcnt(7)
    v_mfma_f32_32x32x16_bf16 v[168:183], a[84:87], v[28:31], v[168:183]
    ds_read_b128 v[28:31], v141 offset:7424
    s_waitcnt lgkmcnt(7)
    v_mfma_f32_32x32x16_bf16 v[168:183], a[88:91], v[32:35], v[168:183]
    ds_read_b128 v[32:35], v141 offset:7680
    s_waitcnt lgkmcnt(7)
    v_mfma_f32_32x32x16_bf16 v[168:183], a[92:95], v[36:39], v[168:183]
    ds_read_b128 v[36:39], v141 offset:7936
    s_waitcnt lgkmcnt(7)
    v_mfma_f32_32x32x16_bf16 v[168:183], a[96:99], v[8:11], v[168:183]
    s_waitcnt vmcnt(7)
    ds_read_b128 v[8:11], v141 offset:8192
    s_waitcnt lgkmcnt(7)
    v_mfma_f32_32x32x16_bf16 v[168:183], a[100:103], v[12:15], v[168:183]
    ds_read_b128 v[12:15], v141 offset:8448
    s_waitcnt lgkmcnt(7)
    v_mfma_f32_32x32x16_bf16 v[168:183], a[104:107], v[16:19], v[168:183]
    ds_read_b128 v[16:19], v141 offset:8704
    s_waitcnt lgkmcnt(7)
    v_mfma_f32_32x32x16_bf16 v[168:183], a[108:111], v[20:23], v[168:183]
    ds_read_b128 v[20:23], v141 offset:8960
    s_waitcnt lgkmcnt(7)
    v_mfma_f32_32x32x16_bf16 v[168:183], a[112:115], v[24:27], v[168:183]
    s_waitcnt vmcnt(6)
    ds_read_b128 v[24:27], v141 offset:9216
    s_waitcnt lgkmcnt(7)
    v_mfma_f32_32x32x16_bf16 v[168:183], a[116:119], v[28:31], v[168:183]
    ds_read_b128 v[28:31], v141 offset:9472
    s_waitcnt lgkmcnt(7)
    v_mfma_f32_32x32x16_bf16 v[168:183], a[120:123], v[32:35], v[168:183]
    ds_read_b128 v[32:35], v141 offset:9728
    s_waitcnt lgkmcnt(7)
    v_mfma_f32_32x32x16_bf16 v[168:183], a[124:127], v[36:39], v[168:183]
    ds_read_b128 v[36:39], v141 offset:9984
    s_waitcnt lgkmcnt(7)
    v_mfma_f32_32x32x16_bf16 v[168:183], a[128:131], v[8:11], v[168:183]
    s_waitcnt vmcnt(5)
    ds_read_b128 v[8:11], v141 offset:10240
    s_waitcnt lgkmcnt(7)
    v_mfma_f32_32x32x16_bf16 v[168:183], a[132:135], v[12:15], v[168:183]
    ds_read_b128 v[12:15], v141 offset:10496
    s_waitcnt lgkmcnt(7)
    v_mfma_f32_32x32x16_bf16 v[168:183], a[136:139], v[16:19], v[168:183]
    ds_read_b128 v[16:19], v141 offset:10752
    s_waitcnt lgkmcnt(7)
    v_mfma_f32_32x32x16_bf16 v[168:183], a[140:143], v[20:23], v[168:183]
    ds_read_b128 v[20:23], v141 offset:11008
    s_waitcnt lgkmcnt(7)
    v_mfma_f32_32x32x16_bf16 v[168:183], a[144:147], v[24:27], v[168:183]
    s_waitcnt vmcnt(4)
    ds_read_b128 v[24:27], v141 offset:11264
    s_waitcnt lgkmcnt(7)
    v_mfma_f32_32x32x16_bf16 v[168:183], a[148:151], v[28:31], v[168:183]
    ds_read_b128 v[28:31], v141 offset:11520
    s_waitcnt lgkmcnt(7)
    v_mfma_f32_32x32x16_bf16 v[168:183], a[152:155], v[32:35], v[168:183]
    ds_read_b128 v[32:35], v141 offset:11776
    s_waitcnt lgkmcnt(7)
    v_mfma_f32_32x32x16_bf16 v[168:183], a[156:159], v[36:39], v[168:183]
    ds_read_b128 v[36:39], v141 offset:12032
    s_waitcnt lgkmcnt(7)
    v_mfma_f32_32x32x16_bf16 v[168:183], a[160:163], v[8:11], v[168:183]
    s_waitcnt vmcnt(3)
    ds_read_b128 v[8:11], v141 offset:12288
    s_waitcnt lgkmcnt(7)
    v_mfma_f32_32x32x16_bf16 v[168:183], a[164:167], v[12:15], v[168:183]
    ds_read_b128 v[12:15], v141 offset:12544
    s_waitcnt lgkmcnt(7)
    v_mfma_f32_32x32x16_bf16 v[168:183], a[168:171], v[16:19], v[168:183]
    ds_read_b128 v[16:19], v141 offset:12800
    s_waitcnt lgkmcnt(7)
    v_mfma_f32_32x32x16_bf16 v[168:183], a[172:175], v[20:23], v[168:183]
    ds_read_b128 v[20:23], v141 offset:13056
    s_waitcnt lgkmcnt(7)
    v_mfma_f32_32x32x16_bf16 v[168:183], a[176:179], v[24:27], v[168:183]
    s_waitcnt vmcnt(2)
    ds_read_b128 v[24:27], v141 offset:13312
    s_waitcnt lgkmcnt(7)
    v_mfma_f32_32x32x16_bf16 v[168:183], a[180:183], v[28:31], v[168:183]
    ds_read_b128 v[28:31], v141 offset:13568
    s_waitcnt lgkmcnt(7)
    v_mfma_f32_32x32x16_bf16 v[168:183], a[184:187], v[32:35], v[168:183]
    ds_read_b128 v[32:35], v141 offset:13824
    s_waitcnt lgkmcnt(7)
    v_mfma_f32_32x32x16_bf16 v[168:183], a[188:191], v[36:39], v[168:183]
    ds_read_b128 v[36:39], v141 offset:14080
    s_waitcnt lgkmcnt(7)
    v_mfma_f32_32x32x16_bf16 v[168:183], a[192:195], v[8:11], v[168:183]
    s_waitcnt vmcnt(1)
    ds_read_b128 v[8:11], v141 offset:14336
    s_waitcnt lgkmcnt(7)
    v_mfma_f32_32x32x16_bf16 v[168:183], a[196:199], v[12:15], v[168:183]
    ds_read_b128 v[12:15], v141 offset:14592
    s_waitcnt lgkmcnt(7)
    v_mfma_f32_32x32x16_bf16 v[168:183], a[200:203], v[16:19], v[168:183]
    ds_read_b128 v[16:19], v141 offset:14848
    s_waitcnt lgkmcnt(7)
    v_mfma_f32_32x32x16_bf16 v[168:183], a[204:207], v[20:23], v[168:183]
    ds_read_b128 v[20:23], v141 offset:15104
    s_waitcnt lgkmcnt(7)
    v_mfma_f32_32x32x16_bf16 v[168:183], a[208:211], v[24:27], v[168:183]
    s_waitcnt vmcnt(0)
    ds_read_b128 v[24:27], v141 offset:15360
    s_waitcnt lgkmcnt(7)
    v_mfma_f32_32x32x16_bf16 v[168:183], a[212:215], v[28:31], v[168:183]
    ds_read_b128 v[28:31], v141 offset:15616
    s_waitcnt lgkmcnt(7)
    v_mfma_f32_32x32x16_bf16 v[168:183], a[216:219], v[32:35], v[168:183]
    ds_read_b128 v[32:35], v141 offset:15872
    s_waitcnt lgkmcnt(7)
    v_mfma_f32_32x32x16_bf16 v[168:183], a[220:223], v[36:39], v[168:183]
    ds_read_b128 v[36:39], v141 offset:16128
    s_waitcnt lgkmcnt(7)
    v_mfma_f32_32x32x16_bf16 v[168:183], a[224:227], v[8:11], v[168:183]
    s_waitcnt lgkmcnt(6)
    v_mfma_f32_32x32x16_bf16 v[168:183], a[228:231], v[12:15], v[168:183]
    s_waitcnt lgkmcnt(5)
    v_mfma_f32_32x32x16_bf16 v[168:183], a[232:235], v[16:19], v[168:183]
    s_waitcnt lgkmcnt(4)
    v_mfma_f32_32x32x16_bf16 v[168:183], a[236:239], v[20:23], v[168:183]
    s_waitcnt lgkmcnt(3)
    v_mfma_f32_32x32x16_bf16 v[168:183], a[240:243], v[24:27], v[168:183]
    s_waitcnt lgkmcnt(2)
    v_mfma_f32_32x32x16_bf16 v[168:183], a[244:247], v[28:31], v[168:183]
    s_waitcnt lgkmcnt(1)
    v_mfma_f32_32x32x16_bf16 v[168:183], a[248:251], v[32:35], v[168:183]
    s_waitcnt lgkmcnt(0)
    v_mfma_f32_32x32x16_bf16 v[168:183], a[252:255], v[36:39], v[168:183]
    v_add_u32 v136, s83, v160
    v_add_u32 v137, s83, v161
    s_xor_b32 s83, s83, 16384
    s_mul_i32 s60, s82, 73728
    s_nop 8
    ds_write_b128 v136, v[168:171] offset:0
    ds_write_b128 v136, v[172:175] offset:1024
    ds_write_b128 v136, v[176:179] offset:2048
    ds_write_b128 v136, v[180:183] offset:3072
    s_waitcnt lgkmcnt(0)
    s_barrier
    ds_read_b128 v[168:171], v137 offset:0
    ds_read_b128 v[172:175], v137 offset:4096
    ds_read_b128 v[176:179], v137 offset:8192
    ds_read_b128 v[180:183], v137 offset:12288
    s_waitcnt lgkmcnt(2)
    v_pk_add_f32 v[168:169], v[168:169], v[172:173]
    v_pk_add_f32 v[170:171], v[170:171], v[174:175]
    s_waitcnt lgkmcnt(0)
    v_pk_add_f32 v[176:177], v[176:177], v[180:181]
    v_pk_add_f32 v[178:179], v[178:179], v[182:183]
    v_pk_add_f32 v[168:169], v[168:169], v[176:177]
    v_pk_add_f32 v[170:171], v[170:171], v[178:179]
    v_cvt_pk_bf16_f32 v168, v168, v169
    v_cvt_pk_bf16_f32 v169, v170, v171
    buffer_store_dwordx2 v[168:169], v162, s[44:47], s60 offen
    s_branch M_evO3
M_evO2:
    s_lshl_b32 s60, s82, 18
    s_add_u32 s60, s60, 69206016
    buffer_load_dwordx4 v[8:11], v163, s[52:55], s60 offen offset:0 sc1
    buffer_load_dwordx4 v[12:15], v163, s[52:55], s60 offen offset:1024 sc1
    buffer_load_dwordx4 v[16:19], v163, s[52:55], s60 offen offset:2048 sc1
    buffer_load_dwordx4 v[20:23], v163, s[52:55], s60 offen offset:3072 sc1
    s_add_u32 s60, s60, 4096
    buffer_load_dwordx4 v[24:27], v163, s[52:55], s60 offen offset:0 sc1
    buffer_load_dwordx4 v[28:31], v163, s[52:55], s60 offen offset:1024 sc1
    buffer_load_dwordx4 v[32:35], v163, s[52:55], s60 offen offset:2048 sc1
    buffer_load_dwordx4 v[36:39], v163, s[52:55], s60 offen offset:3072 sc1
    s_add_u32 s60, s60, 4096
    buffer_load_dwordx4 v[40:43], v163, s[52:55], s60 offen offset:0 sc1
    buffer_load_dwordx4 v[44:47], v163, s[52:55], s60 offen offset:1024 sc1
    buffer_load_dwordx4 v[48:51], v163, s[52:55], s60 offen offset:2048 sc1
    buffer_load_dwordx4 v[52:55], v163, s[52:55], s60 offen offset:3072 sc1
    s_add_u32 s60, s60, 4096
    buffer_load_dwordx4 v[56:59], v163, s[52:55], s60 offen offset:0 sc1
    buffer_load_dwordx4 v[60:63], v163, s[52:55], s60 offen offset:1024 sc1
    buffer_load_dwordx4 v[64:67], v163, s[52:55], s60 offen offset:2048 sc1
    buffer_load_dwordx4 v[68:71], v163, s[52:55], s60 offen offset:3072 sc1
    s_add_u32 s60, s60, 4096
    buffer_load_dwordx4 v[72:75], v163, s[52:55], s60 offen offset:0 sc1
    buffer_load_dwordx4 v[76:79], v163, s[52:55], s60 offen offset:1024 sc1
    buffer_load_dwordx4 v[80:83], v163, s[52:55], s60 offen offset:2048 sc1
    buffer_load_dwordx4 v[84:87], v163, s[52:55], s60 offen offset:3072 sc1
    s_add_u32 s60, s60, 4096
    buffer_load_dwordx4 v[88:91], v163, s[52:55], s60 offen offset:0 sc1
    buffer_load_dwordx4 v[92:95], v163, s[52:55], s60 offen offset:1024 sc1
    buffer_load_dwordx4 v[96:99], v163, s[52:55], s60 offen offset:2048 sc1
    buffer_load_dwordx4 v[100:103], v163, s[52:55], s60 offen offset:3072 sc1
    s_add_u32 s60, s60, 4096
    buffer_load_dwordx4 v[104:107], v163, s[52:55], s60 offen offset:0 sc1
    buffer_load_dwordx4 v[108:111], v163, s[52:55], s60 offen offset:1024 sc1
    buffer_load_dwordx4 v[112:115], v163, s[52:55], s60 offen offset:2048 sc1
    buffer_load_dwordx4 v[116:119], v163, s[52:55], s60 offen offset:3072 sc1
    s_add_u32 s60, s60, 4096
    buffer_load_dwordx4 v[120:123], v163, s[52:55], s60 offen offset:0 sc1
    buffer_load_dwordx4 v[124:127], v163, s[52:55], s60 offen offset:1024 sc1
    buffer_load_dwordx4 v[128:131], v163, s[52:55], s60 offen offset:2048 sc1
    buffer_load_dwordx4 v[132:135], v163, s[52:55], s60 offen offset:3072 sc1
    s_waitcnt vmcnt(31)
    v_mfma_f32_32x32x16_bf16 v[168:183], a[0:3], v[8:11], 0
    s_add_u32 s60, s60, 4096
    buffer_load_dwordx4 v[8:11], v163, s[52:55], s60 offen offset:0 sc1
    s_waitcnt vmcnt(31)
    v_mfma_f32_32x32x16_bf16 v[168:183], a[4:7], v[12:15], v[168:183]
    buffer_load_dwordx4 v[12:15], v163, s[52:55], s60 offen offset:1024 sc1
    s_waitcnt vmcnt(31)
    v_mfma_f32_32x32x16_bf16 v[168:183], a[8:11], v[16:19], v[168:183]
    buffer_load_dwordx4 v[16:19], v163, s[52:55], s60 offen offset:2048 sc1
    s_waitcnt vmcnt(31)
    v_mfma_f32_32x32x16_bf16 v[168:183], a[12:15], v[20:23], v[168:183]
    buffer_load_dwordx4 v[20:23], v163, s[52:55], s60 offen offset:3072 sc1
    s_waitcnt vmcnt(31)
    v_mfma_f32_32x32x16_bf16 v[168:183], a[16:19], v[24:27], v[168:183]
    s_add_u32 s60, s60, 4096
    buffer_load_dwordx4 v[24:27], v163, s[52:55], s60 offen offset:0 sc1
    s_waitcnt vmcnt(31)
    v_mfma_f32_32x32x16_bf16 v[168:183], a[20:23], v[28:31], v[168:183]
    buffer_load_dwordx4 v[28:31], v163, s[52:55], s60 offen offset:1024 sc1
    s_waitcnt vmcnt(31)
    v_mfma_f32_32x32x16_bf16 v[168:183], a[24:27], v[32:35], v[168:183]
    buffer_load_dwordx4 v[32:35], v163, s[52:55], s60 offen offset:2048 sc1
    s_waitcnt vmcnt(31)
    v_mfma_f32_32x32x16_bf16 v[168:183], a[28:31], v[36:39], v[168:183]
    buffer_load_dwordx4 v[36:39], v163, s[52:55], s60 offen offset:3072 sc1
    s_waitcnt vmcnt(31)
    v_mfma_f32_32x32x16_bf16 v[168:183], a[32:35], v[40:43], v[168:183]
    s_add_u32 s60, s60, 4096
    buffer_load_dwordx4 v[40:43], v163, s[52:55], s60 offen offset:0 sc1
    s_waitcnt vmcnt(31)
    v_mfma_f32_32x32x16_bf16 v[168:183], a[36:39], v[44:47], v[168:183]
    buffer_load_dwordx4 v[44:47], v163, s[52:55], s60 offen offset:1024 sc1
    s_waitcnt vmcnt(31)
    v_mfma_f32_32x32x16_bf16 v[168:183], a[40:43], v[48:51], v[168:183]
    buffer_load_dwordx4 v[48:51], v163, s[52:55], s60 offen offset:2048 sc1
    s_waitcnt vmcnt(31)
    v_mfma_f32_32x32x16_bf16 v[168:183], a[44:47], v[52:55], v[168:183]
    buffer_load_dwordx4 v[52:55], v163, s[52:55], s60 offen offset:3072 sc1
    s_waitcnt vmcnt(31)
    v_mfma_f32_32x32x16_bf16 v[168:183], a[48:51], v[56:59], v[168:183]
    s_add_u32 s60, s60, 4096
    buffer_load_dwordx4 v[56:59], v163, s[52:55], s60 offen offset:0 sc1
    s_waitcnt vmcnt(31)
    v_mfma_f32_32x32x16_bf16 v[168:183], a[52:55], v[60:63], v[168:183]
    buffer_load_dwordx4 v[60:63], v163, s[52:55], s60 offen offset:1024 sc1
    s_waitcnt vmcnt(31)
    v_mfma_f32_32x32x16_bf16 v[168:183], a[56:59], v[64:67], v[168:183]
    buffer_load_dwordx4 v[64:67], v163, s[52:55], s60 offen offset:2048 sc1
    s_waitcnt vmcnt(31)
    v_mfma_f32_32x32x16_bf16 v[168:183], a[60:63], v[68:71], v[168:183]
    buffer_load_dwordx4 v[68:71], v163, s[52:55], s60 offen offset:3072 sc1
    s_waitcnt vmcnt(31)
    v_mfma_f32_32x32x16_bf16 v[168:183], a[64:67], v[72:75], v[168:183]
    s_add_u32 s60, s60, 4096
    buffer_load_dwordx4 v[72:75], v163, s[52:55], s60 offen offset:0 sc1
    s_waitcnt vmcnt(31)
    v_mfma_f32_32x32x16_bf16 v[168:183], a[68:71], v[76:79], v[168:183]
    buffer_load_dwordx4 v[76:79], v163, s[52:55], s60 offen offset:1024 sc1
    s_waitcnt vmcnt(31)
    v_mfma_f32_32x32x16_bf16 v[168:183], a[72:75], v[80:83], v[168:183]
    buffer_load_dwordx4 v[80:83], v163, s[52:55], s60 offen offset:2048 sc1
    s_waitcnt vmcnt(31)
    v_mfma_f32_32x32x16_bf16 v[168:183], a[76:79], v[84:87], v[168:183]
    buffer_load_dwordx4 v[84:87], v163, s[52:55], s60 offen offset:3072 sc1
    s_waitcnt vmcnt(31)
    v_mfma_f32_32x32x16_bf16 v[168:183], a[80:83], v[88:91], v[168:183]
    s_add_u32 s60, s60, 4096
    buffer_load_dwordx4 v[88:91], v163, s[52:55], s60 offen offset:0 sc1
    s_waitcnt vmcnt(31)
    v_mfma_f32_32x32x16_bf16 v[168:183], a[84:87], v[92:95], v[168:183]
    buffer_load_dwordx4 v[92:95], v163, s[52:55], s60 offen offset:1024 sc1
    s_waitcnt vmcnt(31)
    v_mfma_f32_32x32x16_bf16 v[168:183], a[88:91], v[96:99], v[168:183]
    buffer_load_dwordx4 v[96:99], v163, s[52:55], s60 offen offset:2048 sc1
    s_waitcnt vmcnt(31)
    v_mfma_f32_32x32x16_bf16 v[168:183], a[92:95], v[100:103], v[168:183]
    buffer_load_dwordx4 v[100:103], v163, s[52:55], s60 offen offset:3072 sc1
    s_waitcnt vmcnt(31)
    v_mfma_f32_32x32x16_bf16 v[168:183], a[96:99], v[104:107], v[168:183]
    s_add_u32 s60, s60, 4096
    buffer_load_dwordx4 v[104:107], v163, s[52:55], s60 offen offset:0 sc1
    s_waitcnt vmcnt(31)
    v_mfma_f32_32x32x16_bf16 v[168:183], a[100:103], v[108:111], v[168:183]
    buffer_load_dwordx4 v[108:111], v163, s[52:55], s60 offen offset:1024 sc1
    s_waitcnt vmcnt(31)
    v_mfma_f32_32x32x16_bf16 v[168:183], a[104:107], v[112:115], v[168:183]
    buffer_load_dwordx4 v[112:115], v163, s[52:55], s60 offen offset:2048 sc1
    s_waitcnt vmcnt(31)
    v_mfma_f32_32x32x16_bf16 v[168:183], a[108:111], v[116:119], v[168:183]
    buffer_load_dwordx4 v[116:119], v163, s[52:55], s60 offen offset:3072 sc1
    s_waitcnt vmcnt(31)
    v_mfma_f32_32x32x16_bf16 v[168:183], a[112:115], v[120:123], v[168:183]
    s_add_u32 s60, s60, 4096
    buffer_load_dwordx4 v[120:123], v163, s[52:55], s60 offen offset:0 sc1
    s_waitcnt vmcnt(31)
    v_mfma_f32_32x32x16_bf16 v[168:183], a[116:119], v[124:127], v[168:183]
    buffer_load_dwordx4 v[124:127], v163, s[52:55], s60 offen offset:1024 sc1
    s_waitcnt vmcnt(31)
    v_mfma_f32_32x32x16_bf16 v[168:183], a[120:123], v[128:131], v[168:183]
    buffer_load_dwordx4 v[128:131], v163, s[52:55], s60 offen offset:2048 sc1
    s_waitcnt vmcnt(31)
    v_mfma_f32_32x32x16_bf16 v[168:183], a[124:127], v[132:135], v[168:183]
    buffer_load_dwordx4 v[132:135], v163, s[52:55], s60 offen offset:3072 sc1
    s_waitcnt vmcnt(31)
    v_mfma_f32_32x32x16_bf16 v[168:183], a[128:131], v[8:11], v[168:183]
    s_waitcnt vmcnt(30)
    v_mfma_f32_32x32x16_bf16 v[168:183], a[132:135], v[12:15], v[168:183]
    s_waitcnt vmcnt(29)
    v_mfma_f32_32x32x16_bf16 v[168:183], a[136:139], v[16:19], v[168:183]
    s_waitcnt vmcnt(28)
    v_mfma_f32_32x32x16_bf16 v[168:183], a[140:143], v[20:23], v[168:183]
    s_waitcnt vmcnt(27)
    v_mfma_f32_32x32x16_bf16 v[168:183], a[144:147], v[24:27], v[168:183]
    s_waitcnt vmcnt(26)
    v_mfma_f32_32x32x16_bf16 v[168:183], a[148:151], v[28:31], v[168:183]
    s_waitcnt vmcnt(25)
    v_mfma_f32_32x32x16_bf16 v[168:183], a[152:155], v[32:35], v[168:183]
    s_waitcnt vmcnt(24)
    v_mfma_f32_32x32x16_bf16 v[168:183], a[156:159], v[36:39], v[168:183]
    s_waitcnt vmcnt(23)
    v_mfma_f32_32x32x16_bf16 v[168:183], a[160:163], v[40:43], v[168:183]
    s_waitcnt vmcnt(22)
    v_mfma_f32_32x32x16_bf16 v[168:183], a[164:167], v[44:47], v[168:183]
    s_waitcnt vmcnt(21)
    v_mfma_f32_32x32x16_bf16 v[168:183], a[168:171], v[48:51], v[168:183]
    s_waitcnt vmcnt(20)
    v_mfma_f32_32x32x16_bf16 v[168:183], a[172:175], v[52:55], v[168:183]
    s_waitcnt vmcnt(19)
    v_mfma_f32_32x32x16_bf16 v[168:183], a[176:179], v[56:59], v[168:183]
    s_waitcnt vmcnt(18)
    v_mfma_f32_32x32x16_bf16 v[168:183], a[180:183], v[60:63], v[168:183]
    s_waitcnt vmcnt(17)
    v_mfma_f32_32x32x16_bf16 v[168:183], a[184:187], v[64:67], v[168:183]
    s_waitcnt vmcnt(16)
    v_mfma_f32_32x32x16_bf16 v[168:183], a[188:191], v[68:71], v[168:183]
    s_waitcnt vmcnt(15)
    v_mfma_f32_32x32x16_bf16 v[168:183], a[192:195], v[72:75], v[168:183]
    s_waitcnt vmcnt(14)
    v_mfma_f32_32x32x16_bf16 v[168:183], a[196:199], v[76:79], v[168:183]
    s_waitcnt vmcnt(13)
    v_mfma_f32_32x32x16_bf16 v[168:183], a[200:203], v[80:83], v[168:183]
    s_waitcnt vmcnt(12)
    v_mfma_f32_32x32x16_bf16 v[168:183], a[204:207], v[84:87], v[168:183]
    s_waitcnt vmcnt(11)
    v_mfma_f32_32x32x16_bf16 v[168:183], a[208:211], v[88:91], v[168:183]
    s_waitcnt vmcnt(10)
    v_mfma_f32_32x32x16_bf16 v[168:183], a[212:215], v[92:95], v[168:183]
    s_waitcnt vmcnt(9)
    v_mfma_f32_32x32x16_bf16 v[168:183], a[216:219], v[96:99], v[168:183]
    s_waitcnt vmcnt(8)
    v_mfma_f32_32x32x16_bf16 v[168:183], a[220:223], v[100:103], v[168:183]
    s_waitcnt vmcnt(7)
    v_mfma_f32_32x32x16_bf16 v[168:183], a[224:227], v[104:107], v[168:183]
    s_waitcnt vmcnt(6)
    v_mfma_f32_32x32x16_bf16 v[168:183], a[228:231], v[108:111], v[168:183]
    s_waitcnt vmcnt(5)
    v_mfma_f32_32x32x16_bf16 v[168:183], a[232:235], v[112:115], v[168:183]
    s_waitcnt vmcnt(4)
    v_mfma_f32_32x32x16_bf16 v[168:183], a[236:239], v[116:119], v[168:183]
    s_waitcnt vmcnt(3)
    v_mfma_f32_32x32x16_bf16 v[168:183], a[240:243], v[120:123], v[168:183]
    s_waitcnt vmcnt(2)
    v_mfma_f32_32x32x16_bf16 v[168:183], a[244:247], v[124:127], v[168:183]
    s_waitcnt vmcnt(1)
    v_mfma_f32_32x32x16_bf16 v[168:183], a[248:251], v[128:131], v[168:183]
    s_waitcnt vmcnt(0)
    v_mfma_f32_32x32x16_bf16 v[168:183], a[252:255], v[132:135], v[168:183]
    v_add_u32 v136, s83, v160
    v_add_u32 v137, s83, v161
    s_xor_b32 s83, s83, 16384
    s_mul_i32 s60, s82, 73728
    s_nop 8
    ds_write_b128 v136, v[168:171] offset:0
    ds_write_b128 v136, v[172:175] offset:1024
    ds_write_b128 v136, v[176:179] offset:2048
    ds_write_b128 v136, v[180:183] offset:3072
    s_waitcnt lgkmcnt(0)
    s_barrier
    ds_read_b128 v[168:171], v137 offset:0
    ds_read_b128 v[172:175], v137 offset:4096
    ds_read_b128 v[176:179], v137 offset:8192
    ds_read_b128 v[180:183], v137 offset:12288
    s_waitcnt lgkmcnt(2)
    v_pk_add_f32 v[168:169], v[168:169], v[172:173]
    v_pk_add_f32 v[170:171], v[170:171], v[174:175]
    s_waitcnt lgkmcnt(0)
    v_pk_add_f32 v[176:177], v[176:177], v[180:181]
    v_pk_add_f32 v[178:179], v[178:179], v[182:183]
    v_pk_add_f32 v[168:169], v[168:169], v[176:177]
    v_pk_add_f32 v[170:171], v[170:171], v[178:179]
    v_cvt_pk_bf16_f32 v168, v168, v169
    v_cvt_pk_bf16_f32 v169, v170, v171
    buffer_store_dwordx2 v[168:169], v162, s[44:47], s60 offen
M_evO3:
    s_add_u32 s82, s82, 12
    s_cmp_lt_u32 s82, 64
    s_cbranch_scc1 M_ev
    s_sub_u32 s60, s80, 4
    s_cmp_lt_u32 s60, 6
    s_cbranch_scc0 M_ev
    s_lshr_b32 s59, s60, 1
    s_add_u32 s59, s59, 1
    s_and_b32 s82, s80, 1
    s_add_u32 s82, s82, 62
    s_mov_b32 s80, 99
    s_branch M_ev
M_fin:
    s_branch M_end
M_abort:
    s_mov_b64 exec, -1
    v_mov_b32 v3, 0xdead
    v_mov_b32 v4, 64
    buffer_store_dword v3, v4, s[48:51], 0 offen
    s_waitcnt vmcnt(0)
M_end:
    s_endpgm
M_codeend:
.section .rodata,"a"
.p2align 6
.amdhsa_kernel fused_kernel
  .amdhsa_next_free_vgpr 512
  .amdhsa_next_free_sgpr 102
  .amdhsa_accum_offset 256
  .amdhsa_group_segment_fixed_size 0
  .amdhsa_kernarg_size 104
  .amdhsa_user_sgpr_count 2
  .amdhsa_user_sgpr_kernarg_segment_ptr 1
  .amdhsa_system_sgpr_workgroup_id_x 1
  .amdhsa_float_denorm_mode_32 3
.end_amdhsa_kernel
```
